```python
import torch

def _softmax(x, axis=-1):
    return torch.softmax(x, dim=axis)
def _gelu(x):
    return torch.nn.functional.gelu(x, approximate="tanh")
def _silu(x):
    return torch.nn.functional.silu(x)
def _sigmoid(x):
    return torch.sigmoid(x)
def _layernorm(x, axis=-1, eps=1e-5):
    m = x.mean(dim=axis, keepdim=True)
    v = x.var(dim=axis, keepdim=True, unbiased=False)
    return (x - m) / torch.sqrt(v + eps)
def _scatter_add(tgt, idx, src, axis=0):
    return tgt.clone().index_add_(axis, idx, src)
def _segment_sum(src, seg, n):
    out = torch.zeros((n,) + src.shape[1:], dtype=src.dtype)
    return out.index_add_(0, seg, src)
def _pad(x, pw):
    flat = tuple(v for pair in reversed(pw) for v in pair)
    return torch.nn.functional.pad(x, flat)

kernel_name = 'parallel_sum__softmax_full_mha__dense_activation_silu__prompt'

def setup_inputs():

    _w = (lambda a: (lambda t: t.to(torch.bfloat16) if t.is_floating_point() else t)(torch.as_tensor(a)))
    def _A_setup():
        B, S, D = 1, 2048, 640
        return {
            "x": _w((lambda *s: torch.randn(*s, dtype=torch.bfloat16) * 0.05)(B, S, D)),
            "wqkv": _w((lambda *s: torch.randn(*s, dtype=torch.bfloat16) * 0.05)(D, 3 * D)),
            "wo": _w((lambda *s: torch.randn(*s, dtype=torch.bfloat16) * 0.05)(D, D)),
        }
    _A_in = _A_setup()

    def _B_setup():
        B, S, D, F = 1, 2048, 640, 1728
        return {
            "x": _w((lambda *s: torch.randn(*s, dtype=torch.bfloat16) * 0.05)(B, S, D)),
            "w1": _w((lambda *s: torch.randn(*s, dtype=torch.bfloat16) * 1.6)(D, F) * (D ** -0.5)),
            "w2": _w((lambda *s: torch.randn(*s, dtype=torch.bfloat16) * 0.2)(F, D) * (F ** -0.5)),
        }
    _B_in = _B_setup()

    return {
        "A_x": _A_in["x"],
        "A_wqkv": _A_in["wqkv"],
        "A_wo": _A_in["wo"],
        "B_x": _B_in["x"],
        "B_w1": _B_in["w1"],
        "B_w2": _B_in["w2"],
    }

def reference(A_x, A_wqkv, A_wo, B_x, B_w1, B_w2):
    def _A_ref(x, wqkv, wo):
        B, S, D = x.shape
        H = 32; Dh = D // H
        qkv = (lambda x, *d: x.permute(*d))((x @ wqkv).reshape(B, S, 3, H, Dh), 2, 0, 3, 1, 4)
        q, k, v = qkv[0], qkv[1], qkv[2]
        scale = Dh ** -0.5
        scores = torch.einsum("bhqd,bhkd->bhqk", q, k) * scale
        p = _softmax(scores, axis=-1)
        o = torch.einsum("bhqk,bhkd->bhqd", p, v)
        return (lambda x, *d: x.permute(*d))(o, 0, 2, 1, 3).reshape(B, S, D) @ wo

    def _B_ref(x, w1, w2):
        h = torch.einsum("bsd,df->bsf", x, w1)
        h = _silu(h)
        out = torch.einsum("bsf,fd->bsd", h, w2)
        return out

    x = A_x
    xn = _layernorm(x, axis=-1)
    return x + _A_ref(xn, A_wqkv, A_wo) + _B_ref(xn, B_w1, B_w2)
```

```asm
; @launch grid=(256,1,1) block=(512,1,1) lds=163840
.amdgcn_target "amdgcn-amd-amdhsa--gfx950"
.text
.globl parallel_sum__softmax_full_mha__dense_activation_silu__prompt_kernel
.p2align 8
.type parallel_sum__softmax_full_mha__dense_activation_silu__prompt_kernel,@function
parallel_sum__softmax_full_mha__dense_activation_silu__prompt_kernel:
    s_load_dwordx16 s[40:55], s[0:1], 0
    s_load_dwordx2 s[56:57], s[0:1], 64
    s_cmp_ge_u32 s2, 256
    s_cbranch_scc1 L_end
    s_getpc_b64 s[68:69]
L_pc:
    s_lshr_b32 s63, s2, 3
    s_mul_i32 s63, s63, 1920
    v_lshlrev_b32 v5, 7, v0
    v_add_u32 v5, s63, v5
    v_min_u32 v5, L_code_end-L_pc-4, v5
    v_mov_b32 v7, s69
    v_add_co_u32 v6, vcc, s68, v5
    s_nop 1
    v_addc_co_u32 v7, vcc, 0, v7, vcc
    v_cmp_gt_u32 vcc, 15, v0
    s_and_saveexec_b64 s[66:67], vcc
    s_cbranch_execz L_nocpf
    global_load_dword v127, v[6:7], off
L_nocpf:
    s_mov_b64 exec, s[66:67]
    v_lshrrev_b32 v1, 6, v0
    v_and_b32 v2, 63, v0
    v_readfirstlane_b32 s58, v1
    v_and_b32 v3, 31, v2
    v_lshrrev_b32 v4, 5, v2
    s_and_b32 s62, s2, 7
    s_lshr_b32 s63, s2, 3
    s_and_b32 s59, s62, 1
    s_lshl_b32 s59, s59, 3
    s_and_b32 s65, s63, 7
    s_add_u32 s59, s59, s65
    s_lshr_b32 s65, s62, 1
    s_lshr_b32 s66, s63, 3
    s_lshl_b32 s60, s65, 2
    s_add_u32 s60, s60, s66
    s_mul_i32 s67, s65, 3
    s_sub_u32 s68, s60, 2
    s_add_u32 s61, s67, s66
    s_cmp_eq_u32 s66, 3
    s_cselect_b32 s61, 15, s61
    s_cmp_ge_u32 s65, 2
    s_cselect_b32 s61, s68, s61
    s_mul_i32 s67, s66, 5
    s_lshr_b32 s67, s67, 1
    s_mul_i32 s67, s67, 0
    s_add_u32 s3, s59, s67
    s_mul_i32 s3, s3, 1
    s_mul_i32 s67, s3, 205
    s_lshr_b32 s67, s67, 11
    s_mul_i32 s67, s67, 10
    s_sub_u32 s3, s3, s67
    s_waitcnt lgkmcnt(0)
    s_mov_b32 s8, s40
    s_mov_b32 s9, s41
    s_mov_b32 s10, 0x280000
    s_mov_b32 s11, 0x00020000
    s_mov_b32 s12, s42
    s_mov_b32 s13, s43
    s_mov_b32 s14, 0x258000
    s_mov_b32 s15, 0x00020000
    s_mov_b32 s16, s48
    s_mov_b32 s17, s49
    s_mov_b32 s18, 0x21c000
    s_mov_b32 s19, 0x00020000
    s_mov_b32 s20, s56
    s_mov_b32 s21, s57
    s_mov_b32 s22, 0x14a0000
    s_mov_b32 s23, 0x00020000
    s_cmp_ge_u32 s58, 6
    s_cbranch_scc1 L_misc0
    s_cmp_lt_u32 s58, 4
    s_cbranch_scc1 L_gemm
    s_cmp_eq_u32 s58, 5
    s_cbranch_scc1 L_ld_w
    s_lshl_b32 s40, s59, 7
    v_lshrrev_b32 v5, 3, v2
    v_add_u32 v5, s40, v5
    v_mul_u32_u24 v5, 1280, v5
    v_and_b32 v6, 7, v2
    v_lshrrev_b32 v7, 4, v2
    v_xor_b32 v6, v6, v7
    s_cmp_ge_u32 s60, 10
    s_cselect_b32 s41, 0, 4
    s_cselect_b32 s42, 4, 0
    v_xor_b32 v7, 0, v6
    v_lshl_add_u32 v7, v7, 4, v5
    v_add_u32 v12, 0, v7
    v_xor_b32 v7, 0, v6
    v_lshl_add_u32 v7, v7, 4, v5
    v_add_u32 v8, 0, v7
    v_xor_b32 v7, 4, v6
    v_lshl_add_u32 v7, v7, 4, v5
    v_add_u32 v13, 9216, v7
    v_xor_b32 v7, s41, v6
    v_lshl_add_u32 v7, v7, 4, v5
    v_add_u32 v9, 9216, v7
    v_xor_b32 v7, 0, v6
    v_lshl_add_u32 v7, v7, 4, v5
    v_add_u32 v14, 18432, v7
    v_xor_b32 v7, s42, v6
    v_lshl_add_u32 v7, v7, 4, v5
    v_add_u32 v10, 18432, v7
    v_xor_b32 v7, 4, v6
    v_lshl_add_u32 v7, v7, 4, v5
    v_add_u32 v15, 27648, v7
    v_xor_b32 v7, 4, v6
    v_lshl_add_u32 v7, v7, 4, v5
    v_add_u32 v11, 27648, v7
    s_mov_b64 s[68:69], s[8:9]
    s_mov_b32 s70, s10
    s_mov_b32 s71, 0x00020000
    s_mov_b64 s[44:45], s[8:9]
    s_mov_b32 s46, s10
    s_movk_i32 s40, 128
    s_mov_b32 s41, 40960
    s_movk_i32 s42, 128
    s_mov_b32 s43, 40960
    s_mov_b32 s47, 0
    s_branch L_ld_go
L_ld_w:
    v_lshrrev_b32 v5, 4, v2
    v_and_b32 v6, 15, v2
    v_lshlrev_b32 v7, 2, v5
    v_xor_b32 v6, v6, v7
    v_lshlrev_b32 v6, 4, v6
    s_lshl_b32 s40, s60, 8
    s_lshl_b32 s41, s61, 8
    v_add_u32 v7, s41, v6
    v_add_u32 v6, s40, v6
    s_movk_i32 s40, 3840
    v_mad_u32_u24 v6, v5, s40, v6
    s_movk_i32 s40, 3456
    v_mad_u32_u24 v7, v5, s40, v7
    v_add_u32 v8, 0, v6
    v_add_u32 v12, 0, v7
    v_add_u32 v9, 14336, v6
    v_add_u32 v13, 12800, v7
    v_xor_b32 v6, 32, v6
    v_xor_b32 v7, 32, v7
    v_add_u32 v10, 28672, v6
    v_add_u32 v14, 25600, v7
    v_add_u32 v11, 43008, v6
    v_add_u32 v15, 38400, v7
    s_mov_b64 s[68:69], s[12:13]
    s_mov_b32 s70, s14
    s_mov_b32 s71, 0x00020000
    s_mov_b64 s[44:45], s[16:17]
    s_mov_b32 s46, s18
    s_mov_b32 s40, 245760
    s_mov_b32 s41, 61440
    s_mov_b32 s42, 221184
    s_mov_b32 s43, 55296
    s_mov_b32 s47, 65536
L_ld_go:
    s_mov_b32 s65, 0
    s_mov_b32 s48, 0
    s_mov_b32 s52, s3
    s_cmp_eq_u32 s60, 15
    s_cbranch_scc1 L_ld_h
L_ld_0:
    s_mul_i32 s51, s52, s40
    s_add_u32 m0, s47, s48
    s_setprio 2
    buffer_load_dwordx4 v8, s[68:71], s51 offen offset:0 lds
    buffer_load_dwordx4 v9, s[68:71], s51 offen offset:1024 lds
    buffer_load_dwordx4 v10, s[68:71], s51 offen offset:2048 lds
    buffer_load_dwordx4 v11, s[68:71], s51 offen offset:3072 lds
    s_add_u32 m0, m0, 4096
    s_add_u32 s51, s51, s41
    buffer_load_dwordx4 v8, s[68:71], s51 offen offset:0 lds
    buffer_load_dwordx4 v9, s[68:71], s51 offen offset:1024 lds
    buffer_load_dwordx4 v10, s[68:71], s51 offen offset:2048 lds
    buffer_load_dwordx4 v11, s[68:71], s51 offen offset:3072 lds
    s_add_u32 m0, m0, 4096
    s_add_u32 s51, s51, s41
    buffer_load_dwordx4 v8, s[68:71], s51 offen offset:0 lds
    buffer_load_dwordx4 v9, s[68:71], s51 offen offset:1024 lds
    buffer_load_dwordx4 v10, s[68:71], s51 offen offset:2048 lds
    buffer_load_dwordx4 v11, s[68:71], s51 offen offset:3072 lds
    s_add_u32 m0, m0, 4096
    s_add_u32 s51, s51, s41
    buffer_load_dwordx4 v8, s[68:71], s51 offen offset:0 lds
    buffer_load_dwordx4 v9, s[68:71], s51 offen offset:1024 lds
    buffer_load_dwordx4 v10, s[68:71], s51 offen offset:2048 lds
    buffer_load_dwordx4 v11, s[68:71], s51 offen offset:3072 lds
    s_add_u32 s52, s52, 1
    s_cmp_ge_u32 s52, 10
    s_cselect_b32 s52, 0, s52
    s_add_u32 s48, s48, 16384
    s_and_b32 s48, s48, 0xffff
    s_add_u32 s65, s65, 1
    s_mul_i32 s51, s52, s40
    s_add_u32 m0, s47, s48
    s_nop 0
    buffer_load_dwordx4 v8, s[68:71], s51 offen offset:0 lds
    buffer_load_dwordx4 v9, s[68:71], s51 offen offset:1024 lds
    buffer_load_dwordx4 v10, s[68:71], s51 offen offset:2048 lds
    buffer_load_dwordx4 v11, s[68:71], s51 offen offset:3072 lds
    s_add_u32 m0, m0, 4096
    s_add_u32 s51, s51, s41
    buffer_load_dwordx4 v8, s[68:71], s51 offen offset:0 lds
    buffer_load_dwordx4 v9, s[68:71], s51 offen offset:1024 lds
    buffer_load_dwordx4 v10, s[68:71], s51 offen offset:2048 lds
    buffer_load_dwordx4 v11, s[68:71], s51 offen offset:3072 lds
    s_add_u32 m0, m0, 4096
    s_add_u32 s51, s51, s41
    buffer_load_dwordx4 v8, s[68:71], s51 offen offset:0 lds
    buffer_load_dwordx4 v9, s[68:71], s51 offen offset:1024 lds
    buffer_load_dwordx4 v10, s[68:71], s51 offen offset:2048 lds
    buffer_load_dwordx4 v11, s[68:71], s51 offen offset:3072 lds
    s_add_u32 m0, m0, 4096
    s_add_u32 s51, s51, s41
    buffer_load_dwordx4 v8, s[68:71], s51 offen offset:0 lds
    buffer_load_dwordx4 v9, s[68:71], s51 offen offset:1024 lds
    buffer_load_dwordx4 v10, s[68:71], s51 offen offset:2048 lds
    buffer_load_dwordx4 v11, s[68:71], s51 offen offset:3072 lds
    s_add_u32 s52, s52, 1
    s_cmp_ge_u32 s52, 10
    s_cselect_b32 s52, 0, s52
    s_add_u32 s48, s48, 16384
    s_and_b32 s48, s48, 0xffff
    s_add_u32 s65, s65, 1
    s_cmp_eq_u32 s61, 15
    s_cselect_b32 s66, 10, 20
    s_lshl_b32 s28, s62, 2
    s_lshr_b32 s29, s63, 3
    s_add_u32 s28, s28, s29
    s_and_b32 s29, s63, 7
    s_mul_i32 s30, s28, 20
    s_add_u32 s31, s30, 19
    s_lshr_b32 s30, s30, 7
    s_lshr_b32 s31, s31, 7
    v_mov_b32 v226, s30
    v_mov_b32 v227, s31
    v_bfe_u32 v225, v2, 4, 1
    v_cmp_eq_u32 vcc, 0, v225
    v_mad_u32_u24 v228, v4, 5, 5
    v_and_b32 v229, 15, v2
    v_cndmask_b32 v225, v227, v226, vcc
    v_add_u32 v225, v225, v228
    v_lshl_add_u32 v225, v225, 4, v229
    v_lshlrev_b32 v225, 7, v225
    v_add_u32 v216, 0x1422000, v225
    v_bfe_u32 v225, v2, 1, 1
    v_cmp_eq_u32 vcc, 0, v225
    s_lshl_b32 s30, s29, 1
    v_and_b32 v229, 1, v2
    v_add_u32 v229, s30, v229
    v_cndmask_b32 v225, v227, v226, vcc
    v_lshl_add_u32 v225, v225, 4, v229
    v_lshlrev_b32 v225, 7, v225
    v_add_u32 v217, 0x1422000, v225
    s_sub_u32 s30, s58, 4
    s_mul_i32 s30, s30, 5120
    v_lshlrev_b32 v218, 4, v2
    v_add_u32 v210, s30, v218
    v_lshlrev_b32 v211, 3, v2
    v_lshlrev_b32 v219, 3, v3
    v_add_u32 v212, 8192, v219
    v_mul_u32_u24 v225, 320, v4
    v_lshl_add_u32 v225, v3, 4, v225
    v_add_u32 v213, 10240, v225
    v_add_u32 v204, 139264, v211
    v_add_u32 v206, 139264, v212
    v_add_u32 v208, 139264, v213
    v_add_u32 v205, 118784, v211
    v_add_u32 v207, 118784, v212
    v_add_u32 v209, 118784, v213
    v_mov_b32 v215, 0x100
    v_mov_b32 v214, 162304
    v_cmp_eq_u32 vcc, 24, v3
    v_cmp_eq_u32 s[30:31], 28, v3
    v_mov_b32 v225, 0x3f803f80
    s_or_b64 vcc, vcc, s[30:31]
    s_nop 1
    v_cndmask_b32 v172, 0, v225, vcc
    v_cndmask_b32 v173, 0, v225, vcc
    v_cndmask_b32 v174, 0, v225, vcc
    v_cndmask_b32 v175, 0, v225, vcc
    v_cndmask_b32 v176, 0, v225, vcc
    v_cndmask_b32 v177, 0, v225, vcc
    v_cndmask_b32 v178, 0, v225, vcc
    v_cndmask_b32 v179, 0, v225, vcc
    v_cndmask_b32 v180, 0, v225, vcc
    v_cndmask_b32 v181, 0, v225, vcc
    v_cndmask_b32 v182, 0, v225, vcc
    v_cndmask_b32 v183, 0, v225, vcc
    v_cndmask_b32 v184, 0, v225, vcc
    v_cndmask_b32 v185, 0, v225, vcc
    v_cndmask_b32 v186, 0, v225, vcc
    v_cndmask_b32 v187, 0, v225, vcc
    v_cndmask_b32 v188, 0, v225, vcc
    v_cndmask_b32 v189, 0, v225, vcc
    v_cndmask_b32 v190, 0, v225, vcc
    v_cndmask_b32 v191, 0, v225, vcc
    v_cndmask_b32 v192, 0, v225, vcc
    v_cndmask_b32 v193, 0, v225, vcc
    v_cndmask_b32 v194, 0, v225, vcc
    v_cndmask_b32 v195, 0, v225, vcc
    v_cndmask_b32 v196, 0, v225, vcc
    v_cndmask_b32 v197, 0, v225, vcc
    v_cndmask_b32 v198, 0, v225, vcc
    v_cndmask_b32 v199, 0, v225, vcc
    v_cndmask_b32 v200, 0, v225, vcc
    v_cndmask_b32 v201, 0, v225, vcc
    v_cndmask_b32 v202, 0, v225, vcc
    v_cndmask_b32 v203, 0, v225, vcc
    v_mov_b32 v52, 0
    v_mov_b32 v53, 0
    v_mov_b32 v54, 0
    v_mov_b32 v55, 0
    v_mov_b32 v56, 0
    v_mov_b32 v57, 0
    v_mov_b32 v58, 0
    v_mov_b32 v59, 0
    v_mov_b32 v60, 0
    v_mov_b32 v61, 0
    v_mov_b32 v62, 0
    v_mov_b32 v63, 0
    v_mov_b32 v64, 0
    v_mov_b32 v65, 0
    v_mov_b32 v66, 0
    v_mov_b32 v67, 0
    v_mov_b32 v68, 0
    v_mov_b32 v69, 0
    v_mov_b32 v70, 0
    v_mov_b32 v71, 0
    v_mov_b32 v72, 0
    v_mov_b32 v73, 0
    v_mov_b32 v74, 0
    v_mov_b32 v75, 0
    v_mov_b32 v76, 0
    v_mov_b32 v77, 0
    v_mov_b32 v78, 0
    v_mov_b32 v79, 0
    v_mov_b32 v80, 0
    v_mov_b32 v81, 0
    v_mov_b32 v82, 0
    v_mov_b32 v83, 0
    v_mov_b32 v140, 0
    v_mov_b32 v220, -1
    v_mov_b32 v141, 0
    v_mov_b32 v221, -1
    v_mov_b32 v142, 0
    v_mov_b32 v222, -1
    v_mov_b32 v143, 0
    v_mov_b32 v223, -1
    s_mul_i32 s51, s52, s40
    s_add_u32 m0, s47, s48
    s_waitcnt vmcnt(16)
    s_barrier
    buffer_load_dwordx4 v8, s[68:71], s51 offen offset:0 lds
    buffer_load_dwordx4 v9, s[68:71], s51 offen offset:1024 lds
    buffer_load_dwordx4 v10, s[68:71], s51 offen offset:2048 lds
    buffer_load_dwordx4 v11, s[68:71], s51 offen offset:3072 lds
    s_add_u32 m0, m0, 4096
    s_add_u32 s51, s51, s41
    buffer_load_dwordx4 v8, s[68:71], s51 offen offset:0 lds
    buffer_load_dwordx4 v9, s[68:71], s51 offen offset:1024 lds
    buffer_load_dwordx4 v10, s[68:71], s51 offen offset:2048 lds
    buffer_load_dwordx4 v11, s[68:71], s51 offen offset:3072 lds
    s_add_u32 m0, m0, 4096
    s_add_u32 s51, s51, s41
    buffer_load_dwordx4 v8, s[68:71], s51 offen offset:0 lds
    buffer_load_dwordx4 v9, s[68:71], s51 offen offset:1024 lds
    buffer_load_dwordx4 v10, s[68:71], s51 offen offset:2048 lds
    buffer_load_dwordx4 v11, s[68:71], s51 offen offset:3072 lds
    s_add_u32 m0, m0, 4096
    s_add_u32 s51, s51, s41
    buffer_load_dwordx4 v8, s[68:71], s51 offen offset:0 lds
    buffer_load_dwordx4 v9, s[68:71], s51 offen offset:1024 lds
    buffer_load_dwordx4 v10, s[68:71], s51 offen offset:2048 lds
    buffer_load_dwordx4 v11, s[68:71], s51 offen offset:3072 lds
    s_add_u32 s52, s52, 1
    s_cmp_ge_u32 s52, 10
    s_cselect_b32 s52, 0, s52
    s_add_u32 s48, s48, 16384
    s_and_b32 s48, s48, 0xffff
    s_add_u32 s65, s65, 1
    s_mul_i32 s51, s52, s40
    s_add_u32 m0, s47, s48
    s_branch L_ld_issue
L_ld_w3:
    s_waitcnt vmcnt(32)
    s_barrier
L_ld_issue:
    buffer_load_dwordx4 v8, s[68:71], s51 offen offset:0 lds
    buffer_load_dwordx4 v9, s[68:71], s51 offen offset:1024 lds
    buffer_load_dwordx4 v10, s[68:71], s51 offen offset:2048 lds
    buffer_load_dwordx4 v11, s[68:71], s51 offen offset:3072 lds
    s_add_u32 m0, m0, 4096
    s_add_u32 s51, s51, s41
    buffer_load_dwordx4 v8, s[68:71], s51 offen offset:0 lds
    buffer_load_dwordx4 v9, s[68:71], s51 offen offset:1024 lds
    buffer_load_dwordx4 v10, s[68:71], s51 offen offset:2048 lds
    buffer_load_dwordx4 v11, s[68:71], s51 offen offset:3072 lds
    s_add_u32 m0, m0, 4096
    s_add_u32 s51, s51, s41
    buffer_load_dwordx4 v8, s[68:71], s51 offen offset:0 lds
    buffer_load_dwordx4 v9, s[68:71], s51 offen offset:1024 lds
    buffer_load_dwordx4 v10, s[68:71], s51 offen offset:2048 lds
    buffer_load_dwordx4 v11, s[68:71], s51 offen offset:3072 lds
    s_add_u32 m0, m0, 4096
    s_add_u32 s51, s51, s41
    buffer_load_dwordx4 v8, s[68:71], s51 offen offset:0 lds
    buffer_load_dwordx4 v9, s[68:71], s51 offen offset:1024 lds
    buffer_load_dwordx4 v10, s[68:71], s51 offen offset:2048 lds
    buffer_load_dwordx4 v11, s[68:71], s51 offen offset:3072 lds
    s_add_u32 s52, s52, 1
    s_cmp_ge_u32 s52, 10
    s_cselect_b32 s52, 0, s52
    s_add_u32 s48, s48, 16384
    s_and_b32 s48, s48, 0xffff
    s_add_u32 s65, s65, 1
    s_cmp_eq_u32 s65, 19
    s_cbranch_scc1 L_ld_last
    s_cmp_eq_u32 s65, 10
    s_cbranch_scc1 L_ld_ten
L_ld_prep:
    s_mul_i32 s51, s52, s40
    s_add_u32 m0, s47, s48
    s_branch L_ld_w3
L_ld_ten:
    s_cmp_eq_u32 s66, 10
    s_cbranch_scc1 L_ld_end
    s_mov_b64 s[68:69], s[44:45]
    s_mov_b32 s70, s46
    s_mov_b32 s40, s42
    s_mov_b32 s41, s43
    v_mov_b32 v8, v12
    v_mov_b32 v9, v13
    v_mov_b32 v10, v14
    v_mov_b32 v11, v15
    s_cmp_eq_u32 s58, 4
    s_cbranch_scc1 L_ld_keep
    s_add_u32 s52, s3, 6
    s_sub_u32 s54, s52, 10
    s_cmp_ge_u32 s52, 10
    s_cselect_b32 s52, s54, s52
    s_branch L_ld_prep
L_ld_keep:
    s_mov_b32 s65, 14
    s_mul_i32 s51, s52, s40
    s_add_u32 m0, s47, s48
    s_waitcnt vmcnt(32)
    s_barrier
    s_waitcnt vmcnt(16)
    s_barrier
    s_waitcnt vmcnt(0)
    s_barrier
    s_barrier
    s_barrier
    s_branch L_ld_issue
L_ld_end:
    s_waitcnt vmcnt(32)
    s_barrier
    s_waitcnt vmcnt(16)
    s_barrier
    s_waitcnt vmcnt(0)
    s_barrier
L_ld_last:
    s_waitcnt vmcnt(32)
    s_barrier
    s_branch L_attn
L_misc0:
    s_setprio 2
    s_mov_b32 s24, s54
    s_mov_b32 s25, s55
    s_mov_b32 s26, 0x100
    s_mov_b32 s27, 0x00020000
    v_mov_b32 v16, 0x1440000
    s_lshl_b32 s40, s2, 3
    s_add_u32 s40, s40, s58
    s_cmp_lg_u32 s40, 6
    s_cbranch_scc1 L_m_noep
    buffer_load_dword v17, v16, s[20:23], 0 offen sc1
L_m_noep:
    s_and_b32 s41, s62, 1
    s_lshl_b32 s41, s41, 7
    s_lshr_b32 s42, s62, 1
    s_lshl_b32 s42, s42, 5
    s_add_u32 s41, s41, s42
    s_add_u32 s41, s41, s63
    s_lshl_b32 s41, s41, 3
    s_sub_u32 s42, s58, 6
    s_lshl_b32 s42, s42, 2
    s_add_u32 s41, s41, s42
    v_add_u32 v8, s41, v4
    v_mul_u32_u24 v5, 1280, v8
    v_lshl_add_u32 v84, v3, 4, v5
    v_lshl_add_u32 v85, v3, 3, v5
    s_movk_i32 s47, 2560
    buffer_load_dwordx4 v[20:23], v84, s[8:11], 0 offen
    buffer_load_dwordx4 v[24:27], v84, s[8:11], 0 offen offset:512
    buffer_load_dwordx2 v[28:29], v85, s[8:11], 0 offen offset:1024
    buffer_load_dwordx4 v[32:35], v84, s[8:11], s47 offen
    buffer_load_dwordx4 v[36:39], v84, s[8:11], s47 offen offset:512
    buffer_load_dwordx2 v[40:41], v85, s[8:11], s47 offen offset:1024
    s_cmp_eq_u32 s58, 7
    s_cbranch_scc1 L_m_pfw
    v_mov_b32 v5, 162304
    v_mov_b32 v6, 0
    ds_write_b32 v5, v6
    ds_write_b32 v5, v6 offset:4
    ds_write_b32 v5, v6 offset:8
    ds_write_b32 v5, v6 offset:12
    ds_write_b32 v5, v6 offset:20
    ds_write_b32 v5, v6 offset:24
    ds_write_b32 v5, v6 offset:28
    s_branch L_m_pfd
L_m_pfw:
L_m_pfd:
    s_cmp_lg_u32 s40, 6
    s_cbranch_scc1 L_m_noep2
    s_waitcnt vmcnt(6)
    v_add_u32 v17, 1, v17
    v_or_b32 v17, 0x80000000, v17
    v_mov_b32 v5, 0
    s_mov_b64 exec, 1
    buffer_store_dword v17, v5, s[24:27], 0 offen sc1
    buffer_store_dword v17, v16, s[20:23], 0 offen sc1
    s_mov_b64 exec, -1
    s_waitcnt vmcnt(2)
L_m_noep2:
    s_lshl_b32 s28, s62, 2
    s_lshr_b32 s29, s63, 3
    s_add_u32 s28, s28, s29
    s_and_b32 s29, s63, 7
    s_mul_i32 s30, s28, 20
    s_add_u32 s31, s30, 19
    s_lshr_b32 s30, s30, 7
    s_lshr_b32 s31, s31, 7
    v_mov_b32 v226, s30
    v_mov_b32 v227, s31
    v_bfe_u32 v225, v2, 4, 1
    v_cmp_eq_u32 vcc, 0, v225
    v_mad_u32_u24 v228, v4, 5, 5
    v_and_b32 v229, 15, v2
    v_cndmask_b32 v225, v227, v226, vcc
    v_add_u32 v225, v225, v228
    v_lshl_add_u32 v225, v225, 4, v229
    v_lshlrev_b32 v225, 7, v225
    v_add_u32 v216, 0x1422000, v225
    v_bfe_u32 v225, v2, 1, 1
    v_cmp_eq_u32 vcc, 0, v225
    s_lshl_b32 s30, s29, 1
    v_and_b32 v229, 1, v2
    v_add_u32 v229, s30, v229
    v_cndmask_b32 v225, v227, v226, vcc
    v_lshl_add_u32 v225, v225, 4, v229
    v_lshlrev_b32 v225, 7, v225
    v_add_u32 v217, 0x1422000, v225
    s_sub_u32 s30, s58, 4
    s_mul_i32 s30, s30, 5120
    v_lshlrev_b32 v218, 4, v2
    v_add_u32 v210, s30, v218
    v_lshlrev_b32 v211, 3, v2
    v_lshlrev_b32 v219, 3, v3
    v_add_u32 v212, 8192, v219
    v_mul_u32_u24 v225, 320, v4
    v_lshl_add_u32 v225, v3, 4, v225
    v_add_u32 v213, 10240, v225
    v_add_u32 v204, 139264, v211
    v_add_u32 v206, 139264, v212
    v_add_u32 v208, 139264, v213
    v_add_u32 v205, 118784, v211
    v_add_u32 v207, 118784, v212
    v_add_u32 v209, 118784, v213
    v_mov_b32 v215, 0x100
    v_mov_b32 v214, 162304
    v_cmp_eq_u32 vcc, 24, v3
    v_cmp_eq_u32 s[30:31], 28, v3
    v_mov_b32 v225, 0x3f803f80
    s_or_b64 vcc, vcc, s[30:31]
    s_nop 1
    v_cndmask_b32 v172, 0, v225, vcc
    v_cndmask_b32 v173, 0, v225, vcc
    v_cndmask_b32 v174, 0, v225, vcc
    v_cndmask_b32 v175, 0, v225, vcc
    v_cndmask_b32 v176, 0, v225, vcc
    v_cndmask_b32 v177, 0, v225, vcc
    v_cndmask_b32 v178, 0, v225, vcc
    v_cndmask_b32 v179, 0, v225, vcc
    v_cndmask_b32 v180, 0, v225, vcc
    v_cndmask_b32 v181, 0, v225, vcc
    v_cndmask_b32 v182, 0, v225, vcc
    v_cndmask_b32 v183, 0, v225, vcc
    v_cndmask_b32 v184, 0, v225, vcc
    v_cndmask_b32 v185, 0, v225, vcc
    v_cndmask_b32 v186, 0, v225, vcc
    v_cndmask_b32 v187, 0, v225, vcc
    v_cndmask_b32 v188, 0, v225, vcc
    v_cndmask_b32 v189, 0, v225, vcc
    v_cndmask_b32 v190, 0, v225, vcc
    v_cndmask_b32 v191, 0, v225, vcc
    v_cndmask_b32 v192, 0, v225, vcc
    v_cndmask_b32 v193, 0, v225, vcc
    v_cndmask_b32 v194, 0, v225, vcc
    v_cndmask_b32 v195, 0, v225, vcc
    v_cndmask_b32 v196, 0, v225, vcc
    v_cndmask_b32 v197, 0, v225, vcc
    v_cndmask_b32 v198, 0, v225, vcc
    v_cndmask_b32 v199, 0, v225, vcc
    v_cndmask_b32 v200, 0, v225, vcc
    v_cndmask_b32 v201, 0, v225, vcc
    v_cndmask_b32 v202, 0, v225, vcc
    v_cndmask_b32 v203, 0, v225, vcc
    v_mov_b32 v52, 0
    v_mov_b32 v53, 0
    v_mov_b32 v54, 0
    v_mov_b32 v55, 0
    v_mov_b32 v56, 0
    v_mov_b32 v57, 0
    v_mov_b32 v58, 0
    v_mov_b32 v59, 0
    v_mov_b32 v60, 0
    v_mov_b32 v61, 0
    v_mov_b32 v62, 0
    v_mov_b32 v63, 0
    v_mov_b32 v64, 0
    v_mov_b32 v65, 0
    v_mov_b32 v66, 0
    v_mov_b32 v67, 0
    v_mov_b32 v68, 0
    v_mov_b32 v69, 0
    v_mov_b32 v70, 0
    v_mov_b32 v71, 0
    v_mov_b32 v72, 0
    v_mov_b32 v73, 0
    v_mov_b32 v74, 0
    v_mov_b32 v75, 0
    v_mov_b32 v76, 0
    v_mov_b32 v77, 0
    v_mov_b32 v78, 0
    v_mov_b32 v79, 0
    v_mov_b32 v80, 0
    v_mov_b32 v81, 0
    v_mov_b32 v82, 0
    v_mov_b32 v83, 0
    v_mov_b32 v140, 0
    v_mov_b32 v220, -1
    v_mov_b32 v141, 0
    v_mov_b32 v221, -1
    v_mov_b32 v142, 0
    v_mov_b32 v222, -1
    v_mov_b32 v143, 0
    v_mov_b32 v223, -1
    s_waitcnt lgkmcnt(0)
    s_cmp_eq_u32 s60, 15
    s_cbranch_scc1 L_m_helper
    s_cmp_eq_u32 s58, 7
    s_cbranch_scc1 L_m_7
    s_barrier
    s_waitcnt vmcnt(0)
    v_lshlrev_b32 v88, 16, v20
    v_and_b32 v89, 0xffff0000, v20
    v_lshlrev_b32 v90, 16, v21
    v_and_b32 v91, 0xffff0000, v21
    v_lshlrev_b32 v92, 16, v22
    v_and_b32 v93, 0xffff0000, v22
    v_lshlrev_b32 v94, 16, v23
    v_and_b32 v95, 0xffff0000, v23
    v_lshlrev_b32 v96, 16, v24
    v_and_b32 v97, 0xffff0000, v24
    v_lshlrev_b32 v98, 16, v25
    v_and_b32 v99, 0xffff0000, v25
    v_lshlrev_b32 v100, 16, v26
    v_and_b32 v101, 0xffff0000, v26
    v_lshlrev_b32 v102, 16, v27
    v_and_b32 v103, 0xffff0000, v27
    v_lshlrev_b32 v104, 16, v28
    v_and_b32 v105, 0xffff0000, v28
    v_lshlrev_b32 v106, 16, v29
    v_and_b32 v107, 0xffff0000, v29
    v_lshlrev_b32 v108, 16, v32
    v_and_b32 v109, 0xffff0000, v32
    v_lshlrev_b32 v110, 16, v33
    v_and_b32 v111, 0xffff0000, v33
    v_lshlrev_b32 v112, 16, v34
    v_and_b32 v113, 0xffff0000, v34
    v_lshlrev_b32 v114, 16, v35
    v_and_b32 v115, 0xffff0000, v35
    v_lshlrev_b32 v116, 16, v36
    v_and_b32 v117, 0xffff0000, v36
    v_lshlrev_b32 v118, 16, v37
    v_and_b32 v119, 0xffff0000, v37
    v_lshlrev_b32 v120, 16, v38
    v_and_b32 v121, 0xffff0000, v38
    v_lshlrev_b32 v122, 16, v39
    v_and_b32 v123, 0xffff0000, v39
    v_lshlrev_b32 v124, 16, v40
    v_and_b32 v125, 0xffff0000, v40
    v_lshlrev_b32 v126, 16, v41
    v_and_b32 v127, 0xffff0000, v41
    v_add_f32 v10, v88, v89
    v_add_f32 v11, v108, v109
    v_add_f32 v10, v10, v90
    v_add_f32 v11, v11, v110
    v_add_f32 v10, v10, v91
    v_add_f32 v11, v11, v111
    v_add_f32 v10, v10, v92
    v_add_f32 v11, v11, v112
    v_add_f32 v10, v10, v93
    v_add_f32 v11, v11, v113
    v_add_f32 v10, v10, v94
    v_add_f32 v11, v11, v114
    v_add_f32 v10, v10, v95
    v_add_f32 v11, v11, v115
    v_add_f32 v10, v10, v96
    v_add_f32 v11, v11, v116
    v_add_f32 v10, v10, v97
    v_add_f32 v11, v11, v117
    v_add_f32 v10, v10, v98
    v_add_f32 v11, v11, v118
    v_add_f32 v10, v10, v99
    v_add_f32 v11, v11, v119
    v_add_f32 v10, v10, v100
    v_add_f32 v11, v11, v120
    v_add_f32 v10, v10, v101
    v_add_f32 v11, v11, v121
    v_add_f32 v10, v10, v102
    v_add_f32 v11, v11, v122
    v_add_f32 v10, v10, v103
    v_add_f32 v11, v11, v123
    v_add_f32 v10, v10, v104
    v_add_f32 v11, v11, v124
    v_add_f32 v10, v10, v105
    v_add_f32 v11, v11, v125
    v_add_f32 v10, v10, v106
    v_add_f32 v11, v11, v126
    v_add_f32 v10, v10, v107
    v_add_f32 v11, v11, v127
    s_barrier
    s_nop 0
    v_add_f32_dpp v10, v10, v10 row_ror:8 row_mask:0xf bank_mask:0xf
    v_add_f32_dpp v11, v11, v11 row_ror:8 row_mask:0xf bank_mask:0xf
    s_nop 0
    v_add_f32_dpp v10, v10, v10 row_ror:4 row_mask:0xf bank_mask:0xf
    v_add_f32_dpp v11, v11, v11 row_ror:4 row_mask:0xf bank_mask:0xf
    s_nop 0
    v_add_f32_dpp v10, v10, v10 row_ror:2 row_mask:0xf bank_mask:0xf
    v_add_f32_dpp v11, v11, v11 row_ror:2 row_mask:0xf bank_mask:0xf
    s_nop 0
    v_add_f32_dpp v10, v10, v10 row_ror:1 row_mask:0xf bank_mask:0xf
    v_add_f32_dpp v11, v11, v11 row_ror:1 row_mask:0xf bank_mask:0xf
    v_mov_b32 v14, v10
    v_mov_b32 v15, v11
    s_nop 0
    v_permlane16_swap_b32 v10, v14
    v_permlane16_swap_b32 v11, v15
    v_add_f32 v10, v10, v14
    v_add_f32 v11, v11, v15
    v_mul_f32 v10, 0x3acccccd, v10
    v_mul_f32 v11, 0x3acccccd, v11
    v_sub_f32 v88, v88, v10
    v_sub_f32 v108, v108, v11
    v_sub_f32 v89, v89, v10
    v_sub_f32 v109, v109, v11
    v_sub_f32 v90, v90, v10
    v_sub_f32 v110, v110, v11
    v_sub_f32 v91, v91, v10
    v_sub_f32 v111, v111, v11
    v_sub_f32 v92, v92, v10
    v_sub_f32 v112, v112, v11
    v_sub_f32 v93, v93, v10
    v_sub_f32 v113, v113, v11
    v_sub_f32 v94, v94, v10
    v_sub_f32 v114, v114, v11
    v_sub_f32 v95, v95, v10
    v_sub_f32 v115, v115, v11
    v_sub_f32 v96, v96, v10
    v_sub_f32 v116, v116, v11
    v_sub_f32 v97, v97, v10
    v_sub_f32 v117, v117, v11
    v_sub_f32 v98, v98, v10
    v_sub_f32 v118, v118, v11
    v_sub_f32 v99, v99, v10
    v_sub_f32 v119, v119, v11
    v_sub_f32 v100, v100, v10
    v_sub_f32 v120, v120, v11
    v_sub_f32 v101, v101, v10
    v_sub_f32 v121, v121, v11
    v_sub_f32 v102, v102, v10
    v_sub_f32 v122, v122, v11
    v_sub_f32 v103, v103, v10
    v_sub_f32 v123, v123, v11
    v_sub_f32 v104, v104, v10
    v_sub_f32 v124, v124, v11
    v_sub_f32 v105, v105, v10
    v_sub_f32 v125, v125, v11
    v_sub_f32 v106, v106, v10
    v_sub_f32 v126, v126, v11
    v_sub_f32 v107, v107, v10
    v_sub_f32 v127, v127, v11
    v_mov_b32 v5, 0
    buffer_load_dword v6, v5, s[24:27], 0 offen sc1
    s_barrier
    v_mul_f32 v12, v88, v88
    v_mul_f32 v13, v108, v108
    v_fmac_f32 v12, v89, v89
    v_fmac_f32 v13, v109, v109
    v_fmac_f32 v12, v90, v90
    v_fmac_f32 v13, v110, v110
    v_fmac_f32 v12, v91, v91
    v_fmac_f32 v13, v111, v111
    v_fmac_f32 v12, v92, v92
    v_fmac_f32 v13, v112, v112
    v_fmac_f32 v12, v93, v93
    v_fmac_f32 v13, v113, v113
    v_fmac_f32 v12, v94, v94
    v_fmac_f32 v13, v114, v114
    v_fmac_f32 v12, v95, v95
    v_fmac_f32 v13, v115, v115
    v_fmac_f32 v12, v96, v96
    v_fmac_f32 v13, v116, v116
    v_fmac_f32 v12, v97, v97
    v_fmac_f32 v13, v117, v117
    v_fmac_f32 v12, v98, v98
    v_fmac_f32 v13, v118, v118
    v_fmac_f32 v12, v99, v99
    v_fmac_f32 v13, v119, v119
    v_fmac_f32 v12, v100, v100
    v_fmac_f32 v13, v120, v120
    v_fmac_f32 v12, v101, v101
    v_fmac_f32 v13, v121, v121
    v_fmac_f32 v12, v102, v102
    v_fmac_f32 v13, v122, v122
    v_fmac_f32 v12, v103, v103
    v_fmac_f32 v13, v123, v123
    v_fmac_f32 v12, v104, v104
    v_fmac_f32 v13, v124, v124
    v_fmac_f32 v12, v105, v105
    v_fmac_f32 v13, v125, v125
    v_fmac_f32 v12, v106, v106
    v_fmac_f32 v13, v126, v126
    v_fmac_f32 v12, v107, v107
    v_fmac_f32 v13, v127, v127
    s_nop 0
    v_add_f32_dpp v12, v12, v12 row_ror:8 row_mask:0xf bank_mask:0xf
    v_add_f32_dpp v13, v13, v13 row_ror:8 row_mask:0xf bank_mask:0xf
    s_nop 0
    v_add_f32_dpp v12, v12, v12 row_ror:4 row_mask:0xf bank_mask:0xf
    v_add_f32_dpp v13, v13, v13 row_ror:4 row_mask:0xf bank_mask:0xf
    s_nop 0
    v_add_f32_dpp v12, v12, v12 row_ror:2 row_mask:0xf bank_mask:0xf
    v_add_f32_dpp v13, v13, v13 row_ror:2 row_mask:0xf bank_mask:0xf
    s_nop 0
    v_add_f32_dpp v12, v12, v12 row_ror:1 row_mask:0xf bank_mask:0xf
    v_add_f32_dpp v13, v13, v13 row_ror:1 row_mask:0xf bank_mask:0xf
    v_mov_b32 v14, v12
    v_mov_b32 v15, v13
    s_nop 0
    v_permlane16_swap_b32 v12, v14
    v_permlane16_swap_b32 v13, v15
    v_add_f32 v12, v12, v14
    v_add_f32 v13, v13, v15
    v_sub_f32 v20, 0, v10
    v_mov_b32 v22, 0x3727c5ac
    v_fmac_f32 v22, 0x3acccccd, v12
    v_rsq_f32 v21, v22
    v_sqrt_f32 v22, v22
    v_sub_f32 v24, 0, v11
    v_mov_b32 v26, 0x3727c5ac
    v_fmac_f32 v26, 0x3acccccd, v13
    v_rsq_f32 v25, v26
    v_sqrt_f32 v26, v26
    s_waitcnt vmcnt(0)
    v_cmp_eq_u32 vcc, 0, v6
    s_nop 1
    s_cbranch_vccnz L_o1
L_ob2:
    v_readfirstlane_b32 s64, v6
    v_lshlrev_b32 v8, 4, v8
    v_add_u32 v8, 0x1400000, v8
    v_mov_b32 v23, s64
    v_mov_b32 v27, s64
    s_mov_b32 exec_lo, 1
    s_mov_b32 exec_hi, 1
    buffer_store_dwordx4 v[20:23], v8, s[20:23], 0 offen sc1
    buffer_store_dwordx4 v[24:27], v8, s[20:23], 0 offen offset:32 sc1
    s_mov_b64 exec, -1
    v_mov_b32 v5, 162320
    ds_write_b32 v5, v23
    s_barrier
    s_barrier
    s_barrier
    s_lshl_b32 s42, s59, 11
    s_add_u32 s42, s42, 0x1400000
    v_lshlrev_b32 v9, 4, v2
    buffer_load_dwordx4 v[28:31], v9, s[20:23], s42 offen sc1
    buffer_load_dwordx4 v[32:35], v9, s[20:23], s42 offen offset:1024 sc1
    s_barrier
    s_barrier
    s_waitcnt vmcnt(0)
    v_cmp_ne_u32 vcc, s64, v31
    v_cmp_ne_u32 s[44:45], s64, v35
    s_nop 1
    s_or_b64 vcc, vcc, s[44:45]
    s_nop 1
    s_cbranch_vccnz L_o5
L_ob6:
    s_barrier
    v_lshlrev_b32 v9, 2, v2
    v_add_u32 v9, 159744, v9
    v_mul_f32 v31, 0xbfb8aa3b, v29
    v_mul_f32 v35, 0xbfb8aa3b, v33
    ds_write_b32 v9, v28 offset:0
    ds_write_b32 v9, v32 offset:256
    ds_write_b32 v9, v29 offset:512
    ds_write_b32 v9, v33 offset:768
    ds_write_b32 v9, v30 offset:1024
    ds_write_b32 v9, v34 offset:1280
    ds_write_b32 v9, v31 offset:3584
    ds_write_b32 v9, v35 offset:3840
    s_barrier
    s_waitcnt lgkmcnt(0)
    s_barrier
    s_cmp_eq_u32 s61, 15
    s_cbranch_scc1 L_attn
    s_barrier
    s_barrier
    s_lshl_b32 s42, s60, 4
    s_add_u32 s42, s42, s59
    s_lshl_b32 s42, s42, 7
    s_add_u32 s42, s42, 0x1422000
    v_mov_b32 v5, 0
    v_mov_b32 v6, s64
    s_barrier
    s_mov_b64 exec, 1
    buffer_store_dword v6, v5, s[20:23], s42 offen sc1
    s_mov_b64 exec, -1
    s_barrier
    s_barrier
    s_barrier
    s_branch L_attn
L_m_7:
    s_barrier
    s_waitcnt vmcnt(0)
    v_lshlrev_b32 v88, 16, v20
    v_and_b32 v89, 0xffff0000, v20
    v_lshlrev_b32 v90, 16, v21
    v_and_b32 v91, 0xffff0000, v21
    v_lshlrev_b32 v92, 16, v22
    v_and_b32 v93, 0xffff0000, v22
    v_lshlrev_b32 v94, 16, v23
    v_and_b32 v95, 0xffff0000, v23
    v_lshlrev_b32 v96, 16, v24
    v_and_b32 v97, 0xffff0000, v24
    v_lshlrev_b32 v98, 16, v25
    v_and_b32 v99, 0xffff0000, v25
    v_lshlrev_b32 v100, 16, v26
    v_and_b32 v101, 0xffff0000, v26
    v_lshlrev_b32 v102, 16, v27
    v_and_b32 v103, 0xffff0000, v27
    v_lshlrev_b32 v104, 16, v28
    v_and_b32 v105, 0xffff0000, v28
    v_lshlrev_b32 v106, 16, v29
    v_and_b32 v107, 0xffff0000, v29
    v_lshlrev_b32 v108, 16, v32
    v_and_b32 v109, 0xffff0000, v32
    v_lshlrev_b32 v110, 16, v33
    v_and_b32 v111, 0xffff0000, v33
    v_lshlrev_b32 v112, 16, v34
    v_and_b32 v113, 0xffff0000, v34
    v_lshlrev_b32 v114, 16, v35
    v_and_b32 v115, 0xffff0000, v35
    v_lshlrev_b32 v116, 16, v36
    v_and_b32 v117, 0xffff0000, v36
    v_lshlrev_b32 v118, 16, v37
    v_and_b32 v119, 0xffff0000, v37
    v_lshlrev_b32 v120, 16, v38
    v_and_b32 v121, 0xffff0000, v38
    v_lshlrev_b32 v122, 16, v39
    v_and_b32 v123, 0xffff0000, v39
    v_lshlrev_b32 v124, 16, v40
    v_and_b32 v125, 0xffff0000, v40
    v_lshlrev_b32 v126, 16, v41
    v_and_b32 v127, 0xffff0000, v41
    v_add_f32 v10, v88, v89
    v_add_f32 v11, v108, v109
    v_add_f32 v10, v10, v90
    v_add_f32 v11, v11, v110
    v_add_f32 v10, v10, v91
    v_add_f32 v11, v11, v111
    v_add_f32 v10, v10, v92
    v_add_f32 v11, v11, v112
    v_add_f32 v10, v10, v93
    v_add_f32 v11, v11, v113
    v_add_f32 v10, v10, v94
    v_add_f32 v11, v11, v114
    v_add_f32 v10, v10, v95
    v_add_f32 v11, v11, v115
    v_add_f32 v10, v10, v96
    v_add_f32 v11, v11, v116
    v_add_f32 v10, v10, v97
    v_add_f32 v11, v11, v117
    v_add_f32 v10, v10, v98
    v_add_f32 v11, v11, v118
    v_add_f32 v10, v10, v99
    v_add_f32 v11, v11, v119
    v_add_f32 v10, v10, v100
    v_add_f32 v11, v11, v120
    v_add_f32 v10, v10, v101
    v_add_f32 v11, v11, v121
    v_add_f32 v10, v10, v102
    v_add_f32 v11, v11, v122
    v_add_f32 v10, v10, v103
    v_add_f32 v11, v11, v123
    v_add_f32 v10, v10, v104
    v_add_f32 v11, v11, v124
    v_add_f32 v10, v10, v105
    v_add_f32 v11, v11, v125
    v_add_f32 v10, v10, v106
    v_add_f32 v11, v11, v126
    v_add_f32 v10, v10, v107
    v_add_f32 v11, v11, v127
    s_barrier
    s_nop 0
    v_add_f32_dpp v10, v10, v10 row_ror:8 row_mask:0xf bank_mask:0xf
    v_add_f32_dpp v11, v11, v11 row_ror:8 row_mask:0xf bank_mask:0xf
    s_nop 0
    v_add_f32_dpp v10, v10, v10 row_ror:4 row_mask:0xf bank_mask:0xf
    v_add_f32_dpp v11, v11, v11 row_ror:4 row_mask:0xf bank_mask:0xf
    s_nop 0
    v_add_f32_dpp v10, v10, v10 row_ror:2 row_mask:0xf bank_mask:0xf
    v_add_f32_dpp v11, v11, v11 row_ror:2 row_mask:0xf bank_mask:0xf
    s_nop 0
    v_add_f32_dpp v10, v10, v10 row_ror:1 row_mask:0xf bank_mask:0xf
    v_add_f32_dpp v11, v11, v11 row_ror:1 row_mask:0xf bank_mask:0xf
    v_mov_b32 v14, v10
    v_mov_b32 v15, v11
    s_nop 0
    v_permlane16_swap_b32 v10, v14
    v_permlane16_swap_b32 v11, v15
    v_add_f32 v10, v10, v14
    v_add_f32 v11, v11, v15
    v_mul_f32 v10, 0x3acccccd, v10
    v_mul_f32 v11, 0x3acccccd, v11
    v_sub_f32 v88, v88, v10
    v_sub_f32 v108, v108, v11
    v_sub_f32 v89, v89, v10
    v_sub_f32 v109, v109, v11
    v_sub_f32 v90, v90, v10
    v_sub_f32 v110, v110, v11
    v_sub_f32 v91, v91, v10
    v_sub_f32 v111, v111, v11
    v_sub_f32 v92, v92, v10
    v_sub_f32 v112, v112, v11
    v_sub_f32 v93, v93, v10
    v_sub_f32 v113, v113, v11
    v_sub_f32 v94, v94, v10
    v_sub_f32 v114, v114, v11
    v_sub_f32 v95, v95, v10
    v_sub_f32 v115, v115, v11
    v_sub_f32 v96, v96, v10
    v_sub_f32 v116, v116, v11
    v_sub_f32 v97, v97, v10
    v_sub_f32 v117, v117, v11
    v_sub_f32 v98, v98, v10
    v_sub_f32 v118, v118, v11
    v_sub_f32 v99, v99, v10
    v_sub_f32 v119, v119, v11
    v_sub_f32 v100, v100, v10
    v_sub_f32 v120, v120, v11
    v_sub_f32 v101, v101, v10
    v_sub_f32 v121, v121, v11
    v_sub_f32 v102, v102, v10
    v_sub_f32 v122, v122, v11
    v_sub_f32 v103, v103, v10
    v_sub_f32 v123, v123, v11
    v_sub_f32 v104, v104, v10
    v_sub_f32 v124, v124, v11
    v_sub_f32 v105, v105, v10
    v_sub_f32 v125, v125, v11
    v_sub_f32 v106, v106, v10
    v_sub_f32 v126, v126, v11
    v_sub_f32 v107, v107, v10
    v_sub_f32 v127, v127, v11
    v_mov_b32 v5, 0
    buffer_load_dword v6, v5, s[24:27], 0 offen sc1
    s_barrier
    v_mul_f32 v12, v88, v88
    v_mul_f32 v13, v108, v108
    v_fmac_f32 v12, v89, v89
    v_fmac_f32 v13, v109, v109
    v_fmac_f32 v12, v90, v90
    v_fmac_f32 v13, v110, v110
    v_fmac_f32 v12, v91, v91
    v_fmac_f32 v13, v111, v111
    v_fmac_f32 v12, v92, v92
    v_fmac_f32 v13, v112, v112
    v_fmac_f32 v12, v93, v93
    v_fmac_f32 v13, v113, v113
    v_fmac_f32 v12, v94, v94
    v_fmac_f32 v13, v114, v114
    v_fmac_f32 v12, v95, v95
    v_fmac_f32 v13, v115, v115
    v_fmac_f32 v12, v96, v96
    v_fmac_f32 v13, v116, v116
    v_fmac_f32 v12, v97, v97
    v_fmac_f32 v13, v117, v117
    v_fmac_f32 v12, v98, v98
    v_fmac_f32 v13, v118, v118
    v_fmac_f32 v12, v99, v99
    v_fmac_f32 v13, v119, v119
    v_fmac_f32 v12, v100, v100
    v_fmac_f32 v13, v120, v120
    v_fmac_f32 v12, v101, v101
    v_fmac_f32 v13, v121, v121
    v_fmac_f32 v12, v102, v102
    v_fmac_f32 v13, v122, v122
    v_fmac_f32 v12, v103, v103
    v_fmac_f32 v13, v123, v123
    v_fmac_f32 v12, v104, v104
    v_fmac_f32 v13, v124, v124
    v_fmac_f32 v12, v105, v105
    v_fmac_f32 v13, v125, v125
    v_fmac_f32 v12, v106, v106
    v_fmac_f32 v13, v126, v126
    v_fmac_f32 v12, v107, v107
    v_fmac_f32 v13, v127, v127
    s_nop 0
    v_add_f32_dpp v12, v12, v12 row_ror:8 row_mask:0xf bank_mask:0xf
    v_add_f32_dpp v13, v13, v13 row_ror:8 row_mask:0xf bank_mask:0xf
    s_nop 0
    v_add_f32_dpp v12, v12, v12 row_ror:4 row_mask:0xf bank_mask:0xf
    v_add_f32_dpp v13, v13, v13 row_ror:4 row_mask:0xf bank_mask:0xf
    s_nop 0
    v_add_f32_dpp v12, v12, v12 row_ror:2 row_mask:0xf bank_mask:0xf
    v_add_f32_dpp v13, v13, v13 row_ror:2 row_mask:0xf bank_mask:0xf
    s_nop 0
    v_add_f32_dpp v12, v12, v12 row_ror:1 row_mask:0xf bank_mask:0xf
    v_add_f32_dpp v13, v13, v13 row_ror:1 row_mask:0xf bank_mask:0xf
    v_mov_b32 v14, v12
    v_mov_b32 v15, v13
    s_nop 0
    v_permlane16_swap_b32 v12, v14
    v_permlane16_swap_b32 v13, v15
    v_add_f32 v12, v12, v14
    v_add_f32 v13, v13, v15
    v_sub_f32 v20, 0, v10
    v_mov_b32 v22, 0x3727c5ac
    v_fmac_f32 v22, 0x3acccccd, v12
    v_rsq_f32 v21, v22
    v_sqrt_f32 v22, v22
    v_sub_f32 v24, 0, v11
    v_mov_b32 v26, 0x3727c5ac
    v_fmac_f32 v26, 0x3acccccd, v13
    v_rsq_f32 v25, v26
    v_sqrt_f32 v26, v26
    s_waitcnt vmcnt(0)
    v_cmp_eq_u32 vcc, 0, v6
    s_nop 1
    s_cbranch_vccnz L_o9
L_ob10:
    v_readfirstlane_b32 s64, v6
    v_lshlrev_b32 v8, 4, v8
    v_add_u32 v8, 0x1400000, v8
    v_mov_b32 v23, s64
    v_mov_b32 v27, s64
    s_mov_b32 exec_lo, 1
    s_mov_b32 exec_hi, 1
    buffer_store_dwordx4 v[20:23], v8, s[20:23], 0 offen sc1
    buffer_store_dwordx4 v[24:27], v8, s[20:23], 0 offen offset:32 sc1
    s_mov_b64 exec, -1
    v_mov_b32 v5, 162320
    ds_write_b32 v5, v23
    v_lshlrev_b32 v9, 3, v2
    v_add_u32 v9, 162816, v9
    ds_read_b64 v[10:11], v9
    s_mov_b32 s42, s60
    s_mul_i32 s42, s42, 10
    s_add_u32 s42, s42, s59
    s_lshl_b32 s42, s42, 10
    s_add_u32 s42, s42, 0x1450000
    s_cmp_ge_u32 s59, 10
    s_cselect_b32 s42, 0x14a0000, s42
    v_lshlrev_b32 v9, 4, v2
    v_mov_b32 v13, s64
    s_waitcnt lgkmcnt(0)
    v_mov_b32 v12, v11
    v_mov_b32 v11, v13
    buffer_store_dwordx4 v[10:13], v9, s[20:23], s42 offen sc1
    s_barrier
    s_barrier
    s_barrier
    s_mov_b32 s28, s60
    s_mul_i32 s28, s28, 10240
    s_add_u32 s28, s28, 0x1450000
    s_add_u32 s29, s28, 4096
    s_add_u32 s30, s28, 8192
    buffer_load_dwordx4 v[88:91], v218, s[20:23], s28 offen offset:0 sc1
    buffer_load_dwordx4 v[92:95], v218, s[20:23], s28 offen offset:1024 sc1
    buffer_load_dwordx4 v[96:99], v218, s[20:23], s28 offen offset:2048 sc1
    buffer_load_dwordx4 v[100:103], v218, s[20:23], s28 offen offset:3072 sc1
    buffer_load_dwordx4 v[104:107], v218, s[20:23], s29 offen offset:0 sc1
    buffer_load_dwordx4 v[108:111], v218, s[20:23], s29 offen offset:1024 sc1
    buffer_load_dwordx4 v[112:115], v218, s[20:23], s29 offen offset:2048 sc1
    buffer_load_dwordx4 v[116:119], v218, s[20:23], s29 offen offset:3072 sc1
    buffer_load_dwordx4 v[120:123], v218, s[20:23], s30 offen offset:0 sc1
    buffer_load_dwordx4 v[124:127], v218, s[20:23], s30 offen offset:1024 sc1
    s_barrier
    s_barrier
    s_waitcnt vmcnt(0)
    v_min_u32 v10, v89, v91
    v_max_u32 v11, v89, v91
    v_min3_u32 v10, v10, v93, v95
    v_max3_u32 v11, v11, v93, v95
    v_min3_u32 v10, v10, v97, v99
    v_max3_u32 v11, v11, v97, v99
    v_min3_u32 v10, v10, v101, v103
    v_max3_u32 v11, v11, v101, v103
    v_min3_u32 v10, v10, v105, v107
    v_max3_u32 v11, v11, v105, v107
    v_min3_u32 v10, v10, v109, v111
    v_max3_u32 v11, v11, v109, v111
    v_min3_u32 v10, v10, v113, v115
    v_max3_u32 v11, v11, v113, v115
    v_min3_u32 v10, v10, v117, v119
    v_max3_u32 v11, v11, v117, v119
    v_min3_u32 v10, v10, v121, v123
    v_max3_u32 v11, v11, v121, v123
    v_min3_u32 v10, v10, v125, v127
    v_max3_u32 v11, v11, v125, v127
    v_cmp_ne_u32 vcc, s64, v10
    v_cmp_ne_u32 s[32:33], s64, v11
    s_nop 1
    s_or_b64 vcc, vcc, s[32:33]
    s_nop 1
    s_cbranch_vccnz L_o13
L_ob14:
    s_barrier
    v_add_f32 v88, v88, v92
    v_add_f32 v90, v90, v94
    v_add_f32 v96, v96, v100
    v_add_f32 v98, v98, v102
    v_add_f32 v104, v104, v108
    v_add_f32 v106, v106, v110
    v_add_f32 v112, v112, v116
    v_add_f32 v114, v114, v118
    v_add_f32 v120, v120, v124
    v_add_f32 v122, v122, v126
    v_add_f32 v88, v88, v96
    v_add_f32 v90, v90, v98
    v_add_f32 v104, v104, v112
    v_add_f32 v106, v106, v114
    v_add_f32 v88, v88, v104
    v_add_f32 v90, v90, v106
    v_add_f32 v88, v88, v120
    v_add_f32 v90, v90, v122
    v_mov_b32 v89, v90
    v_add_u32 v9, 161280, v211
    ds_write_b64 v9, v[88:89]
    s_barrier
    s_waitcnt lgkmcnt(0)
    s_barrier
    s_cmp_eq_u32 s61, 15
    s_cbranch_scc1 L_attn
    s_barrier
    s_barrier
    v_lshlrev_b32 v9, 3, v2
    v_add_u32 v9, 162816, v9
    ds_read_b64 v[10:11], v9
    s_add_u32 s42, s61, 15
    s_mul_i32 s42, s42, 10
    s_add_u32 s42, s42, s59
    s_lshl_b32 s42, s42, 10
    s_add_u32 s42, s42, 0x1450000
    s_cmp_ge_u32 s59, 10
    s_cselect_b32 s42, 0x14a0000, s42
    v_lshlrev_b32 v9, 4, v2
    v_mov_b32 v13, s64
    s_waitcnt lgkmcnt(0)
    v_mov_b32 v12, v11
    v_mov_b32 v11, v13
    buffer_store_dwordx4 v[10:13], v9, s[20:23], s42 offen sc1
    s_barrier
    s_barrier
    s_barrier
    s_barrier
    s_add_u32 s28, s61, 15
    s_mul_i32 s28, s28, 10240
    s_add_u32 s28, s28, 0x1450000
    s_add_u32 s29, s28, 4096
    s_add_u32 s30, s28, 8192
    buffer_load_dwordx4 v[88:91], v218, s[20:23], s28 offen offset:0 sc1
    buffer_load_dwordx4 v[92:95], v218, s[20:23], s28 offen offset:1024 sc1
    buffer_load_dwordx4 v[96:99], v218, s[20:23], s28 offen offset:2048 sc1
    buffer_load_dwordx4 v[100:103], v218, s[20:23], s28 offen offset:3072 sc1
    buffer_load_dwordx4 v[104:107], v218, s[20:23], s29 offen offset:0 sc1
    buffer_load_dwordx4 v[108:111], v218, s[20:23], s29 offen offset:1024 sc1
    buffer_load_dwordx4 v[112:115], v218, s[20:23], s29 offen offset:2048 sc1
    buffer_load_dwordx4 v[116:119], v218, s[20:23], s29 offen offset:3072 sc1
    buffer_load_dwordx4 v[120:123], v218, s[20:23], s30 offen offset:0 sc1
    buffer_load_dwordx4 v[124:127], v218, s[20:23], s30 offen offset:1024 sc1
    s_add_u32 s4, s56, 0xa00000
    s_addc_u32 s5, s57, 0
    s_mov_b32 s6, 0x940000
    s_mov_b32 s7, 0x00020000
    s_sub_u32 s58, s58, 4
    s_lshl_b32 s40, s62, 2
    s_lshr_b32 s41, s63, 3
    s_add_u32 s40, s40, s41
    s_and_b32 s41, s63, 7
    s_mul_i32 s42, s40, 163840
    s_mul_i32 s43, s41, 20480
    s_add_u32 s43, s43, s42
    s_add_u32 s42, s42, 5242880
    s_mul_i32 s44, s58, 5120
    s_lshl_b32 s45, s58, 11
    s_add_u32 s45, s45, s43
    s_lshl_b32 s46, s58, 9
    s_add_u32 s46, s46, s43
    s_add_u32 s46, s46, 8192
    s_add_u32 s44, s44, 98304
    s_mov_b32 s50, 0x000fffff
    s_mov_b32 s51, 0x000fffff
    s_mov_b64 s[12:13], s[20:21]
    s_mov_b32 s14, s22
    s_mov_b32 s15, 0x00020000
    s_lshl_b32 s47, s41, 3
    s_lshl_b32 s48, s58, 1
    s_add_u32 s47, s47, s48
    s_mul_i32 s47, s47, 151552
    s_lshl_b32 s16, s40, 10
    s_add_u32 s16, s16, s47
    s_lshl_b32 s17, s40, 8
    s_add_u32 s17, s17, s47
    s_add_u32 s17, s17, 32768
    s_add_u32 s18, s16, 151552
    s_add_u32 s19, s17, 151552
    s_barrier
    s_waitcnt vmcnt(0)
    v_min_u32 v10, v89, v91
    v_max_u32 v11, v89, v91
    v_min3_u32 v10, v10, v93, v95
    v_max3_u32 v11, v11, v93, v95
    v_min3_u32 v10, v10, v97, v99
    v_max3_u32 v11, v11, v97, v99
    v_min3_u32 v10, v10, v101, v103
    v_max3_u32 v11, v11, v101, v103
    v_min3_u32 v10, v10, v105, v107
    v_max3_u32 v11, v11, v105, v107
    v_min3_u32 v10, v10, v109, v111
    v_max3_u32 v11, v11, v109, v111
    v_min3_u32 v10, v10, v113, v115
    v_max3_u32 v11, v11, v113, v115
    v_min3_u32 v10, v10, v117, v119
    v_max3_u32 v11, v11, v117, v119
    v_min3_u32 v10, v10, v121, v123
    v_max3_u32 v11, v11, v121, v123
    v_min3_u32 v10, v10, v125, v127
    v_max3_u32 v11, v11, v125, v127
    v_cmp_ne_u32 vcc, s64, v10
    v_cmp_ne_u32 s[32:33], s64, v11
    s_nop 1
    s_or_b64 vcc, vcc, s[32:33]
    s_nop 1
    s_cbranch_vccnz L_o17
L_ob18:
    v_add_f32 v88, v88, v92
    v_add_f32 v90, v90, v94
    v_add_f32 v96, v96, v100
    v_add_f32 v98, v98, v102
    v_add_f32 v104, v104, v108
    v_add_f32 v106, v106, v110
    v_add_f32 v112, v112, v116
    v_add_f32 v114, v114, v118
    v_add_f32 v120, v120, v124
    v_add_f32 v122, v122, v126
    v_add_f32 v88, v88, v96
    v_add_f32 v90, v90, v98
    v_add_f32 v104, v104, v112
    v_add_f32 v106, v106, v114
    v_add_f32 v88, v88, v104
    v_add_f32 v90, v90, v106
    v_add_f32 v88, v88, v120
    v_add_f32 v90, v90, v122
    v_mov_b32 v89, v90
    v_add_u32 v9, 161792, v211
    ds_write_b64 v9, v[88:89]
    s_mov_b32 s70, 0
    s_waitcnt lgkmcnt(0)
    s_branch L_at_b
L_m_helper:
    s_waitcnt vmcnt(0)
    v_lshlrev_b32 v88, 16, v20
    v_and_b32 v89, 0xffff0000, v20
    v_lshlrev_b32 v90, 16, v21
    v_and_b32 v91, 0xffff0000, v21
    v_lshlrev_b32 v92, 16, v22
    v_and_b32 v93, 0xffff0000, v22
    v_lshlrev_b32 v94, 16, v23
    v_and_b32 v95, 0xffff0000, v23
    v_lshlrev_b32 v96, 16, v24
    v_and_b32 v97, 0xffff0000, v24
    v_lshlrev_b32 v98, 16, v25
    v_and_b32 v99, 0xffff0000, v25
    v_lshlrev_b32 v100, 16, v26
    v_and_b32 v101, 0xffff0000, v26
    v_lshlrev_b32 v102, 16, v27
    v_and_b32 v103, 0xffff0000, v27
    v_lshlrev_b32 v104, 16, v28
    v_and_b32 v105, 0xffff0000, v28
    v_lshlrev_b32 v106, 16, v29
    v_and_b32 v107, 0xffff0000, v29
    v_lshlrev_b32 v108, 16, v32
    v_and_b32 v109, 0xffff0000, v32
    v_lshlrev_b32 v110, 16, v33
    v_and_b32 v111, 0xffff0000, v33
    v_lshlrev_b32 v112, 16, v34
    v_and_b32 v113, 0xffff0000, v34
    v_lshlrev_b32 v114, 16, v35
    v_and_b32 v115, 0xffff0000, v35
    v_lshlrev_b32 v116, 16, v36
    v_and_b32 v117, 0xffff0000, v36
    v_lshlrev_b32 v118, 16, v37
    v_and_b32 v119, 0xffff0000, v37
    v_lshlrev_b32 v120, 16, v38
    v_and_b32 v121, 0xffff0000, v38
    v_lshlrev_b32 v122, 16, v39
    v_and_b32 v123, 0xffff0000, v39
    v_lshlrev_b32 v124, 16, v40
    v_and_b32 v125, 0xffff0000, v40
    v_lshlrev_b32 v126, 16, v41
    v_and_b32 v127, 0xffff0000, v41
    v_add_f32 v10, v88, v89
    v_add_f32 v11, v108, v109
    v_add_f32 v10, v10, v90
    v_add_f32 v11, v11, v110
    v_add_f32 v10, v10, v91
    v_add_f32 v11, v11, v111
    v_add_f32 v10, v10, v92
    v_add_f32 v11, v11, v112
    v_add_f32 v10, v10, v93
    v_add_f32 v11, v11, v113
    v_add_f32 v10, v10, v94
    v_add_f32 v11, v11, v114
    v_add_f32 v10, v10, v95
    v_add_f32 v11, v11, v115
    v_add_f32 v10, v10, v96
    v_add_f32 v11, v11, v116
    v_add_f32 v10, v10, v97
    v_add_f32 v11, v11, v117
    v_add_f32 v10, v10, v98
    v_add_f32 v11, v11, v118
    v_add_f32 v10, v10, v99
    v_add_f32 v11, v11, v119
    v_add_f32 v10, v10, v100
    v_add_f32 v11, v11, v120
    v_add_f32 v10, v10, v101
    v_add_f32 v11, v11, v121
    v_add_f32 v10, v10, v102
    v_add_f32 v11, v11, v122
    v_add_f32 v10, v10, v103
    v_add_f32 v11, v11, v123
    v_add_f32 v10, v10, v104
    v_add_f32 v11, v11, v124
    v_add_f32 v10, v10, v105
    v_add_f32 v11, v11, v125
    v_add_f32 v10, v10, v106
    v_add_f32 v11, v11, v126
    v_add_f32 v10, v10, v107
    v_add_f32 v11, v11, v127
    s_nop 0
    v_add_f32_dpp v10, v10, v10 row_ror:8 row_mask:0xf bank_mask:0xf
    v_add_f32_dpp v11, v11, v11 row_ror:8 row_mask:0xf bank_mask:0xf
    s_nop 0
    v_add_f32_dpp v10, v10, v10 row_ror:4 row_mask:0xf bank_mask:0xf
    v_add_f32_dpp v11, v11, v11 row_ror:4 row_mask:0xf bank_mask:0xf
    s_nop 0
    v_add_f32_dpp v10, v10, v10 row_ror:2 row_mask:0xf bank_mask:0xf
    v_add_f32_dpp v11, v11, v11 row_ror:2 row_mask:0xf bank_mask:0xf
    s_nop 0
    v_add_f32_dpp v10, v10, v10 row_ror:1 row_mask:0xf bank_mask:0xf
    v_add_f32_dpp v11, v11, v11 row_ror:1 row_mask:0xf bank_mask:0xf
    v_mov_b32 v14, v10
    v_mov_b32 v15, v11
    s_nop 0
    v_permlane16_swap_b32 v10, v14
    v_permlane16_swap_b32 v11, v15
    v_add_f32 v10, v10, v14
    v_add_f32 v11, v11, v15
    v_mul_f32 v10, 0x3acccccd, v10
    v_mul_f32 v11, 0x3acccccd, v11
    v_sub_f32 v88, v88, v10
    v_sub_f32 v108, v108, v11
    v_sub_f32 v89, v89, v10
    v_sub_f32 v109, v109, v11
    v_sub_f32 v90, v90, v10
    v_sub_f32 v110, v110, v11
    v_sub_f32 v91, v91, v10
    v_sub_f32 v111, v111, v11
    v_sub_f32 v92, v92, v10
    v_sub_f32 v112, v112, v11
    v_sub_f32 v93, v93, v10
    v_sub_f32 v113, v113, v11
    v_sub_f32 v94, v94, v10
    v_sub_f32 v114, v114, v11
    v_sub_f32 v95, v95, v10
    v_sub_f32 v115, v115, v11
    v_sub_f32 v96, v96, v10
    v_sub_f32 v116, v116, v11
    v_sub_f32 v97, v97, v10
    v_sub_f32 v117, v117, v11
    v_sub_f32 v98, v98, v10
    v_sub_f32 v118, v118, v11
    v_sub_f32 v99, v99, v10
    v_sub_f32 v119, v119, v11
    v_sub_f32 v100, v100, v10
    v_sub_f32 v120, v120, v11
    v_sub_f32 v101, v101, v10
    v_sub_f32 v121, v121, v11
    v_sub_f32 v102, v102, v10
    v_sub_f32 v122, v122, v11
    v_sub_f32 v103, v103, v10
    v_sub_f32 v123, v123, v11
    v_sub_f32 v104, v104, v10
    v_sub_f32 v124, v124, v11
    v_sub_f32 v105, v105, v10
    v_sub_f32 v125, v125, v11
    v_sub_f32 v106, v106, v10
    v_sub_f32 v126, v126, v11
    v_sub_f32 v107, v107, v10
    v_sub_f32 v127, v127, v11
    v_mov_b32 v5, 0
    buffer_load_dword v6, v5, s[24:27], 0 offen sc1
    v_mul_f32 v12, v88, v88
    v_mul_f32 v13, v108, v108
    v_fmac_f32 v12, v89, v89
    v_fmac_f32 v13, v109, v109
    v_fmac_f32 v12, v90, v90
    v_fmac_f32 v13, v110, v110
    v_fmac_f32 v12, v91, v91
    v_fmac_f32 v13, v111, v111
    v_fmac_f32 v12, v92, v92
    v_fmac_f32 v13, v112, v112
    v_fmac_f32 v12, v93, v93
    v_fmac_f32 v13, v113, v113
    v_fmac_f32 v12, v94, v94
    v_fmac_f32 v13, v114, v114
    v_fmac_f32 v12, v95, v95
    v_fmac_f32 v13, v115, v115
    v_fmac_f32 v12, v96, v96
    v_fmac_f32 v13, v116, v116
    v_fmac_f32 v12, v97, v97
    v_fmac_f32 v13, v117, v117
    v_fmac_f32 v12, v98, v98
    v_fmac_f32 v13, v118, v118
    v_fmac_f32 v12, v99, v99
    v_fmac_f32 v13, v119, v119
    v_fmac_f32 v12, v100, v100
    v_fmac_f32 v13, v120, v120
    v_fmac_f32 v12, v101, v101
    v_fmac_f32 v13, v121, v121
    v_fmac_f32 v12, v102, v102
    v_fmac_f32 v13, v122, v122
    v_fmac_f32 v12, v103, v103
    v_fmac_f32 v13, v123, v123
    v_fmac_f32 v12, v104, v104
    v_fmac_f32 v13, v124, v124
    v_fmac_f32 v12, v105, v105
    v_fmac_f32 v13, v125, v125
    v_fmac_f32 v12, v106, v106
    v_fmac_f32 v13, v126, v126
    v_fmac_f32 v12, v107, v107
    v_fmac_f32 v13, v127, v127
    s_nop 0
    v_add_f32_dpp v12, v12, v12 row_ror:8 row_mask:0xf bank_mask:0xf
    v_add_f32_dpp v13, v13, v13 row_ror:8 row_mask:0xf bank_mask:0xf
    s_nop 0
    v_add_f32_dpp v12, v12, v12 row_ror:4 row_mask:0xf bank_mask:0xf
    v_add_f32_dpp v13, v13, v13 row_ror:4 row_mask:0xf bank_mask:0xf
    s_nop 0
    v_add_f32_dpp v12, v12, v12 row_ror:2 row_mask:0xf bank_mask:0xf
    v_add_f32_dpp v13, v13, v13 row_ror:2 row_mask:0xf bank_mask:0xf
    s_nop 0
    v_add_f32_dpp v12, v12, v12 row_ror:1 row_mask:0xf bank_mask:0xf
    v_add_f32_dpp v13, v13, v13 row_ror:1 row_mask:0xf bank_mask:0xf
    v_mov_b32 v14, v12
    v_mov_b32 v15, v13
    s_nop 0
    v_permlane16_swap_b32 v12, v14
    v_permlane16_swap_b32 v13, v15
    v_add_f32 v12, v12, v14
    v_add_f32 v13, v13, v15
    v_sub_f32 v20, 0, v10
    v_mov_b32 v22, 0x3727c5ac
    v_fmac_f32 v22, 0x3acccccd, v12
    v_rsq_f32 v21, v22
    v_sqrt_f32 v22, v22
    v_sub_f32 v24, 0, v11
    v_mov_b32 v26, 0x3727c5ac
    v_fmac_f32 v26, 0x3acccccd, v13
    v_rsq_f32 v25, v26
    v_sqrt_f32 v26, v26
    s_waitcnt vmcnt(0)
    v_cmp_eq_u32 vcc, 0, v6
    s_nop 1
    s_cbranch_vccnz L_o21
L_ob22:
    v_readfirstlane_b32 s64, v6
    v_lshlrev_b32 v8, 4, v8
    v_add_u32 v8, 0x1400000, v8
    v_mov_b32 v23, s64
    v_mov_b32 v27, s64
    s_mov_b32 exec_lo, 1
    s_mov_b32 exec_hi, 1
    buffer_store_dwordx4 v[20:23], v8, s[20:23], 0 offen sc1
    buffer_store_dwordx4 v[24:27], v8, s[20:23], 0 offen offset:32 sc1
    s_mov_b64 exec, -1
    v_mov_b32 v5, 162320
    ds_write_b32 v5, v23
    s_waitcnt lgkmcnt(0)
    s_barrier
    s_cmp_eq_u32 s58, 7
    s_cbranch_scc1 L_m_h7
    s_lshl_b32 s42, s59, 11
    s_add_u32 s42, s42, 0x1400000
    v_lshlrev_b32 v9, 4, v2
    buffer_load_dwordx4 v[28:31], v9, s[20:23], s42 offen sc1
    buffer_load_dwordx4 v[32:35], v9, s[20:23], s42 offen offset:1024 sc1
    s_barrier
    s_waitcnt vmcnt(0)
    v_cmp_ne_u32 vcc, s64, v31
    v_cmp_ne_u32 s[44:45], s64, v35
    s_nop 1
    s_or_b64 vcc, vcc, s[44:45]
    s_nop 1
    s_cbranch_vccnz L_o25
L_ob26:
    v_lshlrev_b32 v9, 2, v2
    v_add_u32 v9, 159744, v9
    v_mul_f32 v31, 0xbfb8aa3b, v29
    v_mul_f32 v35, 0xbfb8aa3b, v33
    ds_write_b32 v9, v28 offset:0
    ds_write_b32 v9, v32 offset:256
    ds_write_b32 v9, v29 offset:512
    ds_write_b32 v9, v33 offset:768
    ds_write_b32 v9, v30 offset:1024
    ds_write_b32 v9, v34 offset:1280
    ds_write_b32 v9, v31 offset:3584
    ds_write_b32 v9, v35 offset:3840
    s_waitcnt lgkmcnt(0)
    s_barrier
    s_barrier
    s_barrier
    s_barrier
    s_barrier
    s_branch L_attn
L_m_h7:
    s_barrier
    s_waitcnt lgkmcnt(0)
    s_barrier
    v_lshlrev_b32 v9, 3, v2
    v_add_u32 v9, 162816, v9
    ds_read_b64 v[10:11], v9
    s_add_u32 s42, s61, 15
    s_mul_i32 s42, s42, 10
    s_add_u32 s42, s42, s59
    s_lshl_b32 s42, s42, 10
    s_add_u32 s42, s42, 0x1450000
    s_cmp_ge_u32 s59, 10
    s_cselect_b32 s42, 0x14a0000, s42
    v_lshlrev_b32 v9, 4, v2
    v_mov_b32 v13, s64
    s_waitcnt lgkmcnt(0)
    v_mov_b32 v12, v11
    v_mov_b32 v11, v13
    buffer_store_dwordx4 v[10:13], v9, s[20:23], s42 offen sc1
    s_barrier
    s_barrier
    s_barrier
    s_barrier
    s_add_u32 s28, s61, 15
    s_mul_i32 s28, s28, 10240
    s_add_u32 s28, s28, 0x1450000
    s_add_u32 s29, s28, 4096
    s_add_u32 s30, s28, 8192
    buffer_load_dwordx4 v[88:91], v218, s[20:23], s28 offen offset:0 sc1
    buffer_load_dwordx4 v[92:95], v218, s[20:23], s28 offen offset:1024 sc1
    buffer_load_dwordx4 v[96:99], v218, s[20:23], s28 offen offset:2048 sc1
    buffer_load_dwordx4 v[100:103], v218, s[20:23], s28 offen offset:3072 sc1
    buffer_load_dwordx4 v[104:107], v218, s[20:23], s29 offen offset:0 sc1
    buffer_load_dwordx4 v[108:111], v218, s[20:23], s29 offen offset:1024 sc1
    buffer_load_dwordx4 v[112:115], v218, s[20:23], s29 offen offset:2048 sc1
    buffer_load_dwordx4 v[116:119], v218, s[20:23], s29 offen offset:3072 sc1
    buffer_load_dwordx4 v[120:123], v218, s[20:23], s30 offen offset:0 sc1
    buffer_load_dwordx4 v[124:127], v218, s[20:23], s30 offen offset:1024 sc1
    s_add_u32 s4, s56, 0xa00000
    s_addc_u32 s5, s57, 0
    s_mov_b32 s6, 0x940000
    s_mov_b32 s7, 0x00020000
    s_sub_u32 s58, s58, 4
    s_lshl_b32 s40, s62, 2
    s_lshr_b32 s41, s63, 3
    s_add_u32 s40, s40, s41
    s_and_b32 s41, s63, 7
    s_mul_i32 s42, s40, 163840
    s_mul_i32 s43, s41, 20480
    s_add_u32 s43, s43, s42
    s_add_u32 s42, s42, 5242880
    s_mul_i32 s44, s58, 5120
    s_lshl_b32 s45, s58, 11
    s_add_u32 s45, s45, s43
    s_lshl_b32 s46, s58, 9
    s_add_u32 s46, s46, s43
    s_add_u32 s46, s46, 8192
    s_add_u32 s44, s44, 98304
    s_mov_b32 s50, 0x000fffff
    s_mov_b32 s51, 0x000fffff
    s_mov_b64 s[12:13], s[20:21]
    s_mov_b32 s14, s22
    s_mov_b32 s15, 0x00020000
    s_lshl_b32 s47, s41, 3
    s_lshl_b32 s48, s58, 1
    s_add_u32 s47, s47, s48
    s_mul_i32 s47, s47, 151552
    s_lshl_b32 s16, s40, 10
    s_add_u32 s16, s16, s47
    s_lshl_b32 s17, s40, 8
    s_add_u32 s17, s17, s47
    s_add_u32 s17, s17, 32768
    s_add_u32 s18, s16, 151552
    s_add_u32 s19, s17, 151552
    s_barrier
    s_waitcnt vmcnt(0)
    v_min_u32 v10, v89, v91
    v_max_u32 v11, v89, v91
    v_min3_u32 v10, v10, v93, v95
    v_max3_u32 v11, v11, v93, v95
    v_min3_u32 v10, v10, v97, v99
    v_max3_u32 v11, v11, v97, v99
    v_min3_u32 v10, v10, v101, v103
    v_max3_u32 v11, v11, v101, v103
    v_min3_u32 v10, v10, v105, v107
    v_max3_u32 v11, v11, v105, v107
    v_min3_u32 v10, v10, v109, v111
    v_max3_u32 v11, v11, v109, v111
    v_min3_u32 v10, v10, v113, v115
    v_max3_u32 v11, v11, v113, v115
    v_min3_u32 v10, v10, v117, v119
    v_max3_u32 v11, v11, v117, v119
    v_min3_u32 v10, v10, v121, v123
    v_max3_u32 v11, v11, v121, v123
    v_min3_u32 v10, v10, v125, v127
    v_max3_u32 v11, v11, v125, v127
    v_cmp_ne_u32 vcc, s64, v10
    v_cmp_ne_u32 s[32:33], s64, v11
    s_nop 1
    s_or_b64 vcc, vcc, s[32:33]
    s_nop 1
    s_cbranch_vccnz L_o29
L_ob30:
    v_add_f32 v88, v88, v92
    v_add_f32 v90, v90, v94
    v_add_f32 v96, v96, v100
    v_add_f32 v98, v98, v102
    v_add_f32 v104, v104, v108
    v_add_f32 v106, v106, v110
    v_add_f32 v112, v112, v116
    v_add_f32 v114, v114, v118
    v_add_f32 v120, v120, v124
    v_add_f32 v122, v122, v126
    v_add_f32 v88, v88, v96
    v_add_f32 v90, v90, v98
    v_add_f32 v104, v104, v112
    v_add_f32 v106, v106, v114
    v_add_f32 v88, v88, v104
    v_add_f32 v90, v90, v106
    v_add_f32 v88, v88, v120
    v_add_f32 v90, v90, v122
    v_mov_b32 v89, v90
    v_add_u32 v9, 161792, v211
    ds_write_b64 v9, v[88:89]
    s_mov_b32 s70, 0
    s_waitcnt lgkmcnt(0)
    s_branch L_at_b
L_attn:
    ds_read_b32 v18, v214 offset:16
    s_add_u32 s4, s56, 0xa00000
    s_addc_u32 s5, s57, 0
    s_mov_b32 s6, 0x940000
    s_mov_b32 s7, 0x00020000
    s_sub_u32 s58, s58, 4
    s_lshl_b32 s40, s62, 2
    s_lshr_b32 s41, s63, 3
    s_add_u32 s40, s40, s41
    s_and_b32 s41, s63, 7
    s_mul_i32 s42, s40, 163840
    s_mul_i32 s43, s41, 20480
    s_add_u32 s43, s43, s42
    s_add_u32 s42, s42, 5242880
    s_mul_i32 s44, s58, 5120
    s_lshl_b32 s45, s58, 11
    s_add_u32 s45, s45, s43
    s_lshl_b32 s46, s58, 9
    s_add_u32 s46, s46, s43
    s_add_u32 s46, s46, 8192
    s_add_u32 s44, s44, 98304
    s_mov_b32 s50, 0x000fffff
    s_mov_b32 s51, 0x000fffff
    s_mov_b64 s[12:13], s[20:21]
    s_mov_b32 s14, s22
    s_mov_b32 s15, 0x00020000
    s_lshl_b32 s47, s41, 3
    s_lshl_b32 s48, s58, 1
    s_add_u32 s47, s47, s48
    s_mul_i32 s47, s47, 151552
    s_lshl_b32 s16, s40, 10
    s_add_u32 s16, s16, s47
    s_lshl_b32 s17, s40, 8
    s_add_u32 s17, s17, s47
    s_add_u32 s17, s17, 32768
    s_add_u32 s18, s16, 151552
    s_add_u32 s19, s17, 151552
    s_waitcnt vmcnt(16) lgkmcnt(0)
    s_barrier
    s_waitcnt vmcnt(0)
    v_readfirstlane_b32 s64, v18
    s_mov_b32 s70, 0
    s_cmp_lg_u32 s58, 2
    s_cbranch_scc1 L_at_b
    buffer_load_dword v6, v216, s[20:23], 0 offen sc1
    buffer_load_dword v7, v217, s[20:23], 0 offen sc1
    s_waitcnt vmcnt(0)
    v_cmp_ne_u32 vcc, s64, v6
    v_cmp_ne_u32 s[52:53], s64, v7
    s_nop 1
    s_or_b64 vcc, vcc, s[52:53]
    s_nop 1
    s_cbranch_vccnz L_at_b
    s_mov_b32 s47, s42
    s_mov_b32 m0, 139264
    s_nop 0
    buffer_load_dwordx4 v218, s[12:15], s47 offen offset:0 sc1 lds
    buffer_load_dwordx4 v218, s[12:15], s47 offen offset:1024 sc1 lds
    buffer_load_dwordx4 v218, s[12:15], s47 offen offset:2048 sc1 lds
    buffer_load_dwordx4 v218, s[12:15], s47 offen offset:3072 sc1 lds
    s_add_u32 m0, m0, 4096
    s_add_u32 s47, s47, 4096
    buffer_load_dwordx4 v218, s[12:15], s47 offen offset:0 sc1 lds
    buffer_load_dwordx4 v218, s[12:15], s47 offen offset:1024 sc1 lds
    buffer_load_dwordx4 v218, s[12:15], s47 offen offset:2048 sc1 lds
    buffer_load_dwordx4 v218, s[12:15], s47 offen offset:3072 sc1 lds
    s_add_u32 m0, m0, 4096
    s_add_u32 s47, s47, 4096
    buffer_load_dwordx4 v218, s[12:15], s47 offen offset:0 sc1 lds
    buffer_load_dwordx4 v218, s[12:15], s47 offen offset:1024 sc1 lds
    buffer_load_dwordx4 v218, s[12:15], s47 offen offset:2048 sc1 lds
    buffer_load_dwordx4 v218, s[12:15], s47 offen offset:3072 sc1 lds
    s_add_u32 m0, m0, 4096
    s_add_u32 s47, s47, 4096
    buffer_load_dwordx4 v218, s[12:15], s47 offen offset:0 sc1 lds
    buffer_load_dwordx4 v218, s[12:15], s47 offen offset:1024 sc1 lds
    buffer_load_dwordx4 v218, s[12:15], s47 offen offset:2048 sc1 lds
    buffer_load_dwordx4 v218, s[12:15], s47 offen offset:3072 sc1 lds
    s_add_u32 m0, m0, 4096
    s_add_u32 s47, s47, 4096
    buffer_load_dwordx4 v218, s[12:15], s47 offen offset:0 sc1 lds
    buffer_load_dwordx4 v218, s[12:15], s47 offen offset:1024 sc1 lds
    buffer_load_dwordx4 v218, s[12:15], s47 offen offset:2048 sc1 lds
    buffer_load_dwordx4 v218, s[12:15], s47 offen offset:3072 sc1 lds
    v_mov_b32 v6, 2
    ds_write_b32 v214, v6 offset:20
    s_mov_b32 s70, 2
    s_waitcnt lgkmcnt(0)
L_at_b:
    s_barrier
    s_setprio 3
    s_cmp_lg_u32 s58, 2
    s_cbranch_scc1 L_at_wq
    s_cmp_eq_u32 s70, 2
    s_cbranch_scc1 L_at_go
    s_mov_b32 s71, 20000
L_p33:
    buffer_load_dword v6, v216, s[20:23], 0 offen sc1
    buffer_load_dword v7, v217, s[20:23], 0 offen sc1
    s_waitcnt vmcnt(0)
    v_cmp_ne_u32 vcc, s64, v6
    v_cmp_ne_u32 s[52:53], s64, v7
    s_nop 1
    s_or_b64 vcc, vcc, s[52:53]
    s_nop 1
    s_cbranch_vccz L_pd34
    s_sleep 4
    s_sub_u32 s71, s71, 1
    s_cmp_lg_u32 s71, 0
    s_cbranch_scc1 L_p33
L_pd34:
    v_mov_b32 v6, 1
    ds_write_b32 v214, v6 offset:20
    s_branch L_at_go
L_at_wq:
    s_mov_b32 s71, 80000
L_w35:
    ds_read_b32 v6, v214 offset:20
    s_waitcnt lgkmcnt(0)
    v_readfirstlane_b32 s70, v6
    s_cmp_ge_u32 s70, 1
    s_cbranch_scc1 L_wd36
    s_sleep 1
    s_sub_u32 s71, s71, 1
    s_cmp_lg_u32 s71, 0
    s_cbranch_scc1 L_w35
L_wd36:
L_at_go:
    s_mov_b32 s48, s42
    s_mov_b32 s49, 40960
    s_cmp_eq_u32 s70, 2
    s_cbranch_scc1 L_at_have0
    s_add_u32 m0, s44, s49
    s_add_u32 s47, s48, 4096
    buffer_load_dwordx4 v210, s[12:15], s48 offen offset:0 sc1 lds
    buffer_load_dwordx4 v210, s[12:15], s48 offen offset:1024 sc1 lds
    buffer_load_dwordx4 v210, s[12:15], s48 offen offset:2048 sc1 lds
    buffer_load_dwordx4 v210, s[12:15], s48 offen offset:3072 sc1 lds
    s_add_u32 m0, m0, 4096
    s_nop 0
    buffer_load_dwordx4 v210, s[12:15], s47 offen sc1 lds
L_at_have0:
    buffer_load_dwordx2 v[8:9], v211, s[20:23], s45 offen offset:0 sc1
    buffer_load_dwordx2 v[10:11], v211, s[20:23], s45 offen offset:512 sc1
    buffer_load_dwordx2 v[12:13], v211, s[20:23], s45 offen offset:1024 sc1
    buffer_load_dwordx2 v[14:15], v211, s[20:23], s45 offen offset:1536 sc1
    buffer_load_dwordx2 v[16:17], v211, s[20:23], s46 offen sc1
    buffer_load_dwordx2 v[148:149], v211, s[20:23], s42 offen offset:0 sc1
    buffer_load_dwordx2 v[150:151], v211, s[20:23], s42 offen offset:512 sc1
    buffer_load_dwordx2 v[164:165], v212, s[20:23], s42 offen offset:0 sc1
    buffer_load_dwordx2 v[152:153], v211, s[20:23], s42 offen offset:1024 sc1
    buffer_load_dwordx2 v[154:155], v211, s[20:23], s42 offen offset:1536 sc1
    buffer_load_dwordx2 v[166:167], v212, s[20:23], s42 offen offset:256 sc1
    s_mov_b64 exec, s[50:51]
    buffer_load_dwordx4 v[172:175], v213, s[20:23], s42 offen offset:0 sc1
    buffer_load_dwordx4 v[176:179], v213, s[20:23], s42 offen offset:640 sc1
    s_mov_b64 exec, -1
    s_add_u32 s48, s48, 20480
    s_mov_b32 s49, 20480
    s_add_u32 m0, s44, s49
    s_add_u32 s47, s48, 4096
    buffer_load_dwordx4 v210, s[12:15], s48 offen offset:0 sc1 lds
    buffer_load_dwordx4 v210, s[12:15], s48 offen offset:1024 sc1 lds
    buffer_load_dwordx4 v210, s[12:15], s48 offen offset:2048 sc1 lds
    buffer_load_dwordx4 v210, s[12:15], s48 offen offset:3072 sc1 lds
    s_add_u32 m0, m0, 4096
    s_nop 0
    buffer_load_dwordx4 v210, s[12:15], s47 offen sc1 lds
    buffer_store_dwordx4 v[220:223], v218, s[4:7], s16 offen sc1
    buffer_store_dwordx2 v[220:221], v219, s[4:7], s17 offen sc1
    buffer_store_dwordx4 v[220:223], v218, s[4:7], s18 offen sc1
    buffer_store_dwordx2 v[220:221], v219, s[4:7], s19 offen sc1
    s_waitcnt vmcnt(14)
    s_mov_b64 exec, 1
    ds_add_u32 v214, v215
    s_mov_b64 exec, -1
    v_mfma_f32_32x32x16_bf16 v[84:99], v[148:151], v[8:11], 0
    v_mfma_f32_32x32x16_bf16 v[100:115], v[148:151], v[12:15], 0
    s_nop 9
    v_mfma_f32_32x32x4_2b_bf16 v[84:115], v[164:165], v[16:17], v[84:115]
    s_nop 15
    s_nop 3
    v_max3_f32 v6, v84, v85, v86
    v_max3_f32 v6, v6, v87, v88
    v_max3_f32 v6, v6, v89, v90
    v_max3_f32 v6, v6, v91, v92
    v_max3_f32 v6, v6, v93, v94
    v_max3_f32 v6, v6, v95, v96
    v_max3_f32 v6, v6, v97, v98
    v_max_f32 v6, v6, v99
    v_max3_f32 v7, v100, v101, v102
    v_max3_f32 v7, v7, v103, v104
    v_max3_f32 v7, v7, v105, v106
    v_max3_f32 v7, v7, v107, v108
    v_max3_f32 v7, v7, v109, v110
    v_max3_f32 v7, v7, v111, v112
    v_max3_f32 v7, v7, v113, v114
    v_max_f32 v7, v7, v115
    v_mov_b32 v18, v6
    v_mov_b32 v19, v7
    s_nop 0
    v_permlane32_swap_b32 v6, v18
    v_permlane32_swap_b32 v7, v19
    v_max_f32 v18, v6, v18
    v_max_f32 v19, v7, v19
    v_sub_f32 v20, 0, v18
    v_sub_f32 v21, 0, v18
    v_sub_f32 v22, 0, v18
    v_sub_f32 v23, 0, v18
    v_sub_f32 v24, 0, v18
    v_sub_f32 v25, 0, v18
    v_sub_f32 v26, 0, v18
    v_sub_f32 v27, 0, v18
    v_sub_f32 v28, 0, v18
    v_sub_f32 v29, 0, v18
    v_sub_f32 v30, 0, v18
    v_sub_f32 v31, 0, v18
    v_sub_f32 v32, 0, v18
    v_sub_f32 v33, 0, v18
    v_sub_f32 v34, 0, v18
    v_sub_f32 v35, 0, v18
    v_sub_f32 v36, 0, v19
    v_sub_f32 v37, 0, v19
    v_sub_f32 v38, 0, v19
    v_sub_f32 v39, 0, v19
    v_sub_f32 v40, 0, v19
    v_sub_f32 v41, 0, v19
    v_sub_f32 v42, 0, v19
    v_sub_f32 v43, 0, v19
    v_sub_f32 v44, 0, v19
    v_sub_f32 v45, 0, v19
    v_sub_f32 v46, 0, v19
    v_sub_f32 v47, 0, v19
    v_sub_f32 v48, 0, v19
    v_sub_f32 v49, 0, v19
    v_sub_f32 v50, 0, v19
    v_sub_f32 v51, 0, v19
    v_sub_f32 v84, v84, v18
    v_sub_f32 v85, v85, v18
    v_sub_f32 v86, v86, v18
    v_sub_f32 v87, v87, v18
    v_sub_f32 v88, v88, v18
    v_sub_f32 v89, v89, v18
    v_sub_f32 v90, v90, v18
    v_sub_f32 v91, v91, v18
    v_sub_f32 v92, v92, v18
    v_sub_f32 v93, v93, v18
    v_sub_f32 v94, v94, v18
    v_sub_f32 v95, v95, v18
    v_sub_f32 v96, v96, v18
    v_sub_f32 v97, v97, v18
    v_sub_f32 v98, v98, v18
    v_sub_f32 v99, v99, v18
    v_sub_f32 v100, v100, v19
    v_sub_f32 v101, v101, v19
    v_sub_f32 v102, v102, v19
    v_sub_f32 v103, v103, v19
    v_sub_f32 v104, v104, v19
    v_sub_f32 v105, v105, v19
    v_sub_f32 v106, v106, v19
    v_sub_f32 v107, v107, v19
    v_sub_f32 v108, v108, v19
    v_sub_f32 v109, v109, v19
    v_sub_f32 v110, v110, v19
    v_sub_f32 v111, v111, v19
    v_sub_f32 v112, v112, v19
    v_sub_f32 v113, v113, v19
    v_sub_f32 v114, v114, v19
    v_sub_f32 v115, v115, v19
    s_waitcnt vmcnt(9)
    s_mov_b32 s71, 80000
L_w37:
    ds_read_b32 v6, v214 offset:0
    s_waitcnt lgkmcnt(0)
    v_readfirstlane_b32 s70, v6
    s_cmp_ge_u32 s70, 1024
    s_cbranch_scc1 L_wd38
    s_sub_u32 s71, s71, 1
    s_cmp_lg_u32 s71, 0
    s_cbranch_scc1 L_w37
L_wd38:
    s_movk_i32 s54, 0x404
    s_mov_b32 s55, 0
    s_mov_b32 s49, 0
    s_setprio 1
.p2align 6
L_at_loop:
    v_mfma_f32_32x32x16_bf16 v[116:131], v[152:155], v[8:11], v[20:35]
    v_exp_f32 v84, v84
    v_exp_f32 v85, v85
    v_exp_f32 v86, v86
    v_mfma_f32_32x32x16_bf16 v[68:83], v[200:203], v[140:143], v[68:83]
    v_exp_f32 v87, v87
    v_cvt_pk_bf16_f32 v84, v84, v85
    v_cvt_pk_bf16_f32 v85, v86, v87
    v_exp_f32 v88, v88
    v_mfma_f32_32x32x16_bf16 v[132:147], v[152:155], v[12:15], v[36:51]
    v_exp_f32 v89, v89
    v_exp_f32 v90, v90
    v_exp_f32 v91, v91
    v_cvt_pk_bf16_f32 v86, v88, v89
    v_cvt_pk_bf16_f32 v87, v90, v91
    v_exp_f32 v92, v92
    v_exp_f32 v93, v93
    v_mfma_f32_32x32x16_bf16 v[52:67], v[172:175], v[84:87], v[52:67]
    v_exp_f32 v94, v94
    v_exp_f32 v95, v95
    v_cvt_pk_bf16_f32 v92, v92, v93
    v_cvt_pk_bf16_f32 v93, v94, v95
    v_mfma_f32_32x32x4_2b_bf16 v[116:147], v[166:167], v[16:17], v[116:147]
    ds_read2st64_b64 v[156:159], v204 offset0:4 offset1:5
    ds_read2st64_b64 v[160:163], v204 offset0:6 offset1:7
    ds_read2_b64 v[168:171], v206 offset0:64 offset1:96
    s_mov_b64 exec, s[50:51]
    ds_read_b128 v[180:183], v208 offset:1280
    ds_read_b128 v[184:187], v208 offset:1920
    ds_read_b128 v[188:191], v208 offset:2560
    ds_read_b128 v[192:195], v208 offset:3200
    s_mov_b64 exec, -1
    v_exp_f32 v96, v96
    v_exp_f32 v97, v97
    v_exp_f32 v98, v98
    v_exp_f32 v99, v99
    v_cvt_pk_bf16_f32 v94, v96, v97
    v_cvt_pk_bf16_f32 v95, v98, v99
    v_exp_f32 v100, v100
    v_exp_f32 v101, v101
    v_exp_f32 v102, v102
    v_mfma_f32_32x32x16_bf16 v[52:67], v[176:179], v[92:95], v[52:67]
    v_exp_f32 v103, v103
    v_cvt_pk_bf16_f32 v100, v100, v101
    v_cvt_pk_bf16_f32 v101, v102, v103
    v_exp_f32 v104, v104
    v_exp_f32 v105, v105
    v_exp_f32 v106, v106
    v_exp_f32 v107, v107
    v_cvt_pk_bf16_f32 v102, v104, v105
    v_cvt_pk_bf16_f32 v103, v106, v107
    v_exp_f32 v108, v108
    v_exp_f32 v109, v109
    v_mfma_f32_32x32x16_bf16 v[68:83], v[172:175], v[100:103], v[68:83]
    v_exp_f32 v110, v110
    v_exp_f32 v111, v111
    v_cvt_pk_bf16_f32 v108, v108, v109
    v_cvt_pk_bf16_f32 v109, v110, v111
    v_exp_f32 v112, v112
    v_exp_f32 v113, v113
    v_exp_f32 v114, v114
    v_exp_f32 v115, v115
    v_cvt_pk_bf16_f32 v110, v112, v113
    v_cvt_pk_bf16_f32 v111, v114, v115
    s_waitcnt lgkmcnt(0)
    v_mfma_f32_32x32x16_bf16 v[84:99], v[156:159], v[8:11], v[20:35]
    v_exp_f32 v116, v116
    v_exp_f32 v117, v117
    v_exp_f32 v118, v118
    v_mfma_f32_32x32x16_bf16 v[68:83], v[176:179], v[108:111], v[68:83]
    v_exp_f32 v119, v119
    v_cvt_pk_bf16_f32 v116, v116, v117
    v_cvt_pk_bf16_f32 v117, v118, v119
    v_exp_f32 v120, v120
    v_mfma_f32_32x32x16_bf16 v[100:115], v[156:159], v[12:15], v[36:51]
    v_exp_f32 v121, v121
    v_exp_f32 v122, v122
    v_exp_f32 v123, v123
    v_cvt_pk_bf16_f32 v118, v120, v121
    v_cvt_pk_bf16_f32 v119, v122, v123
    v_exp_f32 v124, v124
    v_exp_f32 v125, v125
    v_mfma_f32_32x32x16_bf16 v[52:67], v[180:183], v[116:119], v[52:67]
    v_exp_f32 v126, v126
    v_exp_f32 v127, v127
    v_cvt_pk_bf16_f32 v124, v124, v125
    v_cvt_pk_bf16_f32 v125, v126, v127
    v_mfma_f32_32x32x4_2b_bf16 v[84:115], v[168:169], v[16:17], v[84:115]
    v_exp_f32 v128, v128
    v_exp_f32 v129, v129
    v_exp_f32 v130, v130
    v_exp_f32 v131, v131
    v_cvt_pk_bf16_f32 v126, v128, v129
    v_cvt_pk_bf16_f32 v127, v130, v131
    v_exp_f32 v132, v132
    v_exp_f32 v133, v133
    v_exp_f32 v134, v134
    v_mfma_f32_32x32x16_bf16 v[52:67], v[184:187], v[124:127], v[52:67]
    v_exp_f32 v135, v135
    v_cvt_pk_bf16_f32 v132, v132, v133
    v_cvt_pk_bf16_f32 v133, v134, v135
    v_exp_f32 v136, v136
    v_exp_f32 v137, v137
    v_exp_f32 v138, v138
    v_exp_f32 v139, v139
    v_cvt_pk_bf16_f32 v134, v136, v137
    v_cvt_pk_bf16_f32 v135, v138, v139
    v_exp_f32 v140, v140
    v_exp_f32 v141, v141
    v_mfma_f32_32x32x16_bf16 v[68:83], v[180:183], v[132:135], v[68:83]
    v_exp_f32 v142, v142
    v_exp_f32 v143, v143
    v_cvt_pk_bf16_f32 v140, v140, v141
    v_cvt_pk_bf16_f32 v141, v142, v143
    v_exp_f32 v144, v144
    v_exp_f32 v145, v145
    v_exp_f32 v146, v146
    v_exp_f32 v147, v147
    v_cvt_pk_bf16_f32 v142, v144, v145
    v_cvt_pk_bf16_f32 v143, v146, v147
    v_mfma_f32_32x32x16_bf16 v[116:131], v[160:163], v[8:11], v[20:35]
    v_exp_f32 v84, v84
    v_exp_f32 v85, v85
    v_exp_f32 v86, v86
    v_mfma_f32_32x32x16_bf16 v[68:83], v[184:187], v[140:143], v[68:83]
    v_exp_f32 v87, v87
    v_cvt_pk_bf16_f32 v84, v84, v85
    v_cvt_pk_bf16_f32 v85, v86, v87
    v_exp_f32 v88, v88
    v_mfma_f32_32x32x16_bf16 v[132:147], v[160:163], v[12:15], v[36:51]
    v_exp_f32 v89, v89
    v_exp_f32 v90, v90
    v_exp_f32 v91, v91
    v_cvt_pk_bf16_f32 v86, v88, v89
    v_cvt_pk_bf16_f32 v87, v90, v91
    v_exp_f32 v92, v92
    v_exp_f32 v93, v93
    v_mfma_f32_32x32x16_bf16 v[52:67], v[188:191], v[84:87], v[52:67]
    v_exp_f32 v94, v94
    v_exp_f32 v95, v95
    v_cvt_pk_bf16_f32 v92, v92, v93
    v_cvt_pk_bf16_f32 v93, v94, v95
    v_mfma_f32_32x32x4_2b_bf16 v[116:147], v[170:171], v[16:17], v[116:147]
    ds_read2st64_b64 v[148:151], v204 offset0:8 offset1:9
    ds_read2st64_b64 v[152:155], v204 offset0:10 offset1:11
    ds_read2_b64 v[164:167], v206 offset0:128 offset1:160
    s_mov_b64 exec, s[50:51]
    ds_read_b128 v[196:199], v208 offset:3840
    ds_read_b128 v[200:203], v208 offset:4480
    ds_read_b128 v[172:175], v208 offset:5120
    ds_read_b128 v[176:179], v208 offset:5760
    s_mov_b64 exec, -1
    v_exp_f32 v96, v96
    v_exp_f32 v97, v97
    v_exp_f32 v98, v98
    v_exp_f32 v99, v99
    v_cvt_pk_bf16_f32 v94, v96, v97
    v_cvt_pk_bf16_f32 v95, v98, v99
    v_exp_f32 v100, v100
    v_exp_f32 v101, v101
    v_exp_f32 v102, v102
    v_mfma_f32_32x32x16_bf16 v[52:67], v[192:195], v[92:95], v[52:67]
    v_exp_f32 v103, v103
    v_cvt_pk_bf16_f32 v100, v100, v101
    v_cvt_pk_bf16_f32 v101, v102, v103
    v_exp_f32 v104, v104
    v_exp_f32 v105, v105
    v_exp_f32 v106, v106
    v_exp_f32 v107, v107
    v_cvt_pk_bf16_f32 v102, v104, v105
    v_cvt_pk_bf16_f32 v103, v106, v107
    v_exp_f32 v108, v108
    v_exp_f32 v109, v109
    v_mfma_f32_32x32x16_bf16 v[68:83], v[188:191], v[100:103], v[68:83]
    v_exp_f32 v110, v110
    v_exp_f32 v111, v111
    v_cvt_pk_bf16_f32 v108, v108, v109
    v_cvt_pk_bf16_f32 v109, v110, v111
    v_exp_f32 v112, v112
    v_exp_f32 v113, v113
    v_exp_f32 v114, v114
    v_exp_f32 v115, v115
    v_cvt_pk_bf16_f32 v110, v112, v113
    v_cvt_pk_bf16_f32 v111, v114, v115
    s_waitcnt lgkmcnt(0)
    v_mfma_f32_32x32x16_bf16 v[84:99], v[148:151], v[8:11], v[20:35]
    v_exp_f32 v116, v116
    v_exp_f32 v117, v117
    v_exp_f32 v118, v118
    v_mfma_f32_32x32x16_bf16 v[68:83], v[192:195], v[108:111], v[68:83]
    v_exp_f32 v119, v119
    v_cvt_pk_bf16_f32 v116, v116, v117
    v_cvt_pk_bf16_f32 v117, v118, v119
    v_exp_f32 v120, v120
    v_mfma_f32_32x32x16_bf16 v[100:115], v[148:151], v[12:15], v[36:51]
    v_exp_f32 v121, v121
    v_exp_f32 v122, v122
    v_exp_f32 v123, v123
    v_cvt_pk_bf16_f32 v118, v120, v121
    v_cvt_pk_bf16_f32 v119, v122, v123
    v_exp_f32 v124, v124
    v_exp_f32 v125, v125
    v_mfma_f32_32x32x16_bf16 v[52:67], v[196:199], v[116:119], v[52:67]
    v_exp_f32 v126, v126
    v_exp_f32 v127, v127
    v_cvt_pk_bf16_f32 v124, v124, v125
    v_cvt_pk_bf16_f32 v125, v126, v127
    v_mfma_f32_32x32x4_2b_bf16 v[84:115], v[164:165], v[16:17], v[84:115]
    v_exp_f32 v128, v128
    v_exp_f32 v129, v129
    v_exp_f32 v130, v130
    v_exp_f32 v131, v131
    v_cvt_pk_bf16_f32 v126, v128, v129
    v_cvt_pk_bf16_f32 v127, v130, v131
    v_exp_f32 v132, v132
    v_exp_f32 v133, v133
    v_exp_f32 v134, v134
    v_mfma_f32_32x32x16_bf16 v[52:67], v[200:203], v[124:127], v[52:67]
    v_exp_f32 v135, v135
    v_cvt_pk_bf16_f32 v132, v132, v133
    v_cvt_pk_bf16_f32 v133, v134, v135
    v_exp_f32 v136, v136
    v_exp_f32 v137, v137
    v_exp_f32 v138, v138
    v_exp_f32 v139, v139
    v_cvt_pk_bf16_f32 v134, v136, v137
    v_cvt_pk_bf16_f32 v135, v138, v139
    v_exp_f32 v140, v140
    v_exp_f32 v141, v141
    v_mfma_f32_32x32x16_bf16 v[68:83], v[196:199], v[132:135], v[68:83]
    v_exp_f32 v142, v142
    v_exp_f32 v143, v143
    v_cvt_pk_bf16_f32 v140, v140, v141
    v_cvt_pk_bf16_f32 v141, v142, v143
    v_exp_f32 v144, v144
    v_exp_f32 v145, v145
    v_exp_f32 v146, v146
    v_exp_f32 v147, v147
    v_cvt_pk_bf16_f32 v142, v144, v145
    v_cvt_pk_bf16_f32 v143, v146, v147
    v_mfma_f32_32x32x16_bf16 v[116:131], v[152:155], v[8:11], v[20:35]
    v_exp_f32 v84, v84
    v_exp_f32 v85, v85
    v_exp_f32 v86, v86
    v_mfma_f32_32x32x16_bf16 v[68:83], v[200:203], v[140:143], v[68:83]
    v_exp_f32 v87, v87
    v_cvt_pk_bf16_f32 v84, v84, v85
    v_cvt_pk_bf16_f32 v85, v86, v87
    v_exp_f32 v88, v88
    v_mfma_f32_32x32x16_bf16 v[132:147], v[152:155], v[12:15], v[36:51]
    v_exp_f32 v89, v89
    v_exp_f32 v90, v90
    v_exp_f32 v91, v91
    v_cvt_pk_bf16_f32 v86, v88, v89
    v_cvt_pk_bf16_f32 v87, v90, v91
    v_exp_f32 v92, v92
    v_exp_f32 v93, v93
    v_mfma_f32_32x32x16_bf16 v[52:67], v[172:175], v[84:87], v[52:67]
    v_exp_f32 v94, v94
    v_exp_f32 v95, v95
    v_cvt_pk_bf16_f32 v92, v92, v93
    v_cvt_pk_bf16_f32 v93, v94, v95
    v_mfma_f32_32x32x4_2b_bf16 v[116:147], v[166:167], v[16:17], v[116:147]
    s_waitcnt vmcnt(0)
    s_mov_b64 exec, 1
    ds_add_u32 v214, v215
    s_mov_b64 exec, -1
    s_add_u32 s54, s54, 0x400
    ds_read2st64_b64 v[156:159], v204 offset0:12 offset1:13
    ds_read2st64_b64 v[160:163], v204 offset0:14 offset1:15
    ds_read2_b64 v[168:171], v206 offset0:192 offset1:224
    s_mov_b64 exec, s[50:51]
    ds_read_b128 v[180:183], v208 offset:6400
    ds_read_b128 v[184:187], v208 offset:7040
    ds_read_b128 v[188:191], v208 offset:7680
    ds_read_b128 v[192:195], v208 offset:8320
    s_mov_b64 exec, -1
    v_exp_f32 v96, v96
    v_exp_f32 v97, v97
    v_exp_f32 v98, v98
    v_exp_f32 v99, v99
    v_cvt_pk_bf16_f32 v94, v96, v97
    v_cvt_pk_bf16_f32 v95, v98, v99
    v_exp_f32 v100, v100
    v_exp_f32 v101, v101
    v_exp_f32 v102, v102
    v_mfma_f32_32x32x16_bf16 v[52:67], v[176:179], v[92:95], v[52:67]
    v_exp_f32 v103, v103
    v_cvt_pk_bf16_f32 v100, v100, v101
    v_cvt_pk_bf16_f32 v101, v102, v103
    v_exp_f32 v104, v104
    v_exp_f32 v105, v105
    v_exp_f32 v106, v106
    v_exp_f32 v107, v107
    v_cvt_pk_bf16_f32 v102, v104, v105
    v_cvt_pk_bf16_f32 v103, v106, v107
    v_exp_f32 v108, v108
    v_exp_f32 v109, v109
    v_mfma_f32_32x32x16_bf16 v[68:83], v[172:175], v[100:103], v[68:83]
    v_exp_f32 v110, v110
    v_exp_f32 v111, v111
    v_cvt_pk_bf16_f32 v108, v108, v109
    v_cvt_pk_bf16_f32 v109, v110, v111
    v_exp_f32 v112, v112
    v_exp_f32 v113, v113
    v_exp_f32 v114, v114
    v_exp_f32 v115, v115
    v_cvt_pk_bf16_f32 v110, v112, v113
    v_cvt_pk_bf16_f32 v111, v114, v115
    s_waitcnt lgkmcnt(0)
    v_mfma_f32_32x32x16_bf16 v[84:99], v[156:159], v[8:11], v[20:35]
    v_exp_f32 v116, v116
    v_exp_f32 v117, v117
    v_exp_f32 v118, v118
    v_mfma_f32_32x32x16_bf16 v[68:83], v[176:179], v[108:111], v[68:83]
    v_exp_f32 v119, v119
    v_cvt_pk_bf16_f32 v116, v116, v117
    v_cvt_pk_bf16_f32 v117, v118, v119
    v_exp_f32 v120, v120
    v_mfma_f32_32x32x16_bf16 v[100:115], v[156:159], v[12:15], v[36:51]
    v_exp_f32 v121, v121
    v_exp_f32 v122, v122
    v_exp_f32 v123, v123
    v_cvt_pk_bf16_f32 v118, v120, v121
    v_cvt_pk_bf16_f32 v119, v122, v123
    v_exp_f32 v124, v124
    v_exp_f32 v125, v125
    v_mfma_f32_32x32x16_bf16 v[52:67], v[180:183], v[116:119], v[52:67]
    v_exp_f32 v126, v126
    v_exp_f32 v127, v127
    v_cvt_pk_bf16_f32 v124, v124, v125
    v_cvt_pk_bf16_f32 v125, v126, v127
    v_mfma_f32_32x32x4_2b_bf16 v[84:115], v[168:169], v[16:17], v[84:115]
    ds_read_b32 v6, v214
    v_exp_f32 v128, v128
    v_exp_f32 v129, v129
    v_exp_f32 v130, v130
    v_exp_f32 v131, v131
    v_cvt_pk_bf16_f32 v126, v128, v129
    v_cvt_pk_bf16_f32 v127, v130, v131
    v_exp_f32 v132, v132
    v_exp_f32 v133, v133
    v_exp_f32 v134, v134
    v_mfma_f32_32x32x16_bf16 v[52:67], v[184:187], v[124:127], v[52:67]
    v_exp_f32 v135, v135
    v_cvt_pk_bf16_f32 v132, v132, v133
    v_cvt_pk_bf16_f32 v133, v134, v135
    v_exp_f32 v136, v136
    v_exp_f32 v137, v137
    v_exp_f32 v138, v138
    v_exp_f32 v139, v139
    v_cvt_pk_bf16_f32 v134, v136, v137
    v_cvt_pk_bf16_f32 v135, v138, v139
    v_exp_f32 v140, v140
    v_exp_f32 v141, v141
    v_mfma_f32_32x32x16_bf16 v[68:83], v[180:183], v[132:135], v[68:83]
    v_exp_f32 v142, v142
    v_exp_f32 v143, v143
    v_cvt_pk_bf16_f32 v140, v140, v141
    v_cvt_pk_bf16_f32 v141, v142, v143
    v_exp_f32 v144, v144
    v_exp_f32 v145, v145
    s_waitcnt lgkmcnt(0)
    v_readfirstlane_b32 s70, v6
    v_exp_f32 v146, v146
    v_exp_f32 v147, v147
    v_cvt_pk_bf16_f32 v142, v144, v145
    v_cvt_pk_bf16_f32 v143, v146, v147
    v_mfma_f32_32x32x16_bf16 v[116:131], v[160:163], v[8:11], v[20:35]
    v_exp_f32 v84, v84
    v_exp_f32 v85, v85
    v_exp_f32 v86, v86
    v_mfma_f32_32x32x16_bf16 v[68:83], v[184:187], v[140:143], v[68:83]
    v_exp_f32 v87, v87
    v_cvt_pk_bf16_f32 v84, v84, v85
    v_cvt_pk_bf16_f32 v85, v86, v87
    v_exp_f32 v88, v88
    v_mfma_f32_32x32x16_bf16 v[132:147], v[160:163], v[12:15], v[36:51]
    v_exp_f32 v89, v89
    v_exp_f32 v90, v90
    v_exp_f32 v91, v91
    v_cvt_pk_bf16_f32 v86, v88, v89
    v_cvt_pk_bf16_f32 v87, v90, v91
    v_exp_f32 v92, v92
    v_exp_f32 v93, v93
    v_mfma_f32_32x32x16_bf16 v[52:67], v[188:191], v[84:87], v[52:67]
    v_exp_f32 v94, v94
    v_exp_f32 v95, v95
    v_cvt_pk_bf16_f32 v92, v92, v93
    v_cvt_pk_bf16_f32 v93, v94, v95
    v_mfma_f32_32x32x4_2b_bf16 v[116:147], v[170:171], v[16:17], v[116:147]
    s_cmp_ge_u32 s70, s54
    s_cbranch_scc0 L_c39
L_cd40:
    s_or_b32 s70, s55, s58
    s_cbranch_scc0 L_at_mark
L_at_marked:
    s_add_u32 s48, s48, 20480
    ds_read2st64_b64 v[148:151], v205 offset0:0 offset1:1
    ds_read2st64_b64 v[152:155], v205 offset0:2 offset1:3
    ds_read2_b64 v[164:167], v207 offset0:0 offset1:32
    s_mov_b64 exec, s[50:51]
    ds_read_b128 v[196:199], v208 offset:8960
    ds_read_b128 v[200:203], v208 offset:9600
    ds_read_b128 v[172:175], v209 offset:0
    ds_read_b128 v[176:179], v209 offset:640
    s_mov_b64 exec, -1
    s_add_u32 s70, s49, 98304
    s_mov_b32 s53, s49
    v_add_u32 v204, s70, v211
    v_add_u32 v206, s70, v212
    v_add_u32 v208, s70, v213
    s_cmp_eq_u32 s49, 0
    s_cselect_b32 s49, 61440, s49
    s_sub_u32 s49, s49, 20480
    v_exp_f32 v96, v96
    v_exp_f32 v97, v97
    v_exp_f32 v98, v98
    v_exp_f32 v99, v99
    v_cvt_pk_bf16_f32 v94, v96, v97
    v_cvt_pk_bf16_f32 v95, v98, v99
    v_exp_f32 v100, v100
    v_exp_f32 v101, v101
    v_exp_f32 v102, v102
    v_mfma_f32_32x32x16_bf16 v[52:67], v[192:195], v[92:95], v[52:67]
    v_exp_f32 v103, v103
    s_add_u32 m0, s44, s53
    s_add_u32 s47, s48, 4096
    buffer_load_dwordx4 v210, s[12:15], s48 offen offset:0 sc1 lds
    v_cvt_pk_bf16_f32 v100, v100, v101
    v_cvt_pk_bf16_f32 v101, v102, v103
    v_exp_f32 v104, v104
    v_exp_f32 v105, v105
    v_exp_f32 v106, v106
    v_exp_f32 v107, v107
    v_cvt_pk_bf16_f32 v102, v104, v105
    v_cvt_pk_bf16_f32 v103, v106, v107
    v_exp_f32 v108, v108
    v_exp_f32 v109, v109
    v_mfma_f32_32x32x16_bf16 v[68:83], v[188:191], v[100:103], v[68:83]
    v_exp_f32 v110, v110
    v_exp_f32 v111, v111
    buffer_load_dwordx4 v210, s[12:15], s48 offen offset:1024 sc1 lds
    v_cvt_pk_bf16_f32 v108, v108, v109
    v_cvt_pk_bf16_f32 v109, v110, v111
    v_exp_f32 v112, v112
    v_exp_f32 v113, v113
    v_exp_f32 v114, v114
    v_exp_f32 v115, v115
    v_cvt_pk_bf16_f32 v110, v112, v113
    v_cvt_pk_bf16_f32 v111, v114, v115
    s_waitcnt lgkmcnt(0)
    v_mfma_f32_32x32x16_bf16 v[84:99], v[148:151], v[8:11], v[20:35]
    v_exp_f32 v116, v116
    v_exp_f32 v117, v117
    v_exp_f32 v118, v118
    v_mfma_f32_32x32x16_bf16 v[68:83], v[192:195], v[108:111], v[68:83]
    v_exp_f32 v119, v119
    buffer_load_dwordx4 v210, s[12:15], s48 offen offset:2048 sc1 lds
    v_cvt_pk_bf16_f32 v116, v116, v117
    v_cvt_pk_bf16_f32 v117, v118, v119
    v_exp_f32 v120, v120
    v_mfma_f32_32x32x16_bf16 v[100:115], v[148:151], v[12:15], v[36:51]
    v_exp_f32 v121, v121
    v_exp_f32 v122, v122
    v_exp_f32 v123, v123
    v_cvt_pk_bf16_f32 v118, v120, v121
    v_cvt_pk_bf16_f32 v119, v122, v123
    v_exp_f32 v124, v124
    v_exp_f32 v125, v125
    v_mfma_f32_32x32x16_bf16 v[52:67], v[196:199], v[116:119], v[52:67]
    v_exp_f32 v126, v126
    v_exp_f32 v127, v127
    buffer_load_dwordx4 v210, s[12:15], s48 offen offset:3072 sc1 lds
    v_cvt_pk_bf16_f32 v124, v124, v125
    v_cvt_pk_bf16_f32 v125, v126, v127
    v_mfma_f32_32x32x4_2b_bf16 v[84:115], v[164:165], v[16:17], v[84:115]
    v_exp_f32 v128, v128
    v_exp_f32 v129, v129
    v_exp_f32 v130, v130
    v_exp_f32 v131, v131
    v_cvt_pk_bf16_f32 v126, v128, v129
    v_cvt_pk_bf16_f32 v127, v130, v131
    v_exp_f32 v132, v132
    v_exp_f32 v133, v133
    v_exp_f32 v134, v134
    v_mfma_f32_32x32x16_bf16 v[52:67], v[200:203], v[124:127], v[52:67]
    v_exp_f32 v135, v135
    s_add_u32 m0, m0, 4096
    s_nop 0
    buffer_load_dwordx4 v210, s[12:15], s47 offen sc1 lds
    v_cvt_pk_bf16_f32 v132, v132, v133
    v_cvt_pk_bf16_f32 v133, v134, v135
    v_exp_f32 v136, v136
    v_exp_f32 v137, v137
    v_exp_f32 v138, v138
    v_exp_f32 v139, v139
    v_cvt_pk_bf16_f32 v134, v136, v137
    v_cvt_pk_bf16_f32 v135, v138, v139
    v_exp_f32 v140, v140
    v_exp_f32 v141, v141
    v_mfma_f32_32x32x16_bf16 v[68:83], v[196:199], v[132:135], v[68:83]
    v_exp_f32 v142, v142
    v_exp_f32 v143, v143
    v_cvt_pk_bf16_f32 v140, v140, v141
    v_cvt_pk_bf16_f32 v141, v142, v143
    v_exp_f32 v144, v144
    v_exp_f32 v145, v145
    v_exp_f32 v146, v146
    v_exp_f32 v147, v147
    v_cvt_pk_bf16_f32 v142, v144, v145
    v_cvt_pk_bf16_f32 v143, v146, v147
    v_mfma_f32_32x32x16_bf16 v[116:131], v[152:155], v[8:11], v[20:35]
    v_exp_f32 v84, v84
    v_exp_f32 v85, v85
    v_exp_f32 v86, v86
    v_mfma_f32_32x32x16_bf16 v[68:83], v[200:203], v[140:143], v[68:83]
    v_exp_f32 v87, v87
    v_cvt_pk_bf16_f32 v84, v84, v85
    v_cvt_pk_bf16_f32 v85, v86, v87
    v_exp_f32 v88, v88
    v_mfma_f32_32x32x16_bf16 v[132:147], v[152:155], v[12:15], v[36:51]
    v_exp_f32 v89, v89
    v_exp_f32 v90, v90
    v_exp_f32 v91, v91
    v_cvt_pk_bf16_f32 v86, v88, v89
    v_cvt_pk_bf16_f32 v87, v90, v91
    v_exp_f32 v92, v92
    v_exp_f32 v93, v93
    v_mfma_f32_32x32x16_bf16 v[52:67], v[172:175], v[84:87], v[52:67]
    v_exp_f32 v94, v94
    v_exp_f32 v95, v95
    v_cvt_pk_bf16_f32 v92, v92, v93
    v_cvt_pk_bf16_f32 v93, v94, v95
    v_mfma_f32_32x32x4_2b_bf16 v[116:147], v[166:167], v[16:17], v[116:147]
    ds_read2st64_b64 v[156:159], v205 offset0:4 offset1:5
    ds_read2st64_b64 v[160:163], v205 offset0:6 offset1:7
    ds_read2_b64 v[168:171], v207 offset0:64 offset1:96
    s_mov_b64 exec, s[50:51]
    ds_read_b128 v[180:183], v209 offset:1280
    ds_read_b128 v[184:187], v209 offset:1920
    ds_read_b128 v[188:191], v209 offset:2560
    ds_read_b128 v[192:195], v209 offset:3200
    s_mov_b64 exec, -1
    v_exp_f32 v96, v96
    v_exp_f32 v97, v97
    v_exp_f32 v98, v98
    v_exp_f32 v99, v99
    v_cvt_pk_bf16_f32 v94, v96, v97
    v_cvt_pk_bf16_f32 v95, v98, v99
    v_exp_f32 v100, v100
    v_exp_f32 v101, v101
    v_exp_f32 v102, v102
    v_mfma_f32_32x32x16_bf16 v[52:67], v[176:179], v[92:95], v[52:67]
    v_exp_f32 v103, v103
    v_cvt_pk_bf16_f32 v100, v100, v101
    v_cvt_pk_bf16_f32 v101, v102, v103
    v_exp_f32 v104, v104
    v_exp_f32 v105, v105
    v_exp_f32 v106, v106
    v_exp_f32 v107, v107
    v_cvt_pk_bf16_f32 v102, v104, v105
    v_cvt_pk_bf16_f32 v103, v106, v107
    v_exp_f32 v108, v108
    v_exp_f32 v109, v109
    v_mfma_f32_32x32x16_bf16 v[68:83], v[172:175], v[100:103], v[68:83]
    v_exp_f32 v110, v110
    v_exp_f32 v111, v111
    v_cvt_pk_bf16_f32 v108, v108, v109
    v_cvt_pk_bf16_f32 v109, v110, v111
    v_exp_f32 v112, v112
    v_exp_f32 v113, v113
    v_exp_f32 v114, v114
    v_exp_f32 v115, v115
    v_cvt_pk_bf16_f32 v110, v112, v113
    v_cvt_pk_bf16_f32 v111, v114, v115
    s_waitcnt lgkmcnt(0)
    v_mfma_f32_32x32x16_bf16 v[84:99], v[156:159], v[8:11], v[20:35]
    v_exp_f32 v116, v116
    v_exp_f32 v117, v117
    v_exp_f32 v118, v118
    v_mfma_f32_32x32x16_bf16 v[68:83], v[176:179], v[108:111], v[68:83]
    v_exp_f32 v119, v119
    v_cvt_pk_bf16_f32 v116, v116, v117
    v_cvt_pk_bf16_f32 v117, v118, v119
    v_exp_f32 v120, v120
    v_mfma_f32_32x32x16_bf16 v[100:115], v[156:159], v[12:15], v[36:51]
    v_exp_f32 v121, v121
    v_exp_f32 v122, v122
    v_exp_f32 v123, v123
    v_cvt_pk_bf16_f32 v118, v120, v121
    v_cvt_pk_bf16_f32 v119, v122, v123
    v_exp_f32 v124, v124
    v_exp_f32 v125, v125
    v_mfma_f32_32x32x16_bf16 v[52:67], v[180:183], v[116:119], v[52:67]
    v_exp_f32 v126, v126
    v_exp_f32 v127, v127
    v_cvt_pk_bf16_f32 v124, v124, v125
    v_cvt_pk_bf16_f32 v125, v126, v127
    v_mfma_f32_32x32x4_2b_bf16 v[84:115], v[168:169], v[16:17], v[84:115]
    v_exp_f32 v128, v128
    v_exp_f32 v129, v129
    v_exp_f32 v130, v130
    v_exp_f32 v131, v131
    v_cvt_pk_bf16_f32 v126, v128, v129
    v_cvt_pk_bf16_f32 v127, v130, v131
    v_exp_f32 v132, v132
    v_exp_f32 v133, v133
    v_exp_f32 v134, v134
    v_mfma_f32_32x32x16_bf16 v[52:67], v[184:187], v[124:127], v[52:67]
    v_exp_f32 v135, v135
    v_cvt_pk_bf16_f32 v132, v132, v133
    v_cvt_pk_bf16_f32 v133, v134, v135
    v_exp_f32 v136, v136
    v_exp_f32 v137, v137
    v_exp_f32 v138, v138
    v_exp_f32 v139, v139
    v_cvt_pk_bf16_f32 v134, v136, v137
    v_cvt_pk_bf16_f32 v135, v138, v139
    v_exp_f32 v140, v140
    v_exp_f32 v141, v141
    v_mfma_f32_32x32x16_bf16 v[68:83], v[180:183], v[132:135], v[68:83]
    v_exp_f32 v142, v142
    v_exp_f32 v143, v143
    v_cvt_pk_bf16_f32 v140, v140, v141
    v_cvt_pk_bf16_f32 v141, v142, v143
    v_exp_f32 v144, v144
    v_exp_f32 v145, v145
    v_exp_f32 v146, v146
    v_exp_f32 v147, v147
    v_cvt_pk_bf16_f32 v142, v144, v145
    v_cvt_pk_bf16_f32 v143, v146, v147
    v_mfma_f32_32x32x16_bf16 v[116:131], v[160:163], v[8:11], v[20:35]
    v_exp_f32 v84, v84
    v_exp_f32 v85, v85
    v_exp_f32 v86, v86
    v_mfma_f32_32x32x16_bf16 v[68:83], v[184:187], v[140:143], v[68:83]
    v_exp_f32 v87, v87
    v_cvt_pk_bf16_f32 v84, v84, v85
    v_cvt_pk_bf16_f32 v85, v86, v87
    v_exp_f32 v88, v88
    v_mfma_f32_32x32x16_bf16 v[132:147], v[160:163], v[12:15], v[36:51]
    v_exp_f32 v89, v89
    v_exp_f32 v90, v90
    v_exp_f32 v91, v91
    v_cvt_pk_bf16_f32 v86, v88, v89
    v_cvt_pk_bf16_f32 v87, v90, v91
    v_exp_f32 v92, v92
    v_exp_f32 v93, v93
    v_mfma_f32_32x32x16_bf16 v[52:67], v[188:191], v[84:87], v[52:67]
    v_exp_f32 v94, v94
    v_exp_f32 v95, v95
    v_cvt_pk_bf16_f32 v92, v92, v93
    v_cvt_pk_bf16_f32 v93, v94, v95
    v_mfma_f32_32x32x4_2b_bf16 v[116:147], v[170:171], v[16:17], v[116:147]
    ds_read2st64_b64 v[148:151], v205 offset0:8 offset1:9
    ds_read2st64_b64 v[152:155], v205 offset0:10 offset1:11
    ds_read2_b64 v[164:167], v207 offset0:128 offset1:160
    s_mov_b64 exec, s[50:51]
    ds_read_b128 v[196:199], v209 offset:3840
    ds_read_b128 v[200:203], v209 offset:4480
    ds_read_b128 v[172:175], v209 offset:5120
    ds_read_b128 v[176:179], v209 offset:5760
    s_mov_b64 exec, -1
    v_exp_f32 v96, v96
    v_exp_f32 v97, v97
    v_exp_f32 v98, v98
    v_exp_f32 v99, v99
    v_cvt_pk_bf16_f32 v94, v96, v97
    v_cvt_pk_bf16_f32 v95, v98, v99
    v_exp_f32 v100, v100
    v_exp_f32 v101, v101
    v_exp_f32 v102, v102
    v_mfma_f32_32x32x16_bf16 v[52:67], v[192:195], v[92:95], v[52:67]
    v_exp_f32 v103, v103
    v_cvt_pk_bf16_f32 v100, v100, v101
    v_cvt_pk_bf16_f32 v101, v102, v103
    v_exp_f32 v104, v104
    v_exp_f32 v105, v105
    v_exp_f32 v106, v106
    v_exp_f32 v107, v107
    v_cvt_pk_bf16_f32 v102, v104, v105
    v_cvt_pk_bf16_f32 v103, v106, v107
    v_exp_f32 v108, v108
    v_exp_f32 v109, v109
    v_mfma_f32_32x32x16_bf16 v[68:83], v[188:191], v[100:103], v[68:83]
    v_exp_f32 v110, v110
    v_exp_f32 v111, v111
    v_cvt_pk_bf16_f32 v108, v108, v109
    v_cvt_pk_bf16_f32 v109, v110, v111
    v_exp_f32 v112, v112
    v_exp_f32 v113, v113
    v_exp_f32 v114, v114
    v_exp_f32 v115, v115
    v_cvt_pk_bf16_f32 v110, v112, v113
    v_cvt_pk_bf16_f32 v111, v114, v115
    s_waitcnt lgkmcnt(0)
    v_mfma_f32_32x32x16_bf16 v[84:99], v[148:151], v[8:11], v[20:35]
    v_exp_f32 v116, v116
    v_exp_f32 v117, v117
    v_exp_f32 v118, v118
    v_mfma_f32_32x32x16_bf16 v[68:83], v[192:195], v[108:111], v[68:83]
    v_exp_f32 v119, v119
    v_cvt_pk_bf16_f32 v116, v116, v117
    v_cvt_pk_bf16_f32 v117, v118, v119
    v_exp_f32 v120, v120
    v_mfma_f32_32x32x16_bf16 v[100:115], v[148:151], v[12:15], v[36:51]
    v_exp_f32 v121, v121
    v_exp_f32 v122, v122
    v_exp_f32 v123, v123
    v_cvt_pk_bf16_f32 v118, v120, v121
    v_cvt_pk_bf16_f32 v119, v122, v123
    v_exp_f32 v124, v124
    v_exp_f32 v125, v125
    v_mfma_f32_32x32x16_bf16 v[52:67], v[196:199], v[116:119], v[52:67]
    v_exp_f32 v126, v126
    v_exp_f32 v127, v127
    v_cvt_pk_bf16_f32 v124, v124, v125
    v_cvt_pk_bf16_f32 v125, v126, v127
    v_mfma_f32_32x32x4_2b_bf16 v[84:115], v[164:165], v[16:17], v[84:115]
    v_exp_f32 v128, v128
    v_exp_f32 v129, v129
    v_exp_f32 v130, v130
    v_exp_f32 v131, v131
    v_cvt_pk_bf16_f32 v126, v128, v129
    v_cvt_pk_bf16_f32 v127, v130, v131
    v_exp_f32 v132, v132
    v_exp_f32 v133, v133
    v_exp_f32 v134, v134
    v_mfma_f32_32x32x16_bf16 v[52:67], v[200:203], v[124:127], v[52:67]
    v_exp_f32 v135, v135
    v_cvt_pk_bf16_f32 v132, v132, v133
    v_cvt_pk_bf16_f32 v133, v134, v135
    v_exp_f32 v136, v136
    v_exp_f32 v137, v137
    v_exp_f32 v138, v138
    v_exp_f32 v139, v139
    v_cvt_pk_bf16_f32 v134, v136, v137
    v_cvt_pk_bf16_f32 v135, v138, v139
    v_exp_f32 v140, v140
    v_exp_f32 v141, v141
    v_mfma_f32_32x32x16_bf16 v[68:83], v[196:199], v[132:135], v[68:83]
    v_exp_f32 v142, v142
    v_exp_f32 v143, v143
    v_cvt_pk_bf16_f32 v140, v140, v141
    v_cvt_pk_bf16_f32 v141, v142, v143
    v_exp_f32 v144, v144
    v_exp_f32 v145, v145
    v_exp_f32 v146, v146
    v_exp_f32 v147, v147
    v_cvt_pk_bf16_f32 v142, v144, v145
    v_cvt_pk_bf16_f32 v143, v146, v147
    v_mfma_f32_32x32x16_bf16 v[116:131], v[152:155], v[8:11], v[20:35]
    v_exp_f32 v84, v84
    v_exp_f32 v85, v85
    v_exp_f32 v86, v86
    v_mfma_f32_32x32x16_bf16 v[68:83], v[200:203], v[140:143], v[68:83]
    v_exp_f32 v87, v87
    v_cvt_pk_bf16_f32 v84, v84, v85
    v_cvt_pk_bf16_f32 v85, v86, v87
    v_exp_f32 v88, v88
    v_mfma_f32_32x32x16_bf16 v[132:147], v[152:155], v[12:15], v[36:51]
    v_exp_f32 v89, v89
    v_exp_f32 v90, v90
    v_exp_f32 v91, v91
    v_cvt_pk_bf16_f32 v86, v88, v89
    v_cvt_pk_bf16_f32 v87, v90, v91
    v_exp_f32 v92, v92
    v_exp_f32 v93, v93
    v_mfma_f32_32x32x16_bf16 v[52:67], v[172:175], v[84:87], v[52:67]
    v_exp_f32 v94, v94
    v_exp_f32 v95, v95
    v_cvt_pk_bf16_f32 v92, v92, v93
    v_cvt_pk_bf16_f32 v93, v94, v95
    v_mfma_f32_32x32x4_2b_bf16 v[116:147], v[166:167], v[16:17], v[116:147]
    s_waitcnt vmcnt(0)
    s_mov_b64 exec, 1
    ds_add_u32 v214, v215
    s_mov_b64 exec, -1
    s_add_u32 s54, s54, 0x400
    ds_read2st64_b64 v[156:159], v205 offset0:12 offset1:13
    ds_read2st64_b64 v[160:163], v205 offset0:14 offset1:15
    ds_read2_b64 v[168:171], v207 offset0:192 offset1:224
    s_mov_b64 exec, s[50:51]
    ds_read_b128 v[180:183], v209 offset:6400
    ds_read_b128 v[184:187], v209 offset:7040
    ds_read_b128 v[188:191], v209 offset:7680
    ds_read_b128 v[192:195], v209 offset:8320
    s_mov_b64 exec, -1
    v_exp_f32 v96, v96
    v_exp_f32 v97, v97
    v_exp_f32 v98, v98
    v_exp_f32 v99, v99
    v_cvt_pk_bf16_f32 v94, v96, v97
    v_cvt_pk_bf16_f32 v95, v98, v99
    v_exp_f32 v100, v100
    v_exp_f32 v101, v101
    v_exp_f32 v102, v102
    v_mfma_f32_32x32x16_bf16 v[52:67], v[176:179], v[92:95], v[52:67]
    v_exp_f32 v103, v103
    v_cvt_pk_bf16_f32 v100, v100, v101
    v_cvt_pk_bf16_f32 v101, v102, v103
    v_exp_f32 v104, v104
    v_exp_f32 v105, v105
    v_exp_f32 v106, v106
    v_exp_f32 v107, v107
    v_cvt_pk_bf16_f32 v102, v104, v105
    v_cvt_pk_bf16_f32 v103, v106, v107
    v_exp_f32 v108, v108
    v_exp_f32 v109, v109
    v_mfma_f32_32x32x16_bf16 v[68:83], v[172:175], v[100:103], v[68:83]
    v_exp_f32 v110, v110
    v_exp_f32 v111, v111
    v_cvt_pk_bf16_f32 v108, v108, v109
    v_cvt_pk_bf16_f32 v109, v110, v111
    v_exp_f32 v112, v112
    v_exp_f32 v113, v113
    v_exp_f32 v114, v114
    v_exp_f32 v115, v115
    v_cvt_pk_bf16_f32 v110, v112, v113
    v_cvt_pk_bf16_f32 v111, v114, v115
    s_waitcnt lgkmcnt(0)
    v_mfma_f32_32x32x16_bf16 v[84:99], v[156:159], v[8:11], v[20:35]
    v_exp_f32 v116, v116
    v_exp_f32 v117, v117
    v_exp_f32 v118, v118
    v_mfma_f32_32x32x16_bf16 v[68:83], v[176:179], v[108:111], v[68:83]
    v_exp_f32 v119, v119
    v_cvt_pk_bf16_f32 v116, v116, v117
    v_cvt_pk_bf16_f32 v117, v118, v119
    v_exp_f32 v120, v120
    v_mfma_f32_32x32x16_bf16 v[100:115], v[156:159], v[12:15], v[36:51]
    v_exp_f32 v121, v121
    v_exp_f32 v122, v122
    v_exp_f32 v123, v123
    v_cvt_pk_bf16_f32 v118, v120, v121
    v_cvt_pk_bf16_f32 v119, v122, v123
    v_exp_f32 v124, v124
    v_exp_f32 v125, v125
    v_mfma_f32_32x32x16_bf16 v[52:67], v[180:183], v[116:119], v[52:67]
    v_exp_f32 v126, v126
    v_exp_f32 v127, v127
    v_cvt_pk_bf16_f32 v124, v124, v125
    v_cvt_pk_bf16_f32 v125, v126, v127
    v_mfma_f32_32x32x4_2b_bf16 v[84:115], v[168:169], v[16:17], v[84:115]
    ds_read_b32 v6, v214
    v_exp_f32 v128, v128
    v_exp_f32 v129, v129
    v_exp_f32 v130, v130
    v_exp_f32 v131, v131
    v_cvt_pk_bf16_f32 v126, v128, v129
    v_cvt_pk_bf16_f32 v127, v130, v131
    v_exp_f32 v132, v132
    v_exp_f32 v133, v133
    v_exp_f32 v134, v134
    v_mfma_f32_32x32x16_bf16 v[52:67], v[184:187], v[124:127], v[52:67]
    v_exp_f32 v135, v135
    v_cvt_pk_bf16_f32 v132, v132, v133
    v_cvt_pk_bf16_f32 v133, v134, v135
    v_exp_f32 v136, v136
    v_exp_f32 v137, v137
    v_exp_f32 v138, v138
    v_exp_f32 v139, v139
    v_cvt_pk_bf16_f32 v134, v136, v137
    v_cvt_pk_bf16_f32 v135, v138, v139
    v_exp_f32 v140, v140
    v_exp_f32 v141, v141
    v_mfma_f32_32x32x16_bf16 v[68:83], v[180:183], v[132:135], v[68:83]
    v_exp_f32 v142, v142
    v_exp_f32 v143, v143
    v_cvt_pk_bf16_f32 v140, v140, v141
    v_cvt_pk_bf16_f32 v141, v142, v143
    v_exp_f32 v144, v144
    v_exp_f32 v145, v145
    s_waitcnt lgkmcnt(0)
    v_readfirstlane_b32 s70, v6
    v_exp_f32 v146, v146
    v_exp_f32 v147, v147
    v_cvt_pk_bf16_f32 v142, v144, v145
    v_cvt_pk_bf16_f32 v143, v146, v147
    v_mfma_f32_32x32x16_bf16 v[116:131], v[160:163], v[8:11], v[20:35]
    v_exp_f32 v84, v84
    v_exp_f32 v85, v85
    v_exp_f32 v86, v86
    v_mfma_f32_32x32x16_bf16 v[68:83], v[184:187], v[140:143], v[68:83]
    v_exp_f32 v87, v87
    v_cvt_pk_bf16_f32 v84, v84, v85
    v_cvt_pk_bf16_f32 v85, v86, v87
    v_exp_f32 v88, v88
    v_mfma_f32_32x32x16_bf16 v[132:147], v[160:163], v[12:15], v[36:51]
    v_exp_f32 v89, v89
    v_exp_f32 v90, v90
    v_exp_f32 v91, v91
    v_cvt_pk_bf16_f32 v86, v88, v89
    v_cvt_pk_bf16_f32 v87, v90, v91
    v_exp_f32 v92, v92
    v_exp_f32 v93, v93
    v_mfma_f32_32x32x16_bf16 v[52:67], v[188:191], v[84:87], v[52:67]
    v_exp_f32 v94, v94
    v_exp_f32 v95, v95
    v_cvt_pk_bf16_f32 v92, v92, v93
    v_cvt_pk_bf16_f32 v93, v94, v95
    v_mfma_f32_32x32x4_2b_bf16 v[116:147], v[170:171], v[16:17], v[116:147]
    s_cmp_ge_u32 s70, s54
    s_cbranch_scc0 L_c41
L_cd42:
    s_add_u32 s48, s48, 20480
    ds_read2st64_b64 v[148:151], v204 offset0:0 offset1:1
    ds_read2st64_b64 v[152:155], v204 offset0:2 offset1:3
    ds_read2_b64 v[164:167], v206 offset0:0 offset1:32
    s_mov_b64 exec, s[50:51]
    ds_read_b128 v[196:199], v209 offset:8960
    ds_read_b128 v[200:203], v209 offset:9600
    ds_read_b128 v[172:175], v208 offset:0
    ds_read_b128 v[176:179], v208 offset:640
    s_mov_b64 exec, -1
    s_add_u32 s70, s49, 98304
    s_mov_b32 s53, s49
    v_add_u32 v205, s70, v211
    v_add_u32 v207, s70, v212
    v_add_u32 v209, s70, v213
    s_cmp_eq_u32 s49, 0
    s_cselect_b32 s49, 61440, s49
    s_sub_u32 s49, s49, 20480
    v_exp_f32 v96, v96
    v_exp_f32 v97, v97
    v_exp_f32 v98, v98
    v_exp_f32 v99, v99
    v_cvt_pk_bf16_f32 v94, v96, v97
    v_cvt_pk_bf16_f32 v95, v98, v99
    v_exp_f32 v100, v100
    v_exp_f32 v101, v101
    v_exp_f32 v102, v102
    v_mfma_f32_32x32x16_bf16 v[52:67], v[192:195], v[92:95], v[52:67]
    v_exp_f32 v103, v103
    s_add_u32 m0, s44, s53
    s_add_u32 s47, s48, 4096
    buffer_load_dwordx4 v210, s[12:15], s48 offen offset:0 sc1 lds
    v_cvt_pk_bf16_f32 v100, v100, v101
    v_cvt_pk_bf16_f32 v101, v102, v103
    v_exp_f32 v104, v104
    v_exp_f32 v105, v105
    v_exp_f32 v106, v106
    v_exp_f32 v107, v107
    v_cvt_pk_bf16_f32 v102, v104, v105
    v_cvt_pk_bf16_f32 v103, v106, v107
    v_exp_f32 v108, v108
    v_exp_f32 v109, v109
    v_mfma_f32_32x32x16_bf16 v[68:83], v[188:191], v[100:103], v[68:83]
    v_exp_f32 v110, v110
    v_exp_f32 v111, v111
    buffer_load_dwordx4 v210, s[12:15], s48 offen offset:1024 sc1 lds
    v_cvt_pk_bf16_f32 v108, v108, v109
    v_cvt_pk_bf16_f32 v109, v110, v111
    v_exp_f32 v112, v112
    v_exp_f32 v113, v113
    v_exp_f32 v114, v114
    v_exp_f32 v115, v115
    v_cvt_pk_bf16_f32 v110, v112, v113
    v_cvt_pk_bf16_f32 v111, v114, v115
    s_waitcnt lgkmcnt(0)
    v_mfma_f32_32x32x16_bf16 v[84:99], v[148:151], v[8:11], v[20:35]
    v_exp_f32 v116, v116
    v_exp_f32 v117, v117
    v_exp_f32 v118, v118
    v_mfma_f32_32x32x16_bf16 v[68:83], v[192:195], v[108:111], v[68:83]
    v_exp_f32 v119, v119
    buffer_load_dwordx4 v210, s[12:15], s48 offen offset:2048 sc1 lds
    v_cvt_pk_bf16_f32 v116, v116, v117
    v_cvt_pk_bf16_f32 v117, v118, v119
    v_exp_f32 v120, v120
    v_mfma_f32_32x32x16_bf16 v[100:115], v[148:151], v[12:15], v[36:51]
    v_exp_f32 v121, v121
    v_exp_f32 v122, v122
    v_exp_f32 v123, v123
    v_cvt_pk_bf16_f32 v118, v120, v121
    v_cvt_pk_bf16_f32 v119, v122, v123
    v_exp_f32 v124, v124
    v_exp_f32 v125, v125
    v_mfma_f32_32x32x16_bf16 v[52:67], v[196:199], v[116:119], v[52:67]
    v_exp_f32 v126, v126
    v_exp_f32 v127, v127
    buffer_load_dwordx4 v210, s[12:15], s48 offen offset:3072 sc1 lds
    v_cvt_pk_bf16_f32 v124, v124, v125
    v_cvt_pk_bf16_f32 v125, v126, v127
    v_mfma_f32_32x32x4_2b_bf16 v[84:115], v[164:165], v[16:17], v[84:115]
    v_exp_f32 v128, v128
    v_exp_f32 v129, v129
    v_exp_f32 v130, v130
    v_exp_f32 v131, v131
    v_cvt_pk_bf16_f32 v126, v128, v129
    v_cvt_pk_bf16_f32 v127, v130, v131
    v_exp_f32 v132, v132
    v_exp_f32 v133, v133
    v_exp_f32 v134, v134
    v_mfma_f32_32x32x16_bf16 v[52:67], v[200:203], v[124:127], v[52:67]
    v_exp_f32 v135, v135
    s_add_u32 m0, m0, 4096
    s_nop 0
    buffer_load_dwordx4 v210, s[12:15], s47 offen sc1 lds
    v_cvt_pk_bf16_f32 v132, v132, v133
    v_cvt_pk_bf16_f32 v133, v134, v135
    v_exp_f32 v136, v136
    v_exp_f32 v137, v137
    v_exp_f32 v138, v138
    v_exp_f32 v139, v139
    v_cvt_pk_bf16_f32 v134, v136, v137
    v_cvt_pk_bf16_f32 v135, v138, v139
    v_exp_f32 v140, v140
    v_exp_f32 v141, v141
    v_mfma_f32_32x32x16_bf16 v[68:83], v[196:199], v[132:135], v[68:83]
    v_exp_f32 v142, v142
    v_exp_f32 v143, v143
    v_cvt_pk_bf16_f32 v140, v140, v141
    v_cvt_pk_bf16_f32 v141, v142, v143
    v_exp_f32 v144, v144
    v_exp_f32 v145, v145
    v_exp_f32 v146, v146
    v_exp_f32 v147, v147
    v_cvt_pk_bf16_f32 v142, v144, v145
    v_cvt_pk_bf16_f32 v143, v146, v147
    s_add_u32 s55, s55, 2
    s_cmp_lt_u32 s55, 6
    s_cbranch_scc1 L_at_loop
    v_mfma_f32_32x32x16_bf16 v[116:131], v[152:155], v[8:11], v[20:35]
    v_exp_f32 v84, v84
    v_exp_f32 v85, v85
    v_exp_f32 v86, v86
    v_exp_f32 v87, v87
    v_cvt_pk_bf16_f32 v84, v84, v85
    v_cvt_pk_bf16_f32 v85, v86, v87
    v_mfma_f32_32x32x16_bf16 v[68:83], v[200:203], v[140:143], v[68:83]
    ds_read2st64_b64 v[156:159], v204 offset0:4 offset1:5
    ds_read2st64_b64 v[160:163], v204 offset0:6 offset1:7
    ds_read2_b64 v[168:171], v206 offset0:64 offset1:96
    s_mov_b64 exec, s[50:51]
    ds_read_b128 v[180:183], v208 offset:1280
    ds_read_b128 v[184:187], v208 offset:1920
    ds_read_b128 v[188:191], v208 offset:2560
    ds_read_b128 v[192:195], v208 offset:3200
    s_mov_b64 exec, -1
    v_exp_f32 v88, v88
    v_exp_f32 v89, v89
    v_exp_f32 v90, v90
    v_exp_f32 v91, v91
    v_cvt_pk_bf16_f32 v86, v88, v89
    v_cvt_pk_bf16_f32 v87, v90, v91
    v_mfma_f32_32x32x16_bf16 v[132:147], v[152:155], v[12:15], v[36:51]
    v_exp_f32 v92, v92
    v_exp_f32 v93, v93
    v_exp_f32 v94, v94
    v_exp_f32 v95, v95
    v_cvt_pk_bf16_f32 v92, v92, v93
    v_cvt_pk_bf16_f32 v93, v94, v95
    v_mfma_f32_32x32x16_bf16 v[52:67], v[172:175], v[84:87], v[52:67]
    v_exp_f32 v96, v96
    v_exp_f32 v97, v97
    v_exp_f32 v98, v98
    v_exp_f32 v99, v99
    v_cvt_pk_bf16_f32 v94, v96, v97
    v_cvt_pk_bf16_f32 v95, v98, v99
    v_mfma_f32_32x32x4_2b_bf16 v[116:147], v[166:167], v[16:17], v[116:147]
    v_exp_f32 v100, v100
    v_exp_f32 v101, v101
    v_exp_f32 v102, v102
    v_exp_f32 v103, v103
    v_cvt_pk_bf16_f32 v100, v100, v101
    v_cvt_pk_bf16_f32 v101, v102, v103
    v_exp_f32 v104, v104
    v_exp_f32 v105, v105
    v_exp_f32 v106, v106
    v_exp_f32 v107, v107
    v_cvt_pk_bf16_f32 v102, v104, v105
    v_cvt_pk_bf16_f32 v103, v106, v107
    v_mfma_f32_32x32x16_bf16 v[52:67], v[176:179], v[92:95], v[52:67]
    v_exp_f32 v108, v108
    v_exp_f32 v109, v109
    v_exp_f32 v110, v110
    v_exp_f32 v111, v111
    v_cvt_pk_bf16_f32 v108, v108, v109
    v_cvt_pk_bf16_f32 v109, v110, v111
    v_mfma_f32_32x32x16_bf16 v[68:83], v[172:175], v[100:103], v[68:83]
    v_exp_f32 v112, v112
    v_exp_f32 v113, v113
    v_exp_f32 v114, v114
    v_exp_f32 v115, v115
    v_cvt_pk_bf16_f32 v110, v112, v113
    v_cvt_pk_bf16_f32 v111, v114, v115
    s_waitcnt lgkmcnt(0)
    v_mfma_f32_32x32x16_bf16 v[84:99], v[156:159], v[8:11], v[20:35]
    v_exp_f32 v116, v116
    v_exp_f32 v117, v117
    v_exp_f32 v118, v118
    v_exp_f32 v119, v119
    v_cvt_pk_bf16_f32 v116, v116, v117
    v_cvt_pk_bf16_f32 v117, v118, v119
    v_mfma_f32_32x32x16_bf16 v[68:83], v[176:179], v[108:111], v[68:83]
    v_exp_f32 v120, v120
    v_exp_f32 v121, v121
    v_exp_f32 v122, v122
    v_exp_f32 v123, v123
    v_cvt_pk_bf16_f32 v118, v120, v121
    v_cvt_pk_bf16_f32 v119, v122, v123
    v_mfma_f32_32x32x16_bf16 v[100:115], v[156:159], v[12:15], v[36:51]
    v_exp_f32 v124, v124
    v_exp_f32 v125, v125
    v_exp_f32 v126, v126
    v_exp_f32 v127, v127
    v_cvt_pk_bf16_f32 v124, v124, v125
    v_cvt_pk_bf16_f32 v125, v126, v127
    v_mfma_f32_32x32x16_bf16 v[52:67], v[180:183], v[116:119], v[52:67]
    v_exp_f32 v128, v128
    v_exp_f32 v129, v129
    v_exp_f32 v130, v130
    v_exp_f32 v131, v131
    v_cvt_pk_bf16_f32 v126, v128, v129
    v_cvt_pk_bf16_f32 v127, v130, v131
    v_mfma_f32_32x32x4_2b_bf16 v[84:115], v[168:169], v[16:17], v[84:115]
    v_exp_f32 v132, v132
    v_exp_f32 v133, v133
    v_exp_f32 v134, v134
    v_exp_f32 v135, v135
    v_cvt_pk_bf16_f32 v132, v132, v133
    v_cvt_pk_bf16_f32 v133, v134, v135
    v_exp_f32 v136, v136
    v_exp_f32 v137, v137
    v_exp_f32 v138, v138
    v_exp_f32 v139, v139
    v_cvt_pk_bf16_f32 v134, v136, v137
    v_cvt_pk_bf16_f32 v135, v138, v139
    v_mfma_f32_32x32x16_bf16 v[52:67], v[184:187], v[124:127], v[52:67]
    v_exp_f32 v140, v140
    v_exp_f32 v141, v141
    v_exp_f32 v142, v142
    v_exp_f32 v143, v143
    v_cvt_pk_bf16_f32 v140, v140, v141
    v_cvt_pk_bf16_f32 v141, v142, v143
    v_mfma_f32_32x32x16_bf16 v[68:83], v[180:183], v[132:135], v[68:83]
    v_exp_f32 v144, v144
    v_exp_f32 v145, v145
    v_exp_f32 v146, v146
    v_exp_f32 v147, v147
    v_cvt_pk_bf16_f32 v142, v144, v145
    v_cvt_pk_bf16_f32 v143, v146, v147
    v_mfma_f32_32x32x16_bf16 v[116:131], v[160:163], v[8:11], v[20:35]
    v_exp_f32 v84, v84
    v_exp_f32 v85, v85
    v_exp_f32 v86, v86
    v_exp_f32 v87, v87
    v_cvt_pk_bf16_f32 v84, v84, v85
    v_cvt_pk_bf16_f32 v85, v86, v87
    v_mfma_f32_32x32x16_bf16 v[68:83], v[184:187], v[140:143], v[68:83]
    ds_read2st64_b64 v[148:151], v204 offset0:8 offset1:9
    ds_read2st64_b64 v[152:155], v204 offset0:10 offset1:11
    ds_read2_b64 v[164:167], v206 offset0:128 offset1:160
    s_mov_b64 exec, s[50:51]
    ds_read_b128 v[196:199], v208 offset:3840
    ds_read_b128 v[200:203], v208 offset:4480
    ds_read_b128 v[172:175], v208 offset:5120
    ds_read_b128 v[176:179], v208 offset:5760
    s_mov_b64 exec, -1
    v_exp_f32 v88, v88
    v_exp_f32 v89, v89
    v_exp_f32 v90, v90
    v_exp_f32 v91, v91
    v_cvt_pk_bf16_f32 v86, v88, v89
    v_cvt_pk_bf16_f32 v87, v90, v91
    v_mfma_f32_32x32x16_bf16 v[132:147], v[160:163], v[12:15], v[36:51]
    v_exp_f32 v92, v92
    v_exp_f32 v93, v93
    v_exp_f32 v94, v94
    v_exp_f32 v95, v95
    v_cvt_pk_bf16_f32 v92, v92, v93
    v_cvt_pk_bf16_f32 v93, v94, v95
    v_mfma_f32_32x32x16_bf16 v[52:67], v[188:191], v[84:87], v[52:67]
    v_exp_f32 v96, v96
    v_exp_f32 v97, v97
    v_exp_f32 v98, v98
    v_exp_f32 v99, v99
    v_cvt_pk_bf16_f32 v94, v96, v97
    v_cvt_pk_bf16_f32 v95, v98, v99
    v_mfma_f32_32x32x4_2b_bf16 v[116:147], v[170:171], v[16:17], v[116:147]
    v_exp_f32 v100, v100
    v_exp_f32 v101, v101
    v_exp_f32 v102, v102
    v_exp_f32 v103, v103
    v_cvt_pk_bf16_f32 v100, v100, v101
    v_cvt_pk_bf16_f32 v101, v102, v103
    v_exp_f32 v104, v104
    v_exp_f32 v105, v105
    v_exp_f32 v106, v106
    v_exp_f32 v107, v107
    v_cvt_pk_bf16_f32 v102, v104, v105
    v_cvt_pk_bf16_f32 v103, v106, v107
    v_mfma_f32_32x32x16_bf16 v[52:67], v[192:195], v[92:95], v[52:67]
    v_exp_f32 v108, v108
    v_exp_f32 v109, v109
    v_exp_f32 v110, v110
    v_exp_f32 v111, v111
    v_cvt_pk_bf16_f32 v108, v108, v109
    v_cvt_pk_bf16_f32 v109, v110, v111
    v_mfma_f32_32x32x16_bf16 v[68:83], v[188:191], v[100:103], v[68:83]
    v_exp_f32 v112, v112
    v_exp_f32 v113, v113
    v_exp_f32 v114, v114
    v_exp_f32 v115, v115
    v_cvt_pk_bf16_f32 v110, v112, v113
    v_cvt_pk_bf16_f32 v111, v114, v115
    s_waitcnt lgkmcnt(0)
    v_mfma_f32_32x32x16_bf16 v[84:99], v[148:151], v[8:11], v[20:35]
    v_exp_f32 v116, v116
    v_exp_f32 v117, v117
    v_exp_f32 v118, v118
    v_exp_f32 v119, v119
    v_cvt_pk_bf16_f32 v116, v116, v117
    v_cvt_pk_bf16_f32 v117, v118, v119
    v_mfma_f32_32x32x16_bf16 v[68:83], v[192:195], v[108:111], v[68:83]
    v_exp_f32 v120, v120
    v_exp_f32 v121, v121
    v_exp_f32 v122, v122
    v_exp_f32 v123, v123
    v_cvt_pk_bf16_f32 v118, v120, v121
    v_cvt_pk_bf16_f32 v119, v122, v123
    v_mfma_f32_32x32x16_bf16 v[100:115], v[148:151], v[12:15], v[36:51]
    v_exp_f32 v124, v124
    v_exp_f32 v125, v125
    v_exp_f32 v126, v126
    v_exp_f32 v127, v127
    v_cvt_pk_bf16_f32 v124, v124, v125
    v_cvt_pk_bf16_f32 v125, v126, v127
    v_mfma_f32_32x32x16_bf16 v[52:67], v[196:199], v[116:119], v[52:67]
    v_exp_f32 v128, v128
    v_exp_f32 v129, v129
    v_exp_f32 v130, v130
    v_exp_f32 v131, v131
    v_cvt_pk_bf16_f32 v126, v128, v129
    v_cvt_pk_bf16_f32 v127, v130, v131
    v_mfma_f32_32x32x4_2b_bf16 v[84:115], v[164:165], v[16:17], v[84:115]
    v_exp_f32 v132, v132
    v_exp_f32 v133, v133
    v_exp_f32 v134, v134
    v_exp_f32 v135, v135
    v_cvt_pk_bf16_f32 v132, v132, v133
    v_cvt_pk_bf16_f32 v133, v134, v135
    v_exp_f32 v136, v136
    v_exp_f32 v137, v137
    v_exp_f32 v138, v138
    v_exp_f32 v139, v139
    v_cvt_pk_bf16_f32 v134, v136, v137
    v_cvt_pk_bf16_f32 v135, v138, v139
    v_mfma_f32_32x32x16_bf16 v[52:67], v[200:203], v[124:127], v[52:67]
    v_exp_f32 v140, v140
    v_exp_f32 v141, v141
    v_exp_f32 v142, v142
    v_exp_f32 v143, v143
    v_cvt_pk_bf16_f32 v140, v140, v141
    v_cvt_pk_bf16_f32 v141, v142, v143
    v_mfma_f32_32x32x16_bf16 v[68:83], v[196:199], v[132:135], v[68:83]
    v_exp_f32 v144, v144
    v_exp_f32 v145, v145
    v_exp_f32 v146, v146
    v_exp_f32 v147, v147
    v_cvt_pk_bf16_f32 v142, v144, v145
    v_cvt_pk_bf16_f32 v143, v146, v147
    v_mfma_f32_32x32x16_bf16 v[116:131], v[152:155], v[8:11], v[20:35]
    v_exp_f32 v84, v84
    v_exp_f32 v85, v85
    v_exp_f32 v86, v86
    v_exp_f32 v87, v87
    v_cvt_pk_bf16_f32 v84, v84, v85
    v_cvt_pk_bf16_f32 v85, v86, v87
    v_mfma_f32_32x32x16_bf16 v[68:83], v[200:203], v[140:143], v[68:83]
    s_waitcnt vmcnt(0)
    s_mov_b64 exec, 1
    ds_add_u32 v214, v215
    s_mov_b64 exec, -1
    s_add_u32 s54, s54, 0x400
    ds_read2st64_b64 v[156:159], v204 offset0:12 offset1:13
    ds_read2st64_b64 v[160:163], v204 offset0:14 offset1:15
    ds_read2_b64 v[168:171], v206 offset0:192 offset1:224
    s_mov_b64 exec, s[50:51]
    ds_read_b128 v[180:183], v208 offset:6400
    ds_read_b128 v[184:187], v208 offset:7040
    ds_read_b128 v[188:191], v208 offset:7680
    ds_read_b128 v[192:195], v208 offset:8320
    s_mov_b64 exec, -1
    v_exp_f32 v88, v88
    v_exp_f32 v89, v89
    v_exp_f32 v90, v90
    v_exp_f32 v91, v91
    v_cvt_pk_bf16_f32 v86, v88, v89
    v_cvt_pk_bf16_f32 v87, v90, v91
    v_mfma_f32_32x32x16_bf16 v[132:147], v[152:155], v[12:15], v[36:51]
    v_exp_f32 v92, v92
    v_exp_f32 v93, v93
    v_exp_f32 v94, v94
    v_exp_f32 v95, v95
    v_cvt_pk_bf16_f32 v92, v92, v93
    v_cvt_pk_bf16_f32 v93, v94, v95
    v_mfma_f32_32x32x16_bf16 v[52:67], v[172:175], v[84:87], v[52:67]
    v_exp_f32 v96, v96
    v_exp_f32 v97, v97
    v_exp_f32 v98, v98
    v_exp_f32 v99, v99
    v_cvt_pk_bf16_f32 v94, v96, v97
    v_cvt_pk_bf16_f32 v95, v98, v99
    v_mfma_f32_32x32x4_2b_bf16 v[116:147], v[166:167], v[16:17], v[116:147]
    v_exp_f32 v100, v100
    v_exp_f32 v101, v101
    v_exp_f32 v102, v102
    v_exp_f32 v103, v103
    v_cvt_pk_bf16_f32 v100, v100, v101
    v_cvt_pk_bf16_f32 v101, v102, v103
    v_exp_f32 v104, v104
    v_exp_f32 v105, v105
    v_exp_f32 v106, v106
    v_exp_f32 v107, v107
    v_cvt_pk_bf16_f32 v102, v104, v105
    v_cvt_pk_bf16_f32 v103, v106, v107
    v_mfma_f32_32x32x16_bf16 v[52:67], v[176:179], v[92:95], v[52:67]
    v_exp_f32 v108, v108
    v_exp_f32 v109, v109
    v_exp_f32 v110, v110
    v_exp_f32 v111, v111
    v_cvt_pk_bf16_f32 v108, v108, v109
    v_cvt_pk_bf16_f32 v109, v110, v111
    v_mfma_f32_32x32x16_bf16 v[68:83], v[172:175], v[100:103], v[68:83]
    v_exp_f32 v112, v112
    v_exp_f32 v113, v113
    v_exp_f32 v114, v114
    v_exp_f32 v115, v115
    v_cvt_pk_bf16_f32 v110, v112, v113
    v_cvt_pk_bf16_f32 v111, v114, v115
    s_waitcnt lgkmcnt(0)
    v_mfma_f32_32x32x16_bf16 v[84:99], v[156:159], v[8:11], v[20:35]
    v_exp_f32 v116, v116
    v_exp_f32 v117, v117
    v_exp_f32 v118, v118
    v_exp_f32 v119, v119
    v_cvt_pk_bf16_f32 v116, v116, v117
    v_cvt_pk_bf16_f32 v117, v118, v119
    v_mfma_f32_32x32x16_bf16 v[68:83], v[176:179], v[108:111], v[68:83]
    ds_read_b32 v6, v214
    v_exp_f32 v120, v120
    v_exp_f32 v121, v121
    v_exp_f32 v122, v122
    v_exp_f32 v123, v123
    v_cvt_pk_bf16_f32 v118, v120, v121
    v_cvt_pk_bf16_f32 v119, v122, v123
    v_mfma_f32_32x32x16_bf16 v[100:115], v[156:159], v[12:15], v[36:51]
    v_exp_f32 v124, v124
    v_exp_f32 v125, v125
    v_exp_f32 v126, v126
    v_exp_f32 v127, v127
    v_cvt_pk_bf16_f32 v124, v124, v125
    v_cvt_pk_bf16_f32 v125, v126, v127
    v_mfma_f32_32x32x16_bf16 v[52:67], v[180:183], v[116:119], v[52:67]
    v_exp_f32 v128, v128
    v_exp_f32 v129, v129
    v_exp_f32 v130, v130
    v_exp_f32 v131, v131
    v_cvt_pk_bf16_f32 v126, v128, v129
    v_cvt_pk_bf16_f32 v127, v130, v131
    v_mfma_f32_32x32x4_2b_bf16 v[84:115], v[168:169], v[16:17], v[84:115]
    v_exp_f32 v132, v132
    v_exp_f32 v133, v133
    v_exp_f32 v134, v134
    v_exp_f32 v135, v135
    v_cvt_pk_bf16_f32 v132, v132, v133
    v_cvt_pk_bf16_f32 v133, v134, v135
    v_exp_f32 v136, v136
    v_exp_f32 v137, v137
    v_exp_f32 v138, v138
    v_exp_f32 v139, v139
    v_cvt_pk_bf16_f32 v134, v136, v137
    v_cvt_pk_bf16_f32 v135, v138, v139
    v_mfma_f32_32x32x16_bf16 v[52:67], v[184:187], v[124:127], v[52:67]
    v_exp_f32 v140, v140
    v_exp_f32 v141, v141
    v_exp_f32 v142, v142
    v_exp_f32 v143, v143
    v_cvt_pk_bf16_f32 v140, v140, v141
    v_cvt_pk_bf16_f32 v141, v142, v143
    v_mfma_f32_32x32x16_bf16 v[68:83], v[180:183], v[132:135], v[68:83]
    v_exp_f32 v144, v144
    v_exp_f32 v145, v145
    s_waitcnt lgkmcnt(0)
    v_readfirstlane_b32 s70, v6
    v_exp_f32 v146, v146
    v_exp_f32 v147, v147
    v_cvt_pk_bf16_f32 v142, v144, v145
    v_cvt_pk_bf16_f32 v143, v146, v147
    v_mfma_f32_32x32x16_bf16 v[116:131], v[160:163], v[8:11], v[20:35]
    v_exp_f32 v84, v84
    v_exp_f32 v85, v85
    v_exp_f32 v86, v86
    v_exp_f32 v87, v87
    v_cvt_pk_bf16_f32 v84, v84, v85
    v_cvt_pk_bf16_f32 v85, v86, v87
    v_mfma_f32_32x32x16_bf16 v[68:83], v[184:187], v[140:143], v[68:83]
    s_cmp_ge_u32 s70, s54
    s_cbranch_scc0 L_c43
L_cd44:
    ds_read2st64_b64 v[148:151], v205 offset0:0 offset1:1
    ds_read2st64_b64 v[152:155], v205 offset0:2 offset1:3
    ds_read2_b64 v[164:167], v207 offset0:0 offset1:32
    s_mov_b64 exec, s[50:51]
    ds_read_b128 v[196:199], v208 offset:8960
    ds_read_b128 v[200:203], v208 offset:9600
    ds_read_b128 v[172:175], v209 offset:0
    ds_read_b128 v[176:179], v209 offset:640
    s_mov_b64 exec, -1
    v_exp_f32 v88, v88
    v_exp_f32 v89, v89
    v_exp_f32 v90, v90
    v_exp_f32 v91, v91
    v_cvt_pk_bf16_f32 v86, v88, v89
    v_cvt_pk_bf16_f32 v87, v90, v91
    v_mfma_f32_32x32x16_bf16 v[132:147], v[160:163], v[12:15], v[36:51]
    v_exp_f32 v92, v92
    v_exp_f32 v93, v93
    v_exp_f32 v94, v94
    v_exp_f32 v95, v95
    v_cvt_pk_bf16_f32 v92, v92, v93
    v_cvt_pk_bf16_f32 v93, v94, v95
    v_mfma_f32_32x32x16_bf16 v[52:67], v[188:191], v[84:87], v[52:67]
    v_exp_f32 v96, v96
    v_exp_f32 v97, v97
    v_exp_f32 v98, v98
    v_exp_f32 v99, v99
    v_cvt_pk_bf16_f32 v94, v96, v97
    v_cvt_pk_bf16_f32 v95, v98, v99
    v_mfma_f32_32x32x4_2b_bf16 v[116:147], v[170:171], v[16:17], v[116:147]
    v_exp_f32 v100, v100
    v_exp_f32 v101, v101
    v_exp_f32 v102, v102
    v_exp_f32 v103, v103
    v_cvt_pk_bf16_f32 v100, v100, v101
    v_cvt_pk_bf16_f32 v101, v102, v103
    v_exp_f32 v104, v104
    v_exp_f32 v105, v105
    v_exp_f32 v106, v106
    v_exp_f32 v107, v107
    v_cvt_pk_bf16_f32 v102, v104, v105
    v_cvt_pk_bf16_f32 v103, v106, v107
    v_mfma_f32_32x32x16_bf16 v[52:67], v[192:195], v[92:95], v[52:67]
    v_exp_f32 v108, v108
    v_exp_f32 v109, v109
    v_exp_f32 v110, v110
    v_exp_f32 v111, v111
    v_cvt_pk_bf16_f32 v108, v108, v109
    v_cvt_pk_bf16_f32 v109, v110, v111
    v_mfma_f32_32x32x16_bf16 v[68:83], v[188:191], v[100:103], v[68:83]
    v_exp_f32 v112, v112
    v_exp_f32 v113, v113
    v_exp_f32 v114, v114
    v_exp_f32 v115, v115
    v_cvt_pk_bf16_f32 v110, v112, v113
    v_cvt_pk_bf16_f32 v111, v114, v115
    s_waitcnt lgkmcnt(0)
    v_mfma_f32_32x32x16_bf16 v[84:99], v[148:151], v[8:11], v[20:35]
    v_exp_f32 v116, v116
    v_exp_f32 v117, v117
    v_exp_f32 v118, v118
    v_exp_f32 v119, v119
    v_cvt_pk_bf16_f32 v116, v116, v117
    v_cvt_pk_bf16_f32 v117, v118, v119
    v_mfma_f32_32x32x16_bf16 v[68:83], v[192:195], v[108:111], v[68:83]
    v_exp_f32 v120, v120
    v_exp_f32 v121, v121
    v_exp_f32 v122, v122
    v_exp_f32 v123, v123
    v_cvt_pk_bf16_f32 v118, v120, v121
    v_cvt_pk_bf16_f32 v119, v122, v123
    v_mfma_f32_32x32x16_bf16 v[100:115], v[148:151], v[12:15], v[36:51]
    v_exp_f32 v124, v124
    v_exp_f32 v125, v125
    v_exp_f32 v126, v126
    v_exp_f32 v127, v127
    v_cvt_pk_bf16_f32 v124, v124, v125
    v_cvt_pk_bf16_f32 v125, v126, v127
    v_mfma_f32_32x32x16_bf16 v[52:67], v[196:199], v[116:119], v[52:67]
    v_exp_f32 v128, v128
    v_exp_f32 v129, v129
    v_exp_f32 v130, v130
    v_exp_f32 v131, v131
    v_cvt_pk_bf16_f32 v126, v128, v129
    v_cvt_pk_bf16_f32 v127, v130, v131
    v_mfma_f32_32x32x4_2b_bf16 v[84:115], v[164:165], v[16:17], v[84:115]
    v_exp_f32 v132, v132
    v_exp_f32 v133, v133
    v_exp_f32 v134, v134
    v_exp_f32 v135, v135
    v_cvt_pk_bf16_f32 v132, v132, v133
    v_cvt_pk_bf16_f32 v133, v134, v135
    v_exp_f32 v136, v136
    v_exp_f32 v137, v137
    v_exp_f32 v138, v138
    v_exp_f32 v139, v139
    v_cvt_pk_bf16_f32 v134, v136, v137
    v_cvt_pk_bf16_f32 v135, v138, v139
    v_mfma_f32_32x32x16_bf16 v[52:67], v[200:203], v[124:127], v[52:67]
    v_exp_f32 v140, v140
    v_exp_f32 v141, v141
    v_exp_f32 v142, v142
    v_exp_f32 v143, v143
    v_cvt_pk_bf16_f32 v140, v140, v141
    v_cvt_pk_bf16_f32 v141, v142, v143
    v_mfma_f32_32x32x16_bf16 v[68:83], v[196:199], v[132:135], v[68:83]
    v_exp_f32 v144, v144
    v_exp_f32 v145, v145
    v_exp_f32 v146, v146
    v_exp_f32 v147, v147
    v_cvt_pk_bf16_f32 v142, v144, v145
    v_cvt_pk_bf16_f32 v143, v146, v147
    v_mfma_f32_32x32x16_bf16 v[116:131], v[152:155], v[8:11], v[20:35]
    v_exp_f32 v84, v84
    v_exp_f32 v85, v85
    v_exp_f32 v86, v86
    v_exp_f32 v87, v87
    v_cvt_pk_bf16_f32 v84, v84, v85
    v_cvt_pk_bf16_f32 v85, v86, v87
    v_mfma_f32_32x32x16_bf16 v[68:83], v[200:203], v[140:143], v[68:83]
    ds_read2st64_b64 v[156:159], v205 offset0:4 offset1:5
    ds_read2st64_b64 v[160:163], v205 offset0:6 offset1:7
    ds_read2_b64 v[168:171], v207 offset0:64 offset1:96
    s_mov_b64 exec, s[50:51]
    ds_read_b128 v[180:183], v209 offset:1280
    ds_read_b128 v[184:187], v209 offset:1920
    ds_read_b128 v[188:191], v209 offset:2560
    ds_read_b128 v[192:195], v209 offset:3200
    s_mov_b64 exec, -1
    v_exp_f32 v88, v88
    v_exp_f32 v89, v89
    v_exp_f32 v90, v90
    v_exp_f32 v91, v91
    v_cvt_pk_bf16_f32 v86, v88, v89
    v_cvt_pk_bf16_f32 v87, v90, v91
    v_mfma_f32_32x32x16_bf16 v[132:147], v[152:155], v[12:15], v[36:51]
    v_exp_f32 v92, v92
    v_exp_f32 v93, v93
    v_exp_f32 v94, v94
    v_exp_f32 v95, v95
    v_cvt_pk_bf16_f32 v92, v92, v93
    v_cvt_pk_bf16_f32 v93, v94, v95
    v_mfma_f32_32x32x16_bf16 v[52:67], v[172:175], v[84:87], v[52:67]
    v_exp_f32 v96, v96
    v_exp_f32 v97, v97
    v_exp_f32 v98, v98
    v_exp_f32 v99, v99
    v_cvt_pk_bf16_f32 v94, v96, v97
    v_cvt_pk_bf16_f32 v95, v98, v99
    v_mfma_f32_32x32x4_2b_bf16 v[116:147], v[166:167], v[16:17], v[116:147]
    v_exp_f32 v100, v100
    v_exp_f32 v101, v101
    v_exp_f32 v102, v102
    v_exp_f32 v103, v103
    v_cvt_pk_bf16_f32 v100, v100, v101
    v_cvt_pk_bf16_f32 v101, v102, v103
    v_exp_f32 v104, v104
    v_exp_f32 v105, v105
    v_exp_f32 v106, v106
    v_exp_f32 v107, v107
    v_cvt_pk_bf16_f32 v102, v104, v105
    v_cvt_pk_bf16_f32 v103, v106, v107
    v_mfma_f32_32x32x16_bf16 v[52:67], v[176:179], v[92:95], v[52:67]
    v_exp_f32 v108, v108
    v_exp_f32 v109, v109
    v_exp_f32 v110, v110
    v_exp_f32 v111, v111
    v_cvt_pk_bf16_f32 v108, v108, v109
    v_cvt_pk_bf16_f32 v109, v110, v111
    v_mfma_f32_32x32x16_bf16 v[68:83], v[172:175], v[100:103], v[68:83]
    v_exp_f32 v112, v112
    v_exp_f32 v113, v113
    v_exp_f32 v114, v114
    v_exp_f32 v115, v115
    v_cvt_pk_bf16_f32 v110, v112, v113
    v_cvt_pk_bf16_f32 v111, v114, v115
    s_waitcnt lgkmcnt(0)
    v_mfma_f32_32x32x16_bf16 v[84:99], v[156:159], v[8:11], v[20:35]
    v_exp_f32 v116, v116
    v_exp_f32 v117, v117
    v_exp_f32 v118, v118
    v_exp_f32 v119, v119
    v_cvt_pk_bf16_f32 v116, v116, v117
    v_cvt_pk_bf16_f32 v117, v118, v119
    v_mfma_f32_32x32x16_bf16 v[68:83], v[176:179], v[108:111], v[68:83]
    v_exp_f32 v120, v120
    v_exp_f32 v121, v121
    v_exp_f32 v122, v122
    v_exp_f32 v123, v123
    v_cvt_pk_bf16_f32 v118, v120, v121
    v_cvt_pk_bf16_f32 v119, v122, v123
    v_mfma_f32_32x32x16_bf16 v[100:115], v[156:159], v[12:15], v[36:51]
    v_exp_f32 v124, v124
    v_exp_f32 v125, v125
    v_exp_f32 v126, v126
    v_exp_f32 v127, v127
    v_cvt_pk_bf16_f32 v124, v124, v125
    v_cvt_pk_bf16_f32 v125, v126, v127
    v_mfma_f32_32x32x16_bf16 v[52:67], v[180:183], v[116:119], v[52:67]
    v_exp_f32 v128, v128
    v_exp_f32 v129, v129
    v_exp_f32 v130, v130
    v_exp_f32 v131, v131
    v_cvt_pk_bf16_f32 v126, v128, v129
    v_cvt_pk_bf16_f32 v127, v130, v131
    v_mfma_f32_32x32x4_2b_bf16 v[84:115], v[168:169], v[16:17], v[84:115]
    v_exp_f32 v132, v132
    v_exp_f32 v133, v133
    v_exp_f32 v134, v134
    v_exp_f32 v135, v135
    v_cvt_pk_bf16_f32 v132, v132, v133
    v_cvt_pk_bf16_f32 v133, v134, v135
    v_exp_f32 v136, v136
    v_exp_f32 v137, v137
    v_exp_f32 v138, v138
    v_exp_f32 v139, v139
    v_cvt_pk_bf16_f32 v134, v136, v137
    v_cvt_pk_bf16_f32 v135, v138, v139
    v_mfma_f32_32x32x16_bf16 v[52:67], v[184:187], v[124:127], v[52:67]
    v_exp_f32 v140, v140
    v_exp_f32 v141, v141
    v_exp_f32 v142, v142
    v_exp_f32 v143, v143
    v_cvt_pk_bf16_f32 v140, v140, v141
    v_cvt_pk_bf16_f32 v141, v142, v143
    v_mfma_f32_32x32x16_bf16 v[68:83], v[180:183], v[132:135], v[68:83]
    v_exp_f32 v144, v144
    v_exp_f32 v145, v145
    v_exp_f32 v146, v146
    v_exp_f32 v147, v147
    v_cvt_pk_bf16_f32 v142, v144, v145
    v_cvt_pk_bf16_f32 v143, v146, v147
    v_mfma_f32_32x32x16_bf16 v[116:131], v[160:163], v[8:11], v[20:35]
    v_exp_f32 v84, v84
    v_exp_f32 v85, v85
    v_exp_f32 v86, v86
    v_exp_f32 v87, v87
    v_cvt_pk_bf16_f32 v84, v84, v85
    v_cvt_pk_bf16_f32 v85, v86, v87
    v_mfma_f32_32x32x16_bf16 v[68:83], v[184:187], v[140:143], v[68:83]
    ds_read2st64_b64 v[148:151], v205 offset0:8 offset1:9
    ds_read2st64_b64 v[152:155], v205 offset0:10 offset1:11
    ds_read2_b64 v[164:167], v207 offset0:128 offset1:160
    s_mov_b64 exec, s[50:51]
    ds_read_b128 v[196:199], v209 offset:3840
    ds_read_b128 v[200:203], v209 offset:4480
    ds_read_b128 v[172:175], v209 offset:5120
    ds_read_b128 v[176:179], v209 offset:5760
    s_mov_b64 exec, -1
    v_exp_f32 v88, v88
    v_exp_f32 v89, v89
    v_exp_f32 v90, v90
    v_exp_f32 v91, v91
    v_cvt_pk_bf16_f32 v86, v88, v89
    v_cvt_pk_bf16_f32 v87, v90, v91
    v_mfma_f32_32x32x16_bf16 v[132:147], v[160:163], v[12:15], v[36:51]
    v_exp_f32 v92, v92
    v_exp_f32 v93, v93
    v_exp_f32 v94, v94
    v_exp_f32 v95, v95
    v_cvt_pk_bf16_f32 v92, v92, v93
    v_cvt_pk_bf16_f32 v93, v94, v95
    v_mfma_f32_32x32x16_bf16 v[52:67], v[188:191], v[84:87], v[52:67]
    v_exp_f32 v96, v96
    v_exp_f32 v97, v97
    v_exp_f32 v98, v98
    v_exp_f32 v99, v99
    v_cvt_pk_bf16_f32 v94, v96, v97
    v_cvt_pk_bf16_f32 v95, v98, v99
    v_mfma_f32_32x32x4_2b_bf16 v[116:147], v[170:171], v[16:17], v[116:147]
    v_exp_f32 v100, v100
    v_exp_f32 v101, v101
    v_exp_f32 v102, v102
    v_exp_f32 v103, v103
    v_cvt_pk_bf16_f32 v100, v100, v101
    v_cvt_pk_bf16_f32 v101, v102, v103
    v_exp_f32 v104, v104
    v_exp_f32 v105, v105
    v_exp_f32 v106, v106
    v_exp_f32 v107, v107
    v_cvt_pk_bf16_f32 v102, v104, v105
    v_cvt_pk_bf16_f32 v103, v106, v107
    v_mfma_f32_32x32x16_bf16 v[52:67], v[192:195], v[92:95], v[52:67]
    v_exp_f32 v108, v108
    v_exp_f32 v109, v109
    v_exp_f32 v110, v110
    v_exp_f32 v111, v111
    v_cvt_pk_bf16_f32 v108, v108, v109
    v_cvt_pk_bf16_f32 v109, v110, v111
    v_mfma_f32_32x32x16_bf16 v[68:83], v[188:191], v[100:103], v[68:83]
    v_exp_f32 v112, v112
    v_exp_f32 v113, v113
    v_exp_f32 v114, v114
    v_exp_f32 v115, v115
    v_cvt_pk_bf16_f32 v110, v112, v113
    v_cvt_pk_bf16_f32 v111, v114, v115
    s_waitcnt lgkmcnt(0)
    v_mfma_f32_32x32x16_bf16 v[84:99], v[148:151], v[8:11], v[20:35]
    v_exp_f32 v116, v116
    v_exp_f32 v117, v117
    v_exp_f32 v118, v118
    v_exp_f32 v119, v119
    v_cvt_pk_bf16_f32 v116, v116, v117
    v_cvt_pk_bf16_f32 v117, v118, v119
    v_mfma_f32_32x32x16_bf16 v[68:83], v[192:195], v[108:111], v[68:83]
    v_exp_f32 v120, v120
    v_exp_f32 v121, v121
    v_exp_f32 v122, v122
    v_exp_f32 v123, v123
    v_cvt_pk_bf16_f32 v118, v120, v121
    v_cvt_pk_bf16_f32 v119, v122, v123
    v_mfma_f32_32x32x16_bf16 v[100:115], v[148:151], v[12:15], v[36:51]
    v_exp_f32 v124, v124
    v_exp_f32 v125, v125
    v_exp_f32 v126, v126
    v_exp_f32 v127, v127
    v_cvt_pk_bf16_f32 v124, v124, v125
    v_cvt_pk_bf16_f32 v125, v126, v127
    v_mfma_f32_32x32x16_bf16 v[52:67], v[196:199], v[116:119], v[52:67]
    v_exp_f32 v128, v128
    v_exp_f32 v129, v129
    v_exp_f32 v130, v130
    v_exp_f32 v131, v131
    v_cvt_pk_bf16_f32 v126, v128, v129
    v_cvt_pk_bf16_f32 v127, v130, v131
    v_mfma_f32_32x32x4_2b_bf16 v[84:115], v[164:165], v[16:17], v[84:115]
    v_exp_f32 v132, v132
    v_exp_f32 v133, v133
    v_exp_f32 v134, v134
    v_exp_f32 v135, v135
    v_cvt_pk_bf16_f32 v132, v132, v133
    v_cvt_pk_bf16_f32 v133, v134, v135
    v_exp_f32 v136, v136
    v_exp_f32 v137, v137
    v_exp_f32 v138, v138
    v_exp_f32 v139, v139
    v_cvt_pk_bf16_f32 v134, v136, v137
    v_cvt_pk_bf16_f32 v135, v138, v139
    v_mfma_f32_32x32x16_bf16 v[52:67], v[200:203], v[124:127], v[52:67]
    v_exp_f32 v140, v140
    v_exp_f32 v141, v141
    v_exp_f32 v142, v142
    v_exp_f32 v143, v143
    v_cvt_pk_bf16_f32 v140, v140, v141
    v_cvt_pk_bf16_f32 v141, v142, v143
    v_mfma_f32_32x32x16_bf16 v[68:83], v[196:199], v[132:135], v[68:83]
    v_exp_f32 v144, v144
    v_exp_f32 v145, v145
    v_exp_f32 v146, v146
    v_exp_f32 v147, v147
    v_cvt_pk_bf16_f32 v142, v144, v145
    v_cvt_pk_bf16_f32 v143, v146, v147
    v_mfma_f32_32x32x16_bf16 v[116:131], v[152:155], v[8:11], v[20:35]
    v_exp_f32 v84, v84
    v_exp_f32 v85, v85
    v_exp_f32 v86, v86
    v_exp_f32 v87, v87
    v_cvt_pk_bf16_f32 v84, v84, v85
    v_cvt_pk_bf16_f32 v85, v86, v87
    v_mfma_f32_32x32x16_bf16 v[68:83], v[200:203], v[140:143], v[68:83]
    ds_read2st64_b64 v[156:159], v205 offset0:12 offset1:13
    ds_read2st64_b64 v[160:163], v205 offset0:14 offset1:15
    ds_read2_b64 v[168:171], v207 offset0:192 offset1:224
    s_mov_b64 exec, s[50:51]
    ds_read_b128 v[180:183], v209 offset:6400
    ds_read_b128 v[184:187], v209 offset:7040
    ds_read_b128 v[188:191], v209 offset:7680
    ds_read_b128 v[192:195], v209 offset:8320
    s_mov_b64 exec, -1
    v_exp_f32 v88, v88
    v_exp_f32 v89, v89
    v_exp_f32 v90, v90
    v_exp_f32 v91, v91
    v_cvt_pk_bf16_f32 v86, v88, v89
    v_cvt_pk_bf16_f32 v87, v90, v91
    v_mfma_f32_32x32x16_bf16 v[132:147], v[152:155], v[12:15], v[36:51]
    v_exp_f32 v92, v92
    v_exp_f32 v93, v93
    v_exp_f32 v94, v94
    v_exp_f32 v95, v95
    v_cvt_pk_bf16_f32 v92, v92, v93
    v_cvt_pk_bf16_f32 v93, v94, v95
    v_mfma_f32_32x32x16_bf16 v[52:67], v[172:175], v[84:87], v[52:67]
    v_exp_f32 v96, v96
    v_exp_f32 v97, v97
    v_exp_f32 v98, v98
    v_exp_f32 v99, v99
    v_cvt_pk_bf16_f32 v94, v96, v97
    v_cvt_pk_bf16_f32 v95, v98, v99
    v_mfma_f32_32x32x4_2b_bf16 v[116:147], v[166:167], v[16:17], v[116:147]
    v_exp_f32 v100, v100
    v_exp_f32 v101, v101
    v_exp_f32 v102, v102
    v_exp_f32 v103, v103
    v_cvt_pk_bf16_f32 v100, v100, v101
    v_cvt_pk_bf16_f32 v101, v102, v103
    v_exp_f32 v104, v104
    v_exp_f32 v105, v105
    v_exp_f32 v106, v106
    v_exp_f32 v107, v107
    v_cvt_pk_bf16_f32 v102, v104, v105
    v_cvt_pk_bf16_f32 v103, v106, v107
    v_mfma_f32_32x32x16_bf16 v[52:67], v[176:179], v[92:95], v[52:67]
    v_exp_f32 v108, v108
    v_exp_f32 v109, v109
    v_exp_f32 v110, v110
    v_exp_f32 v111, v111
    v_cvt_pk_bf16_f32 v108, v108, v109
    v_cvt_pk_bf16_f32 v109, v110, v111
    v_mfma_f32_32x32x16_bf16 v[68:83], v[172:175], v[100:103], v[68:83]
    v_exp_f32 v112, v112
    v_exp_f32 v113, v113
    v_exp_f32 v114, v114
    v_exp_f32 v115, v115
    v_cvt_pk_bf16_f32 v110, v112, v113
    v_cvt_pk_bf16_f32 v111, v114, v115
    s_waitcnt lgkmcnt(0)
    v_mfma_f32_32x32x16_bf16 v[84:99], v[156:159], v[8:11], v[20:35]
    v_exp_f32 v116, v116
    v_exp_f32 v117, v117
    v_exp_f32 v118, v118
    v_exp_f32 v119, v119
    v_cvt_pk_bf16_f32 v116, v116, v117
    v_cvt_pk_bf16_f32 v117, v118, v119
    v_mfma_f32_32x32x16_bf16 v[68:83], v[176:179], v[108:111], v[68:83]
    v_exp_f32 v120, v120
    v_exp_f32 v121, v121
    v_exp_f32 v122, v122
    v_exp_f32 v123, v123
    v_cvt_pk_bf16_f32 v118, v120, v121
    v_cvt_pk_bf16_f32 v119, v122, v123
    v_mfma_f32_32x32x16_bf16 v[100:115], v[156:159], v[12:15], v[36:51]
    v_exp_f32 v124, v124
    v_exp_f32 v125, v125
    v_exp_f32 v126, v126
    v_exp_f32 v127, v127
    v_cvt_pk_bf16_f32 v124, v124, v125
    v_cvt_pk_bf16_f32 v125, v126, v127
    v_mfma_f32_32x32x16_bf16 v[52:67], v[180:183], v[116:119], v[52:67]
    v_exp_f32 v128, v128
    v_exp_f32 v129, v129
    v_exp_f32 v130, v130
    v_exp_f32 v131, v131
    v_cvt_pk_bf16_f32 v126, v128, v129
    v_cvt_pk_bf16_f32 v127, v130, v131
    v_mfma_f32_32x32x4_2b_bf16 v[84:115], v[168:169], v[16:17], v[84:115]
    v_exp_f32 v132, v132
    v_exp_f32 v133, v133
    v_exp_f32 v134, v134
    v_exp_f32 v135, v135
    v_cvt_pk_bf16_f32 v132, v132, v133
    v_cvt_pk_bf16_f32 v133, v134, v135
    v_exp_f32 v136, v136
    v_exp_f32 v137, v137
    v_exp_f32 v138, v138
    v_exp_f32 v139, v139
    v_cvt_pk_bf16_f32 v134, v136, v137
    v_cvt_pk_bf16_f32 v135, v138, v139
    v_mfma_f32_32x32x16_bf16 v[52:67], v[184:187], v[124:127], v[52:67]
    v_exp_f32 v140, v140
    v_exp_f32 v141, v141
    v_exp_f32 v142, v142
    v_exp_f32 v143, v143
    v_cvt_pk_bf16_f32 v140, v140, v141
    v_cvt_pk_bf16_f32 v141, v142, v143
    v_mfma_f32_32x32x16_bf16 v[68:83], v[180:183], v[132:135], v[68:83]
    v_exp_f32 v144, v144
    v_exp_f32 v145, v145
    v_exp_f32 v146, v146
    v_exp_f32 v147, v147
    v_cvt_pk_bf16_f32 v142, v144, v145
    v_cvt_pk_bf16_f32 v143, v146, v147
    v_mfma_f32_32x32x16_bf16 v[116:131], v[160:163], v[8:11], v[20:35]
    v_exp_f32 v84, v84
    v_exp_f32 v85, v85
    v_exp_f32 v86, v86
    v_exp_f32 v87, v87
    v_cvt_pk_bf16_f32 v84, v84, v85
    v_cvt_pk_bf16_f32 v85, v86, v87
    v_mfma_f32_32x32x16_bf16 v[68:83], v[184:187], v[140:143], v[68:83]
    s_mov_b64 exec, s[50:51]
    ds_read_b128 v[196:199], v209 offset:8960
    ds_read_b128 v[200:203], v209 offset:9600
    s_mov_b64 exec, -1
    v_exp_f32 v88, v88
    v_exp_f32 v89, v89
    v_exp_f32 v90, v90
    v_exp_f32 v91, v91
    v_cvt_pk_bf16_f32 v86, v88, v89
    v_cvt_pk_bf16_f32 v87, v90, v91
    v_mfma_f32_32x32x16_bf16 v[132:147], v[160:163], v[12:15], v[36:51]
    v_exp_f32 v92, v92
    v_exp_f32 v93, v93
    v_exp_f32 v94, v94
    v_exp_f32 v95, v95
    v_cvt_pk_bf16_f32 v92, v92, v93
    v_cvt_pk_bf16_f32 v93, v94, v95
    v_mfma_f32_32x32x16_bf16 v[52:67], v[188:191], v[84:87], v[52:67]
    v_exp_f32 v96, v96
    v_exp_f32 v97, v97
    v_exp_f32 v98, v98
    v_exp_f32 v99, v99
    v_cvt_pk_bf16_f32 v94, v96, v97
    v_cvt_pk_bf16_f32 v95, v98, v99
    v_mfma_f32_32x32x4_2b_bf16 v[116:147], v[170:171], v[16:17], v[116:147]
    v_exp_f32 v100, v100
    v_exp_f32 v101, v101
    v_exp_f32 v102, v102
    v_exp_f32 v103, v103
    v_cvt_pk_bf16_f32 v100, v100, v101
    v_cvt_pk_bf16_f32 v101, v102, v103
    v_exp_f32 v104, v104
    v_exp_f32 v105, v105
    v_exp_f32 v106, v106
    v_exp_f32 v107, v107
    v_cvt_pk_bf16_f32 v102, v104, v105
    v_cvt_pk_bf16_f32 v103, v106, v107
    v_mfma_f32_32x32x16_bf16 v[52:67], v[192:195], v[92:95], v[52:67]
    v_exp_f32 v108, v108
    v_exp_f32 v109, v109
    v_exp_f32 v110, v110
    v_exp_f32 v111, v111
    v_cvt_pk_bf16_f32 v108, v108, v109
    v_cvt_pk_bf16_f32 v109, v110, v111
    v_mfma_f32_32x32x16_bf16 v[68:83], v[188:191], v[100:103], v[68:83]
    v_exp_f32 v112, v112
    v_exp_f32 v113, v113
    v_exp_f32 v114, v114
    v_exp_f32 v115, v115
    v_cvt_pk_bf16_f32 v110, v112, v113
    v_cvt_pk_bf16_f32 v111, v114, v115
    s_waitcnt lgkmcnt(0)
    v_exp_f32 v116, v116
    v_exp_f32 v117, v117
    v_exp_f32 v118, v118
    v_exp_f32 v119, v119
    v_cvt_pk_bf16_f32 v116, v116, v117
    v_cvt_pk_bf16_f32 v117, v118, v119
    v_mfma_f32_32x32x16_bf16 v[68:83], v[192:195], v[108:111], v[68:83]
    v_exp_f32 v120, v120
    v_exp_f32 v121, v121
    v_exp_f32 v122, v122
    v_exp_f32 v123, v123
    v_cvt_pk_bf16_f32 v118, v120, v121
    v_cvt_pk_bf16_f32 v119, v122, v123
    v_exp_f32 v124, v124
    v_exp_f32 v125, v125
    v_exp_f32 v126, v126
    v_exp_f32 v127, v127
    v_cvt_pk_bf16_f32 v124, v124, v125
    v_cvt_pk_bf16_f32 v125, v126, v127
    v_mfma_f32_32x32x16_bf16 v[52:67], v[196:199], v[116:119], v[52:67]
    v_exp_f32 v128, v128
    v_exp_f32 v129, v129
    v_exp_f32 v130, v130
    v_exp_f32 v131, v131
    v_cvt_pk_bf16_f32 v126, v128, v129
    v_cvt_pk_bf16_f32 v127, v130, v131
    v_exp_f32 v132, v132
    v_exp_f32 v133, v133
    v_exp_f32 v134, v134
    v_exp_f32 v135, v135
    v_cvt_pk_bf16_f32 v132, v132, v133
    v_cvt_pk_bf16_f32 v133, v134, v135
    v_exp_f32 v136, v136
    v_exp_f32 v137, v137
    v_exp_f32 v138, v138
    v_exp_f32 v139, v139
    v_cvt_pk_bf16_f32 v134, v136, v137
    v_cvt_pk_bf16_f32 v135, v138, v139
    v_mfma_f32_32x32x16_bf16 v[52:67], v[200:203], v[124:127], v[52:67]
    v_exp_f32 v140, v140
    v_exp_f32 v141, v141
    v_exp_f32 v142, v142
    v_exp_f32 v143, v143
    v_cvt_pk_bf16_f32 v140, v140, v141
    v_cvt_pk_bf16_f32 v141, v142, v143
    v_mfma_f32_32x32x16_bf16 v[68:83], v[196:199], v[132:135], v[68:83]
    v_exp_f32 v144, v144
    v_exp_f32 v145, v145
    v_exp_f32 v146, v146
    v_exp_f32 v147, v147
    v_cvt_pk_bf16_f32 v142, v144, v145
    v_cvt_pk_bf16_f32 v143, v146, v147
    s_nop 1
    v_mfma_f32_32x32x16_bf16 v[68:83], v[200:203], v[140:143], v[68:83]
    s_nop 11
    v_mov_b32 v7, 0x5d800000
    v_cmp_nlt_f32 vcc, v64, v7
    v_cmp_nlt_f32 s[52:53], v80, v7
    s_nop 1
    s_or_b64 vcc, vcc, s[52:53]
    s_cbranch_vccnz L_at_slow
L_at_fin:
    v_rcp_f32 v6, v64
    v_rcp_f32 v7, v80
    s_nop 0
    v_mul_f32 v52, v52, v6
    v_mul_f32 v53, v53, v6
    v_mul_f32 v54, v54, v6
    v_mul_f32 v55, v55, v6
    v_mul_f32 v56, v56, v6
    v_mul_f32 v57, v57, v6
    v_mul_f32 v58, v58, v6
    v_mul_f32 v59, v59, v6
    v_mul_f32 v60, v60, v6
    v_mul_f32 v61, v61, v6
    v_mul_f32 v62, v62, v6
    v_mul_f32 v63, v63, v6
    v_cvt_pk_bf16_f32 v52, v52, v53
    v_cvt_pk_bf16_f32 v53, v54, v55
    v_cvt_pk_bf16_f32 v54, v56, v57
    v_cvt_pk_bf16_f32 v55, v58, v59
    v_cvt_pk_bf16_f32 v56, v60, v61
    v_cvt_pk_bf16_f32 v57, v62, v63
    v_mul_f32 v68, v68, v7
    v_mul_f32 v69, v69, v7
    v_mul_f32 v70, v70, v7
    v_mul_f32 v71, v71, v7
    v_mul_f32 v72, v72, v7
    v_mul_f32 v73, v73, v7
    v_mul_f32 v74, v74, v7
    v_mul_f32 v75, v75, v7
    v_mul_f32 v76, v76, v7
    v_mul_f32 v77, v77, v7
    v_mul_f32 v78, v78, v7
    v_mul_f32 v79, v79, v7
    v_cvt_pk_bf16_f32 v68, v68, v69
    v_cvt_pk_bf16_f32 v69, v70, v71
    v_cvt_pk_bf16_f32 v70, v72, v73
    v_cvt_pk_bf16_f32 v71, v74, v75
    v_cvt_pk_bf16_f32 v72, v76, v77
    v_cvt_pk_bf16_f32 v73, v78, v79
    buffer_store_dwordx4 v[52:55], v218, s[4:7], s16 offen sc1
    buffer_store_dwordx4 v[68:71], v218, s[4:7], s18 offen sc1
    s_mov_b32 exec_hi, 0
    buffer_store_dwordx2 v[56:57], v219, s[4:7], s17 offen sc1
    buffer_store_dwordx2 v[72:73], v219, s[4:7], s19 offen sc1
    s_waitcnt vmcnt(4) lgkmcnt(0)
    s_barrier
    s_endpgm
L_at_mark:
    s_lshl_b32 s47, s41, 5
    s_add_u32 s47, s47, s40
    s_lshl_b32 s47, s47, 7
    s_add_u32 s47, s47, 0x1432000
    v_mov_b32 v5, 0
    v_mov_b32 v6, s64
    s_mov_b64 exec, 1
    buffer_store_dword v6, v5, s[20:23], s47 offen sc1
    s_mov_b64 exec, -1
    s_branch L_at_marked
L_c39:
    s_mov_b32 s71, 80000
L_c39a:
    ds_read_b32 v6, v214
    s_waitcnt lgkmcnt(0)
    v_readfirstlane_b32 s70, v6
    s_cmp_ge_u32 s70, s54
    s_cbranch_scc1 L_cd40
    s_sub_u32 s71, s71, 1
    s_cmp_lg_u32 s71, 0
    s_cbranch_scc1 L_c39a
    s_branch L_cd40
L_c41:
    s_mov_b32 s71, 80000
L_c41a:
    ds_read_b32 v6, v214
    s_waitcnt lgkmcnt(0)
    v_readfirstlane_b32 s70, v6
    s_cmp_ge_u32 s70, s54
    s_cbranch_scc1 L_cd42
    s_sub_u32 s71, s71, 1
    s_cmp_lg_u32 s71, 0
    s_cbranch_scc1 L_c41a
    s_branch L_cd42
L_c43:
    s_mov_b32 s71, 80000
L_c43a:
    ds_read_b32 v6, v214
    s_waitcnt lgkmcnt(0)
    v_readfirstlane_b32 s70, v6
    s_cmp_ge_u32 s70, s54
    s_cbranch_scc1 L_cd44
    s_sub_u32 s71, s71, 1
    s_cmp_lg_u32 s71, 0
    s_cbranch_scc1 L_c43a
    s_branch L_cd44
L_at_slow:
    s_waitcnt vmcnt(0) lgkmcnt(0)
    s_mov_b32 s55, 0
    v_mov_b32 v216, 0xff800000
    v_mov_b32 v217, 0xff800000
L_at_s1:
    s_lshr_b32 s45, s55, 3
    s_mul_i32 s45, s45, 20480
    s_add_u32 s45, s45, s42
    s_and_b32 s46, s55, 7
    s_lshl_b32 s47, s46, 10
    s_add_u32 s47, s47, s45
    s_lshl_b32 s48, s46, 8
    s_add_u32 s48, s48, s45
    s_mul_i32 s49, s46, 1280
    s_add_u32 s49, s49, s45
    buffer_load_dwordx2 v[148:149], v211, s[20:23], s47 offen sc1
    buffer_load_dwordx2 v[150:151], v211, s[20:23], s47 offen offset:512 sc1
    buffer_load_dwordx2 v[164:165], v212, s[20:23], s48 offen sc1
    s_waitcnt vmcnt(0)
    v_mfma_f32_32x32x16_bf16 v[84:99], v[148:151], v[8:11], 0
    v_mfma_f32_32x32x16_bf16 v[100:115], v[148:151], v[12:15], 0
    s_nop 9
    v_mfma_f32_32x32x4_2b_bf16 v[84:115], v[164:165], v[16:17], v[84:115]
    s_nop 15
    s_nop 3
    v_max3_f32 v6, v84, v85, v86
    v_max3_f32 v6, v6, v87, v88
    v_max3_f32 v6, v6, v89, v90
    v_max3_f32 v6, v6, v91, v92
    v_max3_f32 v6, v6, v93, v94
    v_max3_f32 v6, v6, v95, v96
    v_max3_f32 v6, v6, v97, v98
    v_max_f32 v6, v6, v99
    v_max3_f32 v7, v100, v101, v102
    v_max3_f32 v7, v7, v103, v104
    v_max3_f32 v7, v7, v105, v106
    v_max3_f32 v7, v7, v107, v108
    v_max3_f32 v7, v7, v109, v110
    v_max3_f32 v7, v7, v111, v112
    v_max3_f32 v7, v7, v113, v114
    v_max_f32 v7, v7, v115
    v_max_f32 v216, v216, v6
    v_max_f32 v217, v217, v7
    s_add_u32 s55, s55, 1
    s_cmp_lt_u32 s55, 64
    s_cbranch_scc1 L_at_s1
    v_mov_b32 v18, v216
    v_mov_b32 v19, v217
    s_nop 0
    v_permlane32_swap_b32 v216, v18
    v_permlane32_swap_b32 v217, v19
    v_max_f32 v18, v216, v18
    v_max_f32 v19, v217, v19
    v_sub_f32 v20, 0, v18
    v_sub_f32 v21, 0, v18
    v_sub_f32 v22, 0, v18
    v_sub_f32 v23, 0, v18
    v_sub_f32 v24, 0, v18
    v_sub_f32 v25, 0, v18
    v_sub_f32 v26, 0, v18
    v_sub_f32 v27, 0, v18
    v_sub_f32 v28, 0, v18
    v_sub_f32 v29, 0, v18
    v_sub_f32 v30, 0, v18
    v_sub_f32 v31, 0, v18
    v_sub_f32 v32, 0, v18
    v_sub_f32 v33, 0, v18
    v_sub_f32 v34, 0, v18
    v_sub_f32 v35, 0, v18
    v_sub_f32 v36, 0, v19
    v_sub_f32 v37, 0, v19
    v_sub_f32 v38, 0, v19
    v_sub_f32 v39, 0, v19
    v_sub_f32 v40, 0, v19
    v_sub_f32 v41, 0, v19
    v_sub_f32 v42, 0, v19
    v_sub_f32 v43, 0, v19
    v_sub_f32 v44, 0, v19
    v_sub_f32 v45, 0, v19
    v_sub_f32 v46, 0, v19
    v_sub_f32 v47, 0, v19
    v_sub_f32 v48, 0, v19
    v_sub_f32 v49, 0, v19
    v_sub_f32 v50, 0, v19
    v_sub_f32 v51, 0, v19
    v_mov_b32 v52, 0
    v_mov_b32 v53, 0
    v_mov_b32 v54, 0
    v_mov_b32 v55, 0
    v_mov_b32 v56, 0
    v_mov_b32 v57, 0
    v_mov_b32 v58, 0
    v_mov_b32 v59, 0
    v_mov_b32 v60, 0
    v_mov_b32 v61, 0
    v_mov_b32 v62, 0
    v_mov_b32 v63, 0
    v_mov_b32 v64, 0
    v_mov_b32 v65, 0
    v_mov_b32 v66, 0
    v_mov_b32 v67, 0
    v_mov_b32 v68, 0
    v_mov_b32 v69, 0
    v_mov_b32 v70, 0
    v_mov_b32 v71, 0
    v_mov_b32 v72, 0
    v_mov_b32 v73, 0
    v_mov_b32 v74, 0
    v_mov_b32 v75, 0
    v_mov_b32 v76, 0
    v_mov_b32 v77, 0
    v_mov_b32 v78, 0
    v_mov_b32 v79, 0
    v_mov_b32 v80, 0
    v_mov_b32 v81, 0
    v_mov_b32 v82, 0
    v_mov_b32 v83, 0
    s_mov_b32 s55, 0
L_at_s2:
    s_lshr_b32 s45, s55, 3
    s_mul_i32 s45, s45, 20480
    s_add_u32 s45, s45, s42
    s_and_b32 s46, s55, 7
    s_lshl_b32 s47, s46, 10
    s_add_u32 s47, s47, s45
    s_lshl_b32 s48, s46, 8
    s_add_u32 s48, s48, s45
    s_mul_i32 s49, s46, 1280
    s_add_u32 s49, s49, s45
    buffer_load_dwordx2 v[148:149], v211, s[20:23], s47 offen sc1
    buffer_load_dwordx2 v[150:151], v211, s[20:23], s47 offen offset:512 sc1
    buffer_load_dwordx2 v[164:165], v212, s[20:23], s48 offen sc1
    s_mov_b64 exec, s[50:51]
    buffer_load_dwordx4 v[172:175], v213, s[20:23], s49 offen offset:0 sc1
    buffer_load_dwordx4 v[176:179], v213, s[20:23], s49 offen offset:640 sc1
    s_mov_b64 exec, -1
    s_waitcnt vmcnt(0)
    v_mfma_f32_32x32x16_bf16 v[84:99], v[148:151], v[8:11], v[20:35]
    v_mfma_f32_32x32x16_bf16 v[100:115], v[148:151], v[12:15], v[36:51]
    s_nop 9
    v_mfma_f32_32x32x4_2b_bf16 v[84:115], v[164:165], v[16:17], v[84:115]
    s_nop 15
    s_nop 3
    v_exp_f32 v84, v84
    v_exp_f32 v85, v85
    v_exp_f32 v86, v86
    v_exp_f32 v87, v87
    v_cvt_pk_bf16_f32 v84, v84, v85
    v_cvt_pk_bf16_f32 v85, v86, v87
    v_exp_f32 v88, v88
    v_exp_f32 v89, v89
    v_exp_f32 v90, v90
    v_exp_f32 v91, v91
    v_cvt_pk_bf16_f32 v86, v88, v89
    v_cvt_pk_bf16_f32 v87, v90, v91
    v_exp_f32 v92, v92
    v_exp_f32 v93, v93
    v_exp_f32 v94, v94
    v_exp_f32 v95, v95
    v_cvt_pk_bf16_f32 v92, v92, v93
    v_cvt_pk_bf16_f32 v93, v94, v95
    v_exp_f32 v96, v96
    v_exp_f32 v97, v97
    v_exp_f32 v98, v98
    v_exp_f32 v99, v99
    v_cvt_pk_bf16_f32 v94, v96, v97
    v_cvt_pk_bf16_f32 v95, v98, v99
    v_exp_f32 v100, v100
    v_exp_f32 v101, v101
    v_exp_f32 v102, v102
    v_exp_f32 v103, v103
    v_cvt_pk_bf16_f32 v100, v100, v101
    v_cvt_pk_bf16_f32 v101, v102, v103
    v_exp_f32 v104, v104
    v_exp_f32 v105, v105
    v_exp_f32 v106, v106
    v_exp_f32 v107, v107
    v_cvt_pk_bf16_f32 v102, v104, v105
    v_cvt_pk_bf16_f32 v103, v106, v107
    v_exp_f32 v108, v108
    v_exp_f32 v109, v109
    v_exp_f32 v110, v110
    v_exp_f32 v111, v111
    v_cvt_pk_bf16_f32 v108, v108, v109
    v_cvt_pk_bf16_f32 v109, v110, v111
    v_exp_f32 v112, v112
    v_exp_f32 v113, v113
    v_exp_f32 v114, v114
    v_exp_f32 v115, v115
    v_cvt_pk_bf16_f32 v110, v112, v113
    v_cvt_pk_bf16_f32 v111, v114, v115
    s_nop 1
    v_mfma_f32_32x32x16_bf16 v[52:67], v[172:175], v[84:87], v[52:67]
    v_mfma_f32_32x32x16_bf16 v[52:67], v[176:179], v[92:95], v[52:67]
    v_mfma_f32_32x32x16_bf16 v[68:83], v[172:175], v[100:103], v[68:83]
    v_mfma_f32_32x32x16_bf16 v[68:83], v[176:179], v[108:111], v[68:83]
    s_add_u32 s55, s55, 1
    s_cmp_lt_u32 s55, 64
    s_cbranch_scc1 L_at_s2
    s_nop 11
    s_branch L_at_fin
L_gemm:
    s_mov_b32 s24, s54
    s_mov_b32 s25, s55
    s_mov_b32 s26, 0x100
    s_mov_b32 s27, 0x00020000
    s_mov_b32 s28, s50
    s_mov_b32 s29, s51
    s_mov_b32 s30, 0x21c000
    s_mov_b32 s31, 0x00020000
    s_mov_b32 s32, s44
    s_mov_b32 s33, s45
    s_mov_b32 s34, 0xc8000
    s_mov_b32 s35, 0x00020000
    s_mov_b32 s36, s52
    s_mov_b32 s37, s53
    s_mov_b32 s38, 0x280000
    s_mov_b32 s39, 0x00020000
    s_add_u32 s4, s56, 0xa00000
    s_addc_u32 s5, s57, 0
    s_mov_b32 s6, 0x940000
    s_mov_b32 s7, 0x00020000
    s_setprio 0
    s_lshr_b32 s40, s58, 1
    s_and_b32 s41, s58, 1
    v_and_b32 v60, 15, v2
    v_lshrrev_b32 v61, 4, v2
    s_lshl_b32 s42, s40, 13
    v_lshlrev_b32 v5, 7, v60
    v_add_u32 v5, s42, v5
    v_lshrrev_b32 v6, 1, v60
    v_xor_b32 v6, v6, v61
    v_lshl_add_u32 v8, v6, 4, v5
    v_xor_b32 v9, 64, v8
    v_bfe_u32 v5, v2, 2, 2
    v_lshl_add_u32 v6, v61, 3, v5
    v_lshlrev_b32 v6, 8, v6
    v_and_b32 v7, 1, v61
    v_lshl_add_u32 v6, v7, 5, v6
    v_and_b32 v7, 3, v2
    v_lshl_add_u32 v6, v7, 3, v6
    v_add_u32 v6, 65536, v6
    s_lshl_b32 s42, s41, 1
    v_xor_b32 v7, s42, v5
    v_lshl_add_u32 v10, v7, 6, v6
    v_xor_b32 v11, 32, v10
    v_xor_b32 v12, 64, v10
    v_xor_b32 v13, 96, v10
    s_lshr_b32 s44, s59, 1
    s_mul_i32 s44, s44, 20480
    s_and_b32 s45, s59, 1
    s_lshl_b32 s45, s45, 2
    s_lshl_b32 s42, s40, 1
    s_add_u32 s45, s45, s42
    s_lshl_b32 s46, s59, 2
    s_add_u32 s46, s46, s42
    s_mul_i32 s46, s46, 148
    s_lshl_b32 s43, s61, 3
    s_add_u32 s46, s46, s43
    s_lshl_b32 s43, s41, 2
    s_add_u32 s46, s46, s43
    s_add_u32 s46, s46, 40
    s_lshl_b32 s46, s46, 10
    s_add_u32 s47, s46, 151552
    v_lshlrev_b32 v14, 9, v61
    v_lshl_add_u32 v14, v60, 4, v14
    s_lshl_b32 s42, s40, 8
    s_add_u32 s42, s42, 159744
    v_lshlrev_b32 v15, 2, v60
    v_add_u32 v15, s42, v15
    s_lshl_b32 s42, s41, 8
    s_add_u32 s43, s42, 161280
    v_lshlrev_b32 v62, 4, v61
    v_add_u32 v62, s43, v62
    s_add_u32 s43, s42, 162816
    v_lshlrev_b32 v63, 2, v60
    v_add_u32 v63, s43, v63
    s_lshl_b32 s42, s59, 7
    s_lshl_b32 s43, s58, 5
    s_add_u32 s42, s42, s43
    v_lshrrev_b32 v5, 3, v2
    v_add_u32 v5, s42, v5
    v_mul_u32_u24 v5, 1280, v5
    v_and_b32 v6, 7, v2
    v_xor_b32 v6, v6, v61
    v_xor_b32 v7, 0, v6
    v_lshl_add_u32 v7, v7, 4, v5
    v_add_u32 v208, 0, v7
    v_xor_b32 v7, 4, v6
    v_lshl_add_u32 v7, v7, 4, v5
    v_add_u32 v209, 9216, v7
    v_xor_b32 v7, 0, v6
    v_lshl_add_u32 v7, v7, 4, v5
    v_add_u32 v210, 18432, v7
    v_xor_b32 v7, 4, v6
    v_lshl_add_u32 v7, v7, 4, v5
    v_add_u32 v211, 27648, v7
    v_lshlrev_b32 v7, 2, v61
    v_xor_b32 v6, v60, v7
    v_lshlrev_b32 v6, 4, v6
    s_lshl_b32 s42, s61, 8
    v_add_u32 v6, s42, v6
    s_lshl_b32 s42, s58, 4
    v_add_u32 v5, s42, v61
    s_movk_i32 s42, 3456
    v_mad_u32_u24 v6, v5, s42, v6
    v_add_u32 v212, 0, v6
    v_add_u32 v213, 12800, v6
    v_xor_b32 v6, 32, v6
    v_add_u32 v214, 25600, v6
    v_add_u32 v215, 38400, v6
    v_subrev_u32 v216, 16384, v10
    v_subrev_u32 v217, 16384, v11
    v_subrev_u32 v218, 16384, v12
    v_subrev_u32 v219, 16384, v13
    v_mov_b32 v220, 162316
    v_mov_b32 v221, 1
    v_mov_b32 v222, 162304
    s_lshl_b32 s52, s58, 12
    s_add_u32 s53, s3, 5
    s_sub_u32 s54, s53, 10
    s_cmp_ge_u32 s53, 10
    s_cselect_b32 s53, s54, s53
    s_cmp_eq_u32 s60, 15
    s_cbranch_scc1 L_g_colsum
    s_cmp_ge_u32 s60, 10
    s_cbranch_scc1 L_g_v
    s_lshl_b32 s42, s60, 5
    s_lshl_b32 s43, s41, 4
    s_add_u32 s42, s42, s43
    s_lshl_b32 s48, s45, 10
    s_add_u32 s48, s48, s44
    s_lshl_b32 s49, s45, 8
    s_add_u32 s49, s49, s44
    s_add_u32 s49, s49, 8192
    v_lshlrev_b32 v48, 3, v60
    v_add_u32 v49, s49, v48
    v_add_u32 v48, s48, v48
    s_mov_b32 s50, 163840
    v_mov_b32 v50, 1024
    v_mov_b32 v51, 256
    s_add_u32 s43, s42, 0
    v_add_u32 v5, s43, v61
    v_mul_u32_u24 v6, 205, v5
    v_lshrrev_b32 v6, 10, v6
    v_mul_u32_u24 v7, 5, v6
    v_sub_u32 v7, v5, v7
    v_cmp_gt_u32 vcc, 4, v7
    v_lshl_add_u32 v5, v7, 8, v48
    s_nop 0
    v_cndmask_b32 v5, v49, v5, vcc
    v_cndmask_b32 v7, v51, v50, vcc
    v_mad_u32_u24 v96, v6, s50, v5
    v_add_u32 v97, v96, v7
    s_add_u32 s43, s42, 4
    v_add_u32 v5, s43, v61
    v_mul_u32_u24 v6, 205, v5
    v_lshrrev_b32 v6, 10, v6
    v_mul_u32_u24 v7, 5, v6
    v_sub_u32 v7, v5, v7
    v_cmp_gt_u32 vcc, 4, v7
    v_lshl_add_u32 v5, v7, 8, v48
    s_nop 0
    v_cndmask_b32 v5, v49, v5, vcc
    v_cndmask_b32 v7, v51, v50, vcc
    v_mad_u32_u24 v98, v6, s50, v5
    v_add_u32 v99, v98, v7
    s_add_u32 s43, s42, 8
    v_add_u32 v5, s43, v61
    v_mul_u32_u24 v6, 205, v5
    v_lshrrev_b32 v6, 10, v6
    v_mul_u32_u24 v7, 5, v6
    v_sub_u32 v7, v5, v7
    v_cmp_gt_u32 vcc, 4, v7
    v_lshl_add_u32 v5, v7, 8, v48
    s_nop 0
    v_cndmask_b32 v5, v49, v5, vcc
    v_cndmask_b32 v7, v51, v50, vcc
    v_mad_u32_u24 v100, v6, s50, v5
    v_add_u32 v101, v100, v7
    s_add_u32 s43, s42, 12
    v_add_u32 v5, s43, v61
    v_mul_u32_u24 v6, 205, v5
    v_lshrrev_b32 v6, 10, v6
    v_mul_u32_u24 v7, 5, v6
    v_sub_u32 v7, v5, v7
    v_cmp_gt_u32 vcc, 4, v7
    v_lshl_add_u32 v5, v7, 8, v48
    s_nop 0
    v_cndmask_b32 v5, v49, v5, vcc
    v_cndmask_b32 v7, v51, v50, vcc
    v_mad_u32_u24 v102, v6, s50, v5
    v_add_u32 v103, v102, v7
    s_cmp_lt_u32 s60, 5
    s_cselect_b32 s51, 0x3ea52b5c, 1.0
    v_mov_b32 v48, v8
    v_mov_b32 v49, v8
    v_mov_b32 v50, v9
    v_mov_b32 v51, v9
    s_waitcnt vmcnt(0)
    s_barrier
    ds_read_b64_tr_b16 v[32:33], v10 offset:0
    ds_read_b64_tr_b16 v[34:35], v10 offset:1024
    ds_read_b128 v[16:19], v8 offset:0
    ds_read_b128 v[20:23], v8 offset:2048
    ds_read_b128 v[24:27], v8 offset:4096
    ds_read_b128 v[28:31], v8 offset:6144
    ds_read_b64_tr_b16 v[36:37], v11 offset:0
    ds_read_b64_tr_b16 v[38:39], v11 offset:1024
    ds_read_b64_tr_b16 v[40:41], v12 offset:0
    ds_read_b64_tr_b16 v[42:43], v12 offset:1024
    ds_read_b64_tr_b16 v[44:45], v13 offset:0
    ds_read_b64_tr_b16 v[46:47], v13 offset:1024
    v_mov_b32 v56, 0x3f803f80
    v_mov_b32 v57, 0x3f803f80
    v_mov_b32 v58, 0x3f803f80
    v_mov_b32 v59, 0x3f803f80
    s_waitcnt lgkmcnt(6)
    v_mfma_f32_16x16x32_bf16 v[128:131], v[32:35], v[16:19], 0
    ds_read_b64_tr_b16 v[240:241], v10 offset:8192
    v_mfma_f32_16x16x32_bf16 v[144:147], v[32:35], v[20:23], 0
    ds_read_b64_tr_b16 v[242:243], v10 offset:9216
    v_mfma_f32_16x16x32_bf16 v[160:163], v[32:35], v[24:27], 0
    ds_read_b128 v[224:227], v9 offset:0
    v_mfma_f32_16x16x32_bf16 v[176:179], v[32:35], v[28:31], 0
    ds_read_b128 v[228:231], v9 offset:2048
    s_waitcnt lgkmcnt(8)
    v_mfma_f32_16x16x32_bf16 v[180:183], v[36:39], v[28:31], 0
    ds_read_b128 v[232:235], v9 offset:4096
    v_mfma_f32_16x16x32_bf16 v[164:167], v[36:39], v[24:27], 0
    ds_read_b128 v[236:239], v9 offset:6144
    v_mfma_f32_16x16x32_bf16 v[148:151], v[36:39], v[20:23], 0
    ds_read_b64_tr_b16 v[244:245], v11 offset:8192
    v_mfma_f32_16x16x32_bf16 v[132:135], v[36:39], v[16:19], 0
    ds_read_b64_tr_b16 v[246:247], v11 offset:9216
    s_waitcnt lgkmcnt(10)
    v_mfma_f32_16x16x32_bf16 v[136:139], v[40:43], v[16:19], 0
    ds_read_b64_tr_b16 v[248:249], v12 offset:8192
    v_mfma_f32_16x16x32_bf16 v[152:155], v[40:43], v[20:23], 0
    ds_read_b64_tr_b16 v[250:251], v12 offset:9216
    v_mfma_f32_16x16x32_bf16 v[168:171], v[40:43], v[24:27], 0
    ds_read_b64_tr_b16 v[252:253], v13 offset:8192
    v_mfma_f32_16x16x32_bf16 v[184:187], v[40:43], v[28:31], 0
    ds_read_b64_tr_b16 v[254:255], v13 offset:9216
    s_waitcnt lgkmcnt(12)
    v_mfma_f32_16x16x32_bf16 v[188:191], v[44:47], v[28:31], 0
    v_mfma_f32_16x16x32_bf16 v[172:175], v[44:47], v[24:27], 0
    v_mfma_f32_16x16x32_bf16 v[156:159], v[44:47], v[20:23], 0
    v_mfma_f32_16x16x32_bf16 v[140:143], v[44:47], v[16:19], 0
    v_mfma_f32_16x16x32_bf16 v[112:115], v[56:59], v[32:35], 0
    v_mfma_f32_16x16x32_bf16 v[116:119], v[56:59], v[36:39], 0
    v_mfma_f32_16x16x32_bf16 v[120:123], v[56:59], v[40:43], 0
    v_mfma_f32_16x16x32_bf16 v[124:127], v[56:59], v[44:47], 0
    s_waitcnt lgkmcnt(6)
    v_mfma_f32_16x16x32_bf16 v[128:131], v[240:243], v[224:227], v[128:131]
    v_mfma_f32_16x16x32_bf16 v[144:147], v[240:243], v[228:231], v[144:147]
    v_mfma_f32_16x16x32_bf16 v[160:163], v[240:243], v[232:235], v[160:163]
    s_waitcnt lgkmcnt(0)
    s_barrier
    v_mfma_f32_16x16x32_bf16 v[176:179], v[240:243], v[236:239], v[176:179]
    ds_read_b64_tr_b16 v[32:33], v10 offset:16384
    v_mfma_f32_16x16x32_bf16 v[180:183], v[244:247], v[236:239], v[180:183]
    ds_read_b64_tr_b16 v[34:35], v10 offset:17408
    v_mfma_f32_16x16x32_bf16 v[164:167], v[244:247], v[232:235], v[164:167]
    ds_read_b128 v[16:19], v8 offset:16384
    v_mfma_f32_16x16x32_bf16 v[148:151], v[244:247], v[228:231], v[148:151]
    ds_read_b128 v[20:23], v8 offset:18432
    v_mfma_f32_16x16x32_bf16 v[132:135], v[244:247], v[224:227], v[132:135]
    ds_read_b128 v[24:27], v8 offset:20480
    v_mfma_f32_16x16x32_bf16 v[136:139], v[248:251], v[224:227], v[136:139]
    ds_read_b128 v[28:31], v8 offset:22528
    v_mfma_f32_16x16x32_bf16 v[152:155], v[248:251], v[228:231], v[152:155]
    ds_read_b64_tr_b16 v[36:37], v11 offset:16384
    v_mfma_f32_16x16x32_bf16 v[168:171], v[248:251], v[232:235], v[168:171]
    ds_read_b64_tr_b16 v[38:39], v11 offset:17408
    v_mfma_f32_16x16x32_bf16 v[184:187], v[248:251], v[236:239], v[184:187]
    ds_read_b64_tr_b16 v[40:41], v12 offset:16384
    v_mfma_f32_16x16x32_bf16 v[188:191], v[252:255], v[236:239], v[188:191]
    ds_read_b64_tr_b16 v[42:43], v12 offset:17408
    v_mfma_f32_16x16x32_bf16 v[172:175], v[252:255], v[232:235], v[172:175]
    ds_read_b64_tr_b16 v[44:45], v13 offset:16384
    v_mfma_f32_16x16x32_bf16 v[156:159], v[252:255], v[228:231], v[156:159]
    ds_read_b64_tr_b16 v[46:47], v13 offset:17408
    v_mfma_f32_16x16x32_bf16 v[140:143], v[252:255], v[224:227], v[140:143]
    v_mfma_f32_16x16x32_bf16 v[112:115], v[56:59], v[240:243], v[112:115]
    v_mfma_f32_16x16x32_bf16 v[116:119], v[56:59], v[244:247], v[116:119]
    v_mfma_f32_16x16x32_bf16 v[120:123], v[56:59], v[248:251], v[120:123]
    v_mfma_f32_16x16x32_bf16 v[124:127], v[56:59], v[252:255], v[124:127]
    s_waitcnt lgkmcnt(0)
    v_mfma_f32_16x16x32_bf16 v[128:131], v[32:35], v[16:19], v[128:131]
    ds_read_b64_tr_b16 v[240:241], v10 offset:24576
    v_mfma_f32_16x16x32_bf16 v[144:147], v[32:35], v[20:23], v[144:147]
    ds_read_b64_tr_b16 v[242:243], v10 offset:25600
    v_mfma_f32_16x16x32_bf16 v[160:163], v[32:35], v[24:27], v[160:163]
    ds_read_b128 v[224:227], v9 offset:16384
    v_mfma_f32_16x16x32_bf16 v[176:179], v[32:35], v[28:31], v[176:179]
    ds_read_b128 v[228:231], v9 offset:18432
    v_mfma_f32_16x16x32_bf16 v[180:183], v[36:39], v[28:31], v[180:183]
    ds_read_b128 v[232:235], v9 offset:20480
    v_mfma_f32_16x16x32_bf16 v[164:167], v[36:39], v[24:27], v[164:167]
    ds_read_b128 v[236:239], v9 offset:22528
    v_mfma_f32_16x16x32_bf16 v[148:151], v[36:39], v[20:23], v[148:151]
    ds_read_b64_tr_b16 v[244:245], v11 offset:24576
    v_mfma_f32_16x16x32_bf16 v[132:135], v[36:39], v[16:19], v[132:135]
    ds_read_b64_tr_b16 v[246:247], v11 offset:25600
    v_mfma_f32_16x16x32_bf16 v[136:139], v[40:43], v[16:19], v[136:139]
    ds_read_b64_tr_b16 v[248:249], v12 offset:24576
    v_mfma_f32_16x16x32_bf16 v[152:155], v[40:43], v[20:23], v[152:155]
    ds_read_b64_tr_b16 v[250:251], v12 offset:25600
    v_mfma_f32_16x16x32_bf16 v[168:171], v[40:43], v[24:27], v[168:171]
    ds_read_b64_tr_b16 v[252:253], v13 offset:24576
    v_mfma_f32_16x16x32_bf16 v[184:187], v[40:43], v[28:31], v[184:187]
    ds_read_b64_tr_b16 v[254:255], v13 offset:25600
    v_mfma_f32_16x16x32_bf16 v[188:191], v[44:47], v[28:31], v[188:191]
    ds_write_b32 v63, v112 offset:0
    v_mfma_f32_16x16x32_bf16 v[172:175], v[44:47], v[24:27], v[172:175]
    ds_write_b32 v63, v116 offset:64
    v_mfma_f32_16x16x32_bf16 v[156:159], v[44:47], v[20:23], v[156:159]
    ds_write_b32 v63, v120 offset:128
    v_mfma_f32_16x16x32_bf16 v[140:143], v[44:47], v[16:19], v[140:143]
    ds_write_b32 v63, v124 offset:192
    s_waitcnt lgkmcnt(6)
    v_mfma_f32_16x16x32_bf16 v[128:131], v[240:243], v[224:227], v[128:131]
    v_mfma_f32_16x16x32_bf16 v[144:147], v[240:243], v[228:231], v[144:147]
    v_mfma_f32_16x16x32_bf16 v[160:163], v[240:243], v[232:235], v[160:163]
    s_waitcnt lgkmcnt(0)
    s_barrier
    v_mfma_f32_16x16x32_bf16 v[176:179], v[240:243], v[236:239], v[176:179]
    ds_read_b64_tr_b16 v[32:33], v10 offset:32768
    v_mfma_f32_16x16x32_bf16 v[180:183], v[244:247], v[236:239], v[180:183]
    ds_read_b64_tr_b16 v[34:35], v10 offset:33792
    v_mfma_f32_16x16x32_bf16 v[164:167], v[244:247], v[232:235], v[164:167]
    ds_read_b128 v[16:19], v8 offset:32768
    v_mfma_f32_16x16x32_bf16 v[148:151], v[244:247], v[228:231], v[148:151]
    ds_read_b128 v[20:23], v8 offset:34816
    v_mfma_f32_16x16x32_bf16 v[132:135], v[244:247], v[224:227], v[132:135]
    ds_read_b128 v[24:27], v8 offset:36864
    v_mfma_f32_16x16x32_bf16 v[136:139], v[248:251], v[224:227], v[136:139]
    ds_read_b128 v[28:31], v8 offset:38912
    v_mfma_f32_16x16x32_bf16 v[152:155], v[248:251], v[228:231], v[152:155]
    ds_read_b64_tr_b16 v[36:37], v11 offset:32768
    v_mfma_f32_16x16x32_bf16 v[168:171], v[248:251], v[232:235], v[168:171]
    ds_read_b64_tr_b16 v[38:39], v11 offset:33792
    v_mfma_f32_16x16x32_bf16 v[184:187], v[248:251], v[236:239], v[184:187]
    ds_read_b64_tr_b16 v[40:41], v12 offset:32768
    v_mfma_f32_16x16x32_bf16 v[188:191], v[252:255], v[236:239], v[188:191]
    ds_read_b64_tr_b16 v[42:43], v12 offset:33792
    v_mfma_f32_16x16x32_bf16 v[172:175], v[252:255], v[232:235], v[172:175]
    ds_read_b64_tr_b16 v[44:45], v13 offset:32768
    v_mfma_f32_16x16x32_bf16 v[156:159], v[252:255], v[228:231], v[156:159]
    ds_read_b64_tr_b16 v[46:47], v13 offset:33792
    v_mfma_f32_16x16x32_bf16 v[140:143], v[252:255], v[224:227], v[140:143]
    s_waitcnt lgkmcnt(6)
    v_mfma_f32_16x16x32_bf16 v[128:131], v[32:35], v[16:19], v[128:131]
    ds_read_b64_tr_b16 v[240:241], v10 offset:40960
    v_mfma_f32_16x16x32_bf16 v[144:147], v[32:35], v[20:23], v[144:147]
    ds_read_b64_tr_b16 v[242:243], v10 offset:41984
    v_mfma_f32_16x16x32_bf16 v[160:163], v[32:35], v[24:27], v[160:163]
    ds_read_b128 v[224:227], v9 offset:32768
    v_mfma_f32_16x16x32_bf16 v[176:179], v[32:35], v[28:31], v[176:179]
    ds_read_b128 v[228:231], v9 offset:34816
    s_waitcnt lgkmcnt(8)
    v_mfma_f32_16x16x32_bf16 v[180:183], v[36:39], v[28:31], v[180:183]
    ds_read_b128 v[232:235], v9 offset:36864
    v_mfma_f32_16x16x32_bf16 v[164:167], v[36:39], v[24:27], v[164:167]
    ds_read_b128 v[236:239], v9 offset:38912
    v_mfma_f32_16x16x32_bf16 v[148:151], v[36:39], v[20:23], v[148:151]
    ds_read_b64_tr_b16 v[244:245], v11 offset:40960
    v_mfma_f32_16x16x32_bf16 v[132:135], v[36:39], v[16:19], v[132:135]
    ds_read_b64_tr_b16 v[246:247], v11 offset:41984
    s_waitcnt lgkmcnt(10)
    v_mfma_f32_16x16x32_bf16 v[136:139], v[40:43], v[16:19], v[136:139]
    ds_read_b64_tr_b16 v[248:249], v12 offset:40960
    v_mfma_f32_16x16x32_bf16 v[152:155], v[40:43], v[20:23], v[152:155]
    ds_read_b64_tr_b16 v[250:251], v12 offset:41984
    v_mfma_f32_16x16x32_bf16 v[168:171], v[40:43], v[24:27], v[168:171]
    ds_read_b64_tr_b16 v[252:253], v13 offset:40960
    v_mfma_f32_16x16x32_bf16 v[184:187], v[40:43], v[28:31], v[184:187]
    ds_read_b64_tr_b16 v[254:255], v13 offset:41984
    s_waitcnt lgkmcnt(12)
    v_mfma_f32_16x16x32_bf16 v[188:191], v[44:47], v[28:31], v[188:191]
    v_mfma_f32_16x16x32_bf16 v[172:175], v[44:47], v[24:27], v[172:175]
    v_mfma_f32_16x16x32_bf16 v[156:159], v[44:47], v[20:23], v[156:159]
    v_mfma_f32_16x16x32_bf16 v[140:143], v[44:47], v[16:19], v[140:143]
    s_waitcnt lgkmcnt(6)
    v_mfma_f32_16x16x32_bf16 v[128:131], v[240:243], v[224:227], v[128:131]
    v_mfma_f32_16x16x32_bf16 v[144:147], v[240:243], v[228:231], v[144:147]
    v_mfma_f32_16x16x32_bf16 v[160:163], v[240:243], v[232:235], v[160:163]
    s_waitcnt lgkmcnt(0)
    s_barrier
    v_mfma_f32_16x16x32_bf16 v[176:179], v[240:243], v[236:239], v[176:179]
    ds_read_b64_tr_b16 v[32:33], v10 offset:49152
    v_mfma_f32_16x16x32_bf16 v[180:183], v[244:247], v[236:239], v[180:183]
    ds_read_b64_tr_b16 v[34:35], v10 offset:50176
    v_mfma_f32_16x16x32_bf16 v[164:167], v[244:247], v[232:235], v[164:167]
    ds_read_b128 v[16:19], v8 offset:49152
    v_mfma_f32_16x16x32_bf16 v[148:151], v[244:247], v[228:231], v[148:151]
    ds_read_b128 v[20:23], v8 offset:51200
    v_mfma_f32_16x16x32_bf16 v[132:135], v[244:247], v[224:227], v[132:135]
    ds_read_b128 v[24:27], v8 offset:53248
    v_mfma_f32_16x16x32_bf16 v[136:139], v[248:251], v[224:227], v[136:139]
    ds_read_b128 v[28:31], v8 offset:55296
    v_mfma_f32_16x16x32_bf16 v[152:155], v[248:251], v[228:231], v[152:155]
    ds_read_b64_tr_b16 v[36:37], v11 offset:49152
    v_mfma_f32_16x16x32_bf16 v[168:171], v[248:251], v[232:235], v[168:171]
    ds_read_b64_tr_b16 v[38:39], v11 offset:50176
    v_mfma_f32_16x16x32_bf16 v[184:187], v[248:251], v[236:239], v[184:187]
    ds_read_b64_tr_b16 v[40:41], v12 offset:49152
    v_mfma_f32_16x16x32_bf16 v[188:191], v[252:255], v[236:239], v[188:191]
    ds_read_b64_tr_b16 v[42:43], v12 offset:50176
    v_mfma_f32_16x16x32_bf16 v[172:175], v[252:255], v[232:235], v[172:175]
    ds_read_b64_tr_b16 v[44:45], v13 offset:49152
    v_mfma_f32_16x16x32_bf16 v[156:159], v[252:255], v[228:231], v[156:159]
    ds_read_b64_tr_b16 v[46:47], v13 offset:50176
    v_mfma_f32_16x16x32_bf16 v[140:143], v[252:255], v[224:227], v[140:143]
    s_waitcnt lgkmcnt(6)
    v_mfma_f32_16x16x32_bf16 v[128:131], v[32:35], v[16:19], v[128:131]
    ds_read_b64_tr_b16 v[240:241], v10 offset:57344
    v_mfma_f32_16x16x32_bf16 v[144:147], v[32:35], v[20:23], v[144:147]
    ds_read_b64_tr_b16 v[242:243], v10 offset:58368
    v_mfma_f32_16x16x32_bf16 v[160:163], v[32:35], v[24:27], v[160:163]
    ds_read_b128 v[224:227], v9 offset:49152
    v_mfma_f32_16x16x32_bf16 v[176:179], v[32:35], v[28:31], v[176:179]
    ds_read_b128 v[228:231], v9 offset:51200
    s_waitcnt lgkmcnt(8)
    v_mfma_f32_16x16x32_bf16 v[180:183], v[36:39], v[28:31], v[180:183]
    ds_read_b128 v[232:235], v9 offset:53248
    v_mfma_f32_16x16x32_bf16 v[164:167], v[36:39], v[24:27], v[164:167]
    ds_read_b128 v[236:239], v9 offset:55296
    v_mfma_f32_16x16x32_bf16 v[148:151], v[36:39], v[20:23], v[148:151]
    ds_read_b64_tr_b16 v[244:245], v11 offset:57344
    v_mfma_f32_16x16x32_bf16 v[132:135], v[36:39], v[16:19], v[132:135]
    ds_read_b64_tr_b16 v[246:247], v11 offset:58368
    s_waitcnt lgkmcnt(10)
    v_mfma_f32_16x16x32_bf16 v[136:139], v[40:43], v[16:19], v[136:139]
    ds_read_b64_tr_b16 v[248:249], v12 offset:57344
    v_mfma_f32_16x16x32_bf16 v[152:155], v[40:43], v[20:23], v[152:155]
    ds_read_b64_tr_b16 v[250:251], v12 offset:58368
    v_mfma_f32_16x16x32_bf16 v[168:171], v[40:43], v[24:27], v[168:171]
    ds_read_b64_tr_b16 v[252:253], v13 offset:57344
    v_mfma_f32_16x16x32_bf16 v[184:187], v[40:43], v[28:31], v[184:187]
    ds_read_b64_tr_b16 v[254:255], v13 offset:58368
    s_waitcnt lgkmcnt(12)
    v_mfma_f32_16x16x32_bf16 v[188:191], v[44:47], v[28:31], v[188:191]
    v_mfma_f32_16x16x32_bf16 v[172:175], v[44:47], v[24:27], v[172:175]
    v_mfma_f32_16x16x32_bf16 v[156:159], v[44:47], v[20:23], v[156:159]
    v_mfma_f32_16x16x32_bf16 v[140:143], v[44:47], v[16:19], v[140:143]
    s_waitcnt lgkmcnt(6)
    v_mfma_f32_16x16x32_bf16 v[128:131], v[240:243], v[224:227], v[128:131]
    v_mfma_f32_16x16x32_bf16 v[144:147], v[240:243], v[228:231], v[144:147]
    v_mfma_f32_16x16x32_bf16 v[160:163], v[240:243], v[232:235], v[160:163]
    s_waitcnt lgkmcnt(0)
    s_barrier
    v_mfma_f32_16x16x32_bf16 v[176:179], v[240:243], v[236:239], v[176:179]
    ds_read_b64_tr_b16 v[32:33], v10 offset:0
    v_mfma_f32_16x16x32_bf16 v[180:183], v[244:247], v[236:239], v[180:183]
    ds_read_b64_tr_b16 v[34:35], v10 offset:1024
    v_mfma_f32_16x16x32_bf16 v[164:167], v[244:247], v[232:235], v[164:167]
    ds_read_b128 v[16:19], v8 offset:0
    v_mfma_f32_16x16x32_bf16 v[148:151], v[244:247], v[228:231], v[148:151]
    ds_read_b128 v[20:23], v8 offset:2048
    v_mfma_f32_16x16x32_bf16 v[132:135], v[244:247], v[224:227], v[132:135]
    ds_read_b128 v[24:27], v8 offset:4096
    v_mfma_f32_16x16x32_bf16 v[136:139], v[248:251], v[224:227], v[136:139]
    ds_read_b128 v[28:31], v8 offset:6144
    v_mfma_f32_16x16x32_bf16 v[152:155], v[248:251], v[228:231], v[152:155]
    ds_read_b64_tr_b16 v[36:37], v11 offset:0
    v_mfma_f32_16x16x32_bf16 v[168:171], v[248:251], v[232:235], v[168:171]
    ds_read_b64_tr_b16 v[38:39], v11 offset:1024
    v_mfma_f32_16x16x32_bf16 v[184:187], v[248:251], v[236:239], v[184:187]
    ds_read_b64_tr_b16 v[40:41], v12 offset:0
    v_mfma_f32_16x16x32_bf16 v[188:191], v[252:255], v[236:239], v[188:191]
    ds_read_b64_tr_b16 v[42:43], v12 offset:1024
    v_mfma_f32_16x16x32_bf16 v[172:175], v[252:255], v[232:235], v[172:175]
    ds_read_b64_tr_b16 v[44:45], v13 offset:0
    v_mfma_f32_16x16x32_bf16 v[156:159], v[252:255], v[228:231], v[156:159]
    ds_read_b64_tr_b16 v[46:47], v13 offset:1024
    v_mfma_f32_16x16x32_bf16 v[140:143], v[252:255], v[224:227], v[140:143]
    s_waitcnt lgkmcnt(6)
    v_mfma_f32_16x16x32_bf16 v[128:131], v[32:35], v[16:19], v[128:131]
    ds_read_b64_tr_b16 v[240:241], v10 offset:8192
    v_mfma_f32_16x16x32_bf16 v[144:147], v[32:35], v[20:23], v[144:147]
    ds_read_b64_tr_b16 v[242:243], v10 offset:9216
    v_mfma_f32_16x16x32_bf16 v[160:163], v[32:35], v[24:27], v[160:163]
    ds_read_b128 v[224:227], v9 offset:0
    v_mfma_f32_16x16x32_bf16 v[176:179], v[32:35], v[28:31], v[176:179]
    ds_read_b128 v[228:231], v9 offset:2048
    s_waitcnt lgkmcnt(8)
    v_mfma_f32_16x16x32_bf16 v[180:183], v[36:39], v[28:31], v[180:183]
    ds_read_b128 v[232:235], v9 offset:4096
    v_mfma_f32_16x16x32_bf16 v[164:167], v[36:39], v[24:27], v[164:167]
    ds_read_b128 v[236:239], v9 offset:6144
    v_mfma_f32_16x16x32_bf16 v[148:151], v[36:39], v[20:23], v[148:151]
    ds_read_b64_tr_b16 v[244:245], v11 offset:8192
    v_mfma_f32_16x16x32_bf16 v[132:135], v[36:39], v[16:19], v[132:135]
    ds_read_b64_tr_b16 v[246:247], v11 offset:9216
    s_waitcnt lgkmcnt(10)
    v_mfma_f32_16x16x32_bf16 v[136:139], v[40:43], v[16:19], v[136:139]
    ds_read_b64_tr_b16 v[248:249], v12 offset:8192
    v_mfma_f32_16x16x32_bf16 v[152:155], v[40:43], v[20:23], v[152:155]
    ds_read_b64_tr_b16 v[250:251], v12 offset:9216
    v_mfma_f32_16x16x32_bf16 v[168:171], v[40:43], v[24:27], v[168:171]
    ds_read_b64_tr_b16 v[252:253], v13 offset:8192
    v_mfma_f32_16x16x32_bf16 v[184:187], v[40:43], v[28:31], v[184:187]
    ds_read_b64_tr_b16 v[254:255], v13 offset:9216
    s_waitcnt lgkmcnt(12)
    v_mfma_f32_16x16x32_bf16 v[188:191], v[44:47], v[28:31], v[188:191]
    v_mfma_f32_16x16x32_bf16 v[172:175], v[44:47], v[24:27], v[172:175]
    v_mfma_f32_16x16x32_bf16 v[156:159], v[44:47], v[20:23], v[156:159]
    v_mfma_f32_16x16x32_bf16 v[140:143], v[44:47], v[16:19], v[140:143]
    s_waitcnt lgkmcnt(6)
    v_mfma_f32_16x16x32_bf16 v[128:131], v[240:243], v[224:227], v[128:131]
    v_mfma_f32_16x16x32_bf16 v[144:147], v[240:243], v[228:231], v[144:147]
    v_mfma_f32_16x16x32_bf16 v[160:163], v[240:243], v[232:235], v[160:163]
    s_waitcnt lgkmcnt(0)
    s_barrier
    v_mfma_f32_16x16x32_bf16 v[176:179], v[240:243], v[236:239], v[176:179]
    ds_read_b64_tr_b16 v[32:33], v10 offset:16384
    v_mfma_f32_16x16x32_bf16 v[180:183], v[244:247], v[236:239], v[180:183]
    ds_read_b64_tr_b16 v[34:35], v10 offset:17408
    v_mfma_f32_16x16x32_bf16 v[164:167], v[244:247], v[232:235], v[164:167]
    ds_read_b128 v[16:19], v8 offset:16384
    v_mfma_f32_16x16x32_bf16 v[148:151], v[244:247], v[228:231], v[148:151]
    ds_read_b128 v[20:23], v8 offset:18432
    v_mfma_f32_16x16x32_bf16 v[132:135], v[244:247], v[224:227], v[132:135]
    ds_read_b128 v[24:27], v8 offset:20480
    v_mfma_f32_16x16x32_bf16 v[136:139], v[248:251], v[224:227], v[136:139]
    ds_read_b128 v[28:31], v8 offset:22528
    v_mfma_f32_16x16x32_bf16 v[152:155], v[248:251], v[228:231], v[152:155]
    ds_read_b64_tr_b16 v[36:37], v11 offset:16384
    v_mfma_f32_16x16x32_bf16 v[168:171], v[248:251], v[232:235], v[168:171]
    ds_read_b64_tr_b16 v[38:39], v11 offset:17408
    v_mfma_f32_16x16x32_bf16 v[184:187], v[248:251], v[236:239], v[184:187]
    ds_read_b64_tr_b16 v[40:41], v12 offset:16384
    v_mfma_f32_16x16x32_bf16 v[188:191], v[252:255], v[236:239], v[188:191]
    ds_read_b64_tr_b16 v[42:43], v12 offset:17408
    v_mfma_f32_16x16x32_bf16 v[172:175], v[252:255], v[232:235], v[172:175]
    ds_read_b64_tr_b16 v[44:45], v13 offset:16384
    v_mfma_f32_16x16x32_bf16 v[156:159], v[252:255], v[228:231], v[156:159]
    ds_read_b64_tr_b16 v[46:47], v13 offset:17408
    v_mfma_f32_16x16x32_bf16 v[140:143], v[252:255], v[224:227], v[140:143]
    s_waitcnt lgkmcnt(6)
    v_mfma_f32_16x16x32_bf16 v[128:131], v[32:35], v[16:19], v[128:131]
    ds_read_b64_tr_b16 v[240:241], v10 offset:24576
    v_mfma_f32_16x16x32_bf16 v[144:147], v[32:35], v[20:23], v[144:147]
    ds_read_b64_tr_b16 v[242:243], v10 offset:25600
    v_mfma_f32_16x16x32_bf16 v[160:163], v[32:35], v[24:27], v[160:163]
    ds_read_b128 v[224:227], v9 offset:16384
    v_mfma_f32_16x16x32_bf16 v[176:179], v[32:35], v[28:31], v[176:179]
    ds_read_b128 v[228:231], v9 offset:18432
    s_waitcnt lgkmcnt(8)
    v_mfma_f32_16x16x32_bf16 v[180:183], v[36:39], v[28:31], v[180:183]
    ds_read_b128 v[232:235], v9 offset:20480
    v_mfma_f32_16x16x32_bf16 v[164:167], v[36:39], v[24:27], v[164:167]
    ds_read_b128 v[236:239], v9 offset:22528
    v_mfma_f32_16x16x32_bf16 v[148:151], v[36:39], v[20:23], v[148:151]
    ds_read_b64_tr_b16 v[244:245], v11 offset:24576
    v_mfma_f32_16x16x32_bf16 v[132:135], v[36:39], v[16:19], v[132:135]
    ds_read_b64_tr_b16 v[246:247], v11 offset:25600
    s_waitcnt lgkmcnt(10)
    v_mfma_f32_16x16x32_bf16 v[136:139], v[40:43], v[16:19], v[136:139]
    ds_read_b64_tr_b16 v[248:249], v12 offset:24576
    v_mfma_f32_16x16x32_bf16 v[152:155], v[40:43], v[20:23], v[152:155]
    ds_read_b64_tr_b16 v[250:251], v12 offset:25600
    v_mfma_f32_16x16x32_bf16 v[168:171], v[40:43], v[24:27], v[168:171]
    ds_read_b64_tr_b16 v[252:253], v13 offset:24576
    v_mfma_f32_16x16x32_bf16 v[184:187], v[40:43], v[28:31], v[184:187]
    ds_read_b64_tr_b16 v[254:255], v13 offset:25600
    s_waitcnt lgkmcnt(12)
    v_mfma_f32_16x16x32_bf16 v[188:191], v[44:47], v[28:31], v[188:191]
    v_mfma_f32_16x16x32_bf16 v[172:175], v[44:47], v[24:27], v[172:175]
    v_mfma_f32_16x16x32_bf16 v[156:159], v[44:47], v[20:23], v[156:159]
    v_mfma_f32_16x16x32_bf16 v[140:143], v[44:47], v[16:19], v[140:143]
    s_waitcnt lgkmcnt(6)
    v_mfma_f32_16x16x32_bf16 v[128:131], v[240:243], v[224:227], v[128:131]
    v_mfma_f32_16x16x32_bf16 v[144:147], v[240:243], v[228:231], v[144:147]
    v_mfma_f32_16x16x32_bf16 v[160:163], v[240:243], v[232:235], v[160:163]
    s_waitcnt lgkmcnt(0)
    s_barrier
    v_mfma_f32_16x16x32_bf16 v[176:179], v[240:243], v[236:239], v[176:179]
    ds_read_b64_tr_b16 v[32:33], v10 offset:32768
    v_mfma_f32_16x16x32_bf16 v[180:183], v[244:247], v[236:239], v[180:183]
    ds_read_b64_tr_b16 v[34:35], v10 offset:33792
    v_mfma_f32_16x16x32_bf16 v[164:167], v[244:247], v[232:235], v[164:167]
    ds_read_b128 v[16:19], v8 offset:32768
    v_mfma_f32_16x16x32_bf16 v[148:151], v[244:247], v[228:231], v[148:151]
    ds_read_b128 v[20:23], v8 offset:34816
    v_mfma_f32_16x16x32_bf16 v[132:135], v[244:247], v[224:227], v[132:135]
    ds_read_b128 v[24:27], v8 offset:36864
    v_mfma_f32_16x16x32_bf16 v[136:139], v[248:251], v[224:227], v[136:139]
    ds_read_b128 v[28:31], v8 offset:38912
    v_mfma_f32_16x16x32_bf16 v[152:155], v[248:251], v[228:231], v[152:155]
    ds_read_b64_tr_b16 v[36:37], v11 offset:32768
    v_mfma_f32_16x16x32_bf16 v[168:171], v[248:251], v[232:235], v[168:171]
    ds_read_b64_tr_b16 v[38:39], v11 offset:33792
    v_mfma_f32_16x16x32_bf16 v[184:187], v[248:251], v[236:239], v[184:187]
    ds_read_b64_tr_b16 v[40:41], v12 offset:32768
    v_mfma_f32_16x16x32_bf16 v[188:191], v[252:255], v[236:239], v[188:191]
    ds_read_b64_tr_b16 v[42:43], v12 offset:33792
    v_mfma_f32_16x16x32_bf16 v[172:175], v[252:255], v[232:235], v[172:175]
    ds_read_b64_tr_b16 v[44:45], v13 offset:32768
    v_mfma_f32_16x16x32_bf16 v[156:159], v[252:255], v[228:231], v[156:159]
    ds_read_b64_tr_b16 v[46:47], v13 offset:33792
    v_mfma_f32_16x16x32_bf16 v[140:143], v[252:255], v[224:227], v[140:143]
    s_waitcnt lgkmcnt(6)
    v_mfma_f32_16x16x32_bf16 v[128:131], v[32:35], v[16:19], v[128:131]
    ds_read_b64_tr_b16 v[240:241], v10 offset:40960
    v_mfma_f32_16x16x32_bf16 v[144:147], v[32:35], v[20:23], v[144:147]
    ds_read_b64_tr_b16 v[242:243], v10 offset:41984
    v_mfma_f32_16x16x32_bf16 v[160:163], v[32:35], v[24:27], v[160:163]
    ds_read_b128 v[224:227], v9 offset:32768
    v_mfma_f32_16x16x32_bf16 v[176:179], v[32:35], v[28:31], v[176:179]
    ds_read_b128 v[228:231], v9 offset:34816
    s_waitcnt lgkmcnt(8)
    v_mfma_f32_16x16x32_bf16 v[180:183], v[36:39], v[28:31], v[180:183]
    ds_read_b128 v[232:235], v9 offset:36864
    v_mfma_f32_16x16x32_bf16 v[164:167], v[36:39], v[24:27], v[164:167]
    ds_read_b128 v[236:239], v9 offset:38912
    v_mfma_f32_16x16x32_bf16 v[148:151], v[36:39], v[20:23], v[148:151]
    ds_read_b64_tr_b16 v[244:245], v11 offset:40960
    v_mfma_f32_16x16x32_bf16 v[132:135], v[36:39], v[16:19], v[132:135]
    ds_read_b64_tr_b16 v[246:247], v11 offset:41984
    s_waitcnt lgkmcnt(10)
    v_mfma_f32_16x16x32_bf16 v[136:139], v[40:43], v[16:19], v[136:139]
    ds_read_b64_tr_b16 v[248:249], v12 offset:40960
    v_mfma_f32_16x16x32_bf16 v[152:155], v[40:43], v[20:23], v[152:155]
    ds_read_b64_tr_b16 v[250:251], v12 offset:41984
    v_mfma_f32_16x16x32_bf16 v[168:171], v[40:43], v[24:27], v[168:171]
    ds_read_b64_tr_b16 v[252:253], v13 offset:40960
    v_mfma_f32_16x16x32_bf16 v[184:187], v[40:43], v[28:31], v[184:187]
    ds_read_b64_tr_b16 v[254:255], v13 offset:41984
    s_waitcnt lgkmcnt(12)
    v_mfma_f32_16x16x32_bf16 v[188:191], v[44:47], v[28:31], v[188:191]
    v_mfma_f32_16x16x32_bf16 v[172:175], v[44:47], v[24:27], v[172:175]
    v_mfma_f32_16x16x32_bf16 v[156:159], v[44:47], v[20:23], v[156:159]
    v_mfma_f32_16x16x32_bf16 v[140:143], v[44:47], v[16:19], v[140:143]
    s_waitcnt lgkmcnt(6)
    v_mfma_f32_16x16x32_bf16 v[128:131], v[240:243], v[224:227], v[128:131]
    v_mfma_f32_16x16x32_bf16 v[144:147], v[240:243], v[228:231], v[144:147]
    v_mfma_f32_16x16x32_bf16 v[160:163], v[240:243], v[232:235], v[160:163]
    s_waitcnt lgkmcnt(0)
    s_barrier
    v_mfma_f32_16x16x32_bf16 v[176:179], v[240:243], v[236:239], v[176:179]
    ds_read_b64_tr_b16 v[32:33], v10 offset:49152
    v_mfma_f32_16x16x32_bf16 v[180:183], v[244:247], v[236:239], v[180:183]
    ds_read_b64_tr_b16 v[34:35], v10 offset:50176
    v_mfma_f32_16x16x32_bf16 v[164:167], v[244:247], v[232:235], v[164:167]
    ds_read_b128 v[16:19], v8 offset:49152
    v_mfma_f32_16x16x32_bf16 v[148:151], v[244:247], v[228:231], v[148:151]
    ds_read_b128 v[20:23], v8 offset:51200
    v_mfma_f32_16x16x32_bf16 v[132:135], v[244:247], v[224:227], v[132:135]
    ds_read_b128 v[24:27], v8 offset:53248
    v_mfma_f32_16x16x32_bf16 v[136:139], v[248:251], v[224:227], v[136:139]
    ds_read_b128 v[28:31], v8 offset:55296
    v_mfma_f32_16x16x32_bf16 v[152:155], v[248:251], v[228:231], v[152:155]
    ds_read_b64_tr_b16 v[36:37], v11 offset:49152
    v_mfma_f32_16x16x32_bf16 v[168:171], v[248:251], v[232:235], v[168:171]
    ds_read_b64_tr_b16 v[38:39], v11 offset:50176
    v_mfma_f32_16x16x32_bf16 v[184:187], v[248:251], v[236:239], v[184:187]
    ds_read_b64_tr_b16 v[40:41], v12 offset:49152
    v_mfma_f32_16x16x32_bf16 v[188:191], v[252:255], v[236:239], v[188:191]
    ds_read_b64_tr_b16 v[42:43], v12 offset:50176
    v_mfma_f32_16x16x32_bf16 v[172:175], v[252:255], v[232:235], v[172:175]
    ds_read_b64_tr_b16 v[44:45], v13 offset:49152
    v_mfma_f32_16x16x32_bf16 v[156:159], v[252:255], v[228:231], v[156:159]
    ds_read_b64_tr_b16 v[46:47], v13 offset:50176
    v_mfma_f32_16x16x32_bf16 v[140:143], v[252:255], v[224:227], v[140:143]
    s_waitcnt lgkmcnt(6)
    v_mfma_f32_16x16x32_bf16 v[128:131], v[32:35], v[16:19], v[128:131]
    ds_read_b64_tr_b16 v[240:241], v10 offset:57344
    v_mfma_f32_16x16x32_bf16 v[144:147], v[32:35], v[20:23], v[144:147]
    ds_read_b64_tr_b16 v[242:243], v10 offset:58368
    v_mfma_f32_16x16x32_bf16 v[160:163], v[32:35], v[24:27], v[160:163]
    ds_read_b128 v[224:227], v9 offset:49152
    v_mfma_f32_16x16x32_bf16 v[176:179], v[32:35], v[28:31], v[176:179]
    ds_read_b128 v[228:231], v9 offset:51200
    s_waitcnt lgkmcnt(8)
    v_mfma_f32_16x16x32_bf16 v[180:183], v[36:39], v[28:31], v[180:183]
    ds_read_b128 v[232:235], v9 offset:53248
    v_mfma_f32_16x16x32_bf16 v[164:167], v[36:39], v[24:27], v[164:167]
    ds_read_b128 v[236:239], v9 offset:55296
    v_mfma_f32_16x16x32_bf16 v[148:151], v[36:39], v[20:23], v[148:151]
    ds_read_b64_tr_b16 v[244:245], v11 offset:57344
    v_mfma_f32_16x16x32_bf16 v[132:135], v[36:39], v[16:19], v[132:135]
    ds_read_b64_tr_b16 v[246:247], v11 offset:58368
    s_waitcnt lgkmcnt(10)
    v_mfma_f32_16x16x32_bf16 v[136:139], v[40:43], v[16:19], v[136:139]
    ds_read_b64_tr_b16 v[248:249], v12 offset:57344
    v_mfma_f32_16x16x32_bf16 v[152:155], v[40:43], v[20:23], v[152:155]
    ds_read_b64_tr_b16 v[250:251], v12 offset:58368
    v_mfma_f32_16x16x32_bf16 v[168:171], v[40:43], v[24:27], v[168:171]
    ds_read_b64_tr_b16 v[252:253], v13 offset:57344
    v_mfma_f32_16x16x32_bf16 v[184:187], v[40:43], v[28:31], v[184:187]
    ds_read_b64_tr_b16 v[254:255], v13 offset:58368
    s_waitcnt lgkmcnt(12)
    v_mfma_f32_16x16x32_bf16 v[188:191], v[44:47], v[28:31], v[188:191]
    v_mfma_f32_16x16x32_bf16 v[172:175], v[44:47], v[24:27], v[172:175]
    v_mfma_f32_16x16x32_bf16 v[156:159], v[44:47], v[20:23], v[156:159]
    v_mfma_f32_16x16x32_bf16 v[140:143], v[44:47], v[16:19], v[140:143]
    s_waitcnt lgkmcnt(6)
    v_mfma_f32_16x16x32_bf16 v[128:131], v[240:243], v[224:227], v[128:131]
    v_mfma_f32_16x16x32_bf16 v[144:147], v[240:243], v[228:231], v[144:147]
    v_mfma_f32_16x16x32_bf16 v[160:163], v[240:243], v[232:235], v[160:163]
    s_waitcnt lgkmcnt(0)
    s_barrier
    v_mfma_f32_16x16x32_bf16 v[176:179], v[240:243], v[236:239], v[176:179]
    ds_read_b64_tr_b16 v[32:33], v10 offset:0
    v_mfma_f32_16x16x32_bf16 v[180:183], v[244:247], v[236:239], v[180:183]
    ds_read_b64_tr_b16 v[34:35], v10 offset:1024
    v_mfma_f32_16x16x32_bf16 v[164:167], v[244:247], v[232:235], v[164:167]
    ds_read_b128 v[16:19], v8 offset:0
    v_mfma_f32_16x16x32_bf16 v[148:151], v[244:247], v[228:231], v[148:151]
    ds_read_b128 v[20:23], v8 offset:2048
    v_mfma_f32_16x16x32_bf16 v[132:135], v[244:247], v[224:227], v[132:135]
    ds_read_b128 v[24:27], v8 offset:4096
    v_mfma_f32_16x16x32_bf16 v[136:139], v[248:251], v[224:227], v[136:139]
    ds_read_b128 v[28:31], v8 offset:6144
    v_mfma_f32_16x16x32_bf16 v[152:155], v[248:251], v[228:231], v[152:155]
    ds_read_b64_tr_b16 v[36:37], v11 offset:0
    v_mfma_f32_16x16x32_bf16 v[168:171], v[248:251], v[232:235], v[168:171]
    ds_read_b64_tr_b16 v[38:39], v11 offset:1024
    v_mfma_f32_16x16x32_bf16 v[184:187], v[248:251], v[236:239], v[184:187]
    ds_read_b64_tr_b16 v[40:41], v12 offset:0
    v_mfma_f32_16x16x32_bf16 v[188:191], v[252:255], v[236:239], v[188:191]
    ds_read_b64_tr_b16 v[42:43], v12 offset:1024
    v_mfma_f32_16x16x32_bf16 v[172:175], v[252:255], v[232:235], v[172:175]
    ds_read_b64_tr_b16 v[44:45], v13 offset:0
    v_mfma_f32_16x16x32_bf16 v[156:159], v[252:255], v[228:231], v[156:159]
    ds_read_b64_tr_b16 v[46:47], v13 offset:1024
    v_mfma_f32_16x16x32_bf16 v[140:143], v[252:255], v[224:227], v[140:143]
    s_waitcnt lgkmcnt(6)
    v_mfma_f32_16x16x32_bf16 v[128:131], v[32:35], v[16:19], v[128:131]
    ds_read_b64_tr_b16 v[240:241], v10 offset:8192
    v_mfma_f32_16x16x32_bf16 v[144:147], v[32:35], v[20:23], v[144:147]
    ds_read_b64_tr_b16 v[242:243], v10 offset:9216
    v_mfma_f32_16x16x32_bf16 v[160:163], v[32:35], v[24:27], v[160:163]
    ds_read_b128 v[224:227], v9 offset:0
    v_mfma_f32_16x16x32_bf16 v[176:179], v[32:35], v[28:31], v[176:179]
    ds_read_b128 v[228:231], v9 offset:2048
    s_waitcnt lgkmcnt(8)
    v_mfma_f32_16x16x32_bf16 v[180:183], v[36:39], v[28:31], v[180:183]
    ds_read_b128 v[232:235], v9 offset:4096
    v_mfma_f32_16x16x32_bf16 v[164:167], v[36:39], v[24:27], v[164:167]
    ds_read_b128 v[236:239], v9 offset:6144
    v_mfma_f32_16x16x32_bf16 v[148:151], v[36:39], v[20:23], v[148:151]
    ds_read_b64_tr_b16 v[244:245], v11 offset:8192
    v_mfma_f32_16x16x32_bf16 v[132:135], v[36:39], v[16:19], v[132:135]
    ds_read_b64_tr_b16 v[246:247], v11 offset:9216
    s_waitcnt lgkmcnt(10)
    v_mfma_f32_16x16x32_bf16 v[136:139], v[40:43], v[16:19], v[136:139]
    ds_read_b64_tr_b16 v[248:249], v12 offset:8192
    v_mfma_f32_16x16x32_bf16 v[152:155], v[40:43], v[20:23], v[152:155]
    ds_read_b64_tr_b16 v[250:251], v12 offset:9216
    v_mfma_f32_16x16x32_bf16 v[168:171], v[40:43], v[24:27], v[168:171]
    ds_read_b64_tr_b16 v[252:253], v13 offset:8192
    v_mfma_f32_16x16x32_bf16 v[184:187], v[40:43], v[28:31], v[184:187]
    ds_read_b64_tr_b16 v[254:255], v13 offset:9216
    s_waitcnt lgkmcnt(12)
    v_mfma_f32_16x16x32_bf16 v[188:191], v[44:47], v[28:31], v[188:191]
    v_mfma_f32_16x16x32_bf16 v[172:175], v[44:47], v[24:27], v[172:175]
    v_mfma_f32_16x16x32_bf16 v[156:159], v[44:47], v[20:23], v[156:159]
    v_mfma_f32_16x16x32_bf16 v[140:143], v[44:47], v[16:19], v[140:143]
    s_waitcnt lgkmcnt(6)
    v_mfma_f32_16x16x32_bf16 v[128:131], v[240:243], v[224:227], v[128:131]
    v_mfma_f32_16x16x32_bf16 v[144:147], v[240:243], v[228:231], v[144:147]
    v_mfma_f32_16x16x32_bf16 v[160:163], v[240:243], v[232:235], v[160:163]
    s_waitcnt lgkmcnt(0)
    s_barrier
    v_mfma_f32_16x16x32_bf16 v[176:179], v[240:243], v[236:239], v[176:179]
    ds_read_b64_tr_b16 v[32:33], v10 offset:16384
    v_mfma_f32_16x16x32_bf16 v[180:183], v[244:247], v[236:239], v[180:183]
    ds_read_b64_tr_b16 v[34:35], v10 offset:17408
    v_mfma_f32_16x16x32_bf16 v[164:167], v[244:247], v[232:235], v[164:167]
    ds_read_b128 v[16:19], v8 offset:16384
    v_mfma_f32_16x16x32_bf16 v[148:151], v[244:247], v[228:231], v[148:151]
    ds_read_b128 v[20:23], v8 offset:18432
    v_mfma_f32_16x16x32_bf16 v[132:135], v[244:247], v[224:227], v[132:135]
    ds_read_b128 v[24:27], v8 offset:20480
    v_mfma_f32_16x16x32_bf16 v[136:139], v[248:251], v[224:227], v[136:139]
    ds_read_b128 v[28:31], v8 offset:22528
    v_mfma_f32_16x16x32_bf16 v[152:155], v[248:251], v[228:231], v[152:155]
    ds_read_b64_tr_b16 v[36:37], v11 offset:16384
    v_mfma_f32_16x16x32_bf16 v[168:171], v[248:251], v[232:235], v[168:171]
    ds_read_b64_tr_b16 v[38:39], v11 offset:17408
    v_mfma_f32_16x16x32_bf16 v[184:187], v[248:251], v[236:239], v[184:187]
    ds_read_b64_tr_b16 v[40:41], v12 offset:16384
    v_mfma_f32_16x16x32_bf16 v[188:191], v[252:255], v[236:239], v[188:191]
    ds_read_b64_tr_b16 v[42:43], v12 offset:17408
    v_mfma_f32_16x16x32_bf16 v[172:175], v[252:255], v[232:235], v[172:175]
    ds_read_b64_tr_b16 v[44:45], v13 offset:16384
    v_mfma_f32_16x16x32_bf16 v[156:159], v[252:255], v[228:231], v[156:159]
    ds_read_b64_tr_b16 v[46:47], v13 offset:17408
    v_mfma_f32_16x16x32_bf16 v[140:143], v[252:255], v[224:227], v[140:143]
    s_waitcnt lgkmcnt(6)
    v_mfma_f32_16x16x32_bf16 v[128:131], v[32:35], v[16:19], v[128:131]
    ds_read_b64_tr_b16 v[240:241], v10 offset:24576
    v_mfma_f32_16x16x32_bf16 v[144:147], v[32:35], v[20:23], v[144:147]
    ds_read_b64_tr_b16 v[242:243], v10 offset:25600
    v_mfma_f32_16x16x32_bf16 v[160:163], v[32:35], v[24:27], v[160:163]
    ds_read_b128 v[224:227], v9 offset:16384
    v_mfma_f32_16x16x32_bf16 v[176:179], v[32:35], v[28:31], v[176:179]
    ds_read_b128 v[228:231], v9 offset:18432
    s_waitcnt lgkmcnt(8)
    v_mfma_f32_16x16x32_bf16 v[180:183], v[36:39], v[28:31], v[180:183]
    ds_read_b128 v[232:235], v9 offset:20480
    v_mfma_f32_16x16x32_bf16 v[164:167], v[36:39], v[24:27], v[164:167]
    ds_read_b128 v[236:239], v9 offset:22528
    v_mfma_f32_16x16x32_bf16 v[148:151], v[36:39], v[20:23], v[148:151]
    ds_read_b64_tr_b16 v[244:245], v11 offset:24576
    v_mfma_f32_16x16x32_bf16 v[132:135], v[36:39], v[16:19], v[132:135]
    ds_read_b64_tr_b16 v[246:247], v11 offset:25600
    s_waitcnt lgkmcnt(10)
    v_mfma_f32_16x16x32_bf16 v[136:139], v[40:43], v[16:19], v[136:139]
    ds_read_b64_tr_b16 v[248:249], v12 offset:24576
    v_mfma_f32_16x16x32_bf16 v[152:155], v[40:43], v[20:23], v[152:155]
    ds_read_b64_tr_b16 v[250:251], v12 offset:25600
    v_mfma_f32_16x16x32_bf16 v[168:171], v[40:43], v[24:27], v[168:171]
    ds_read_b64_tr_b16 v[252:253], v13 offset:24576
    v_mfma_f32_16x16x32_bf16 v[184:187], v[40:43], v[28:31], v[184:187]
    ds_read_b64_tr_b16 v[254:255], v13 offset:25600
    s_waitcnt lgkmcnt(12)
    v_mfma_f32_16x16x32_bf16 v[188:191], v[44:47], v[28:31], v[188:191]
    v_mfma_f32_16x16x32_bf16 v[172:175], v[44:47], v[24:27], v[172:175]
    v_mfma_f32_16x16x32_bf16 v[156:159], v[44:47], v[20:23], v[156:159]
    v_mfma_f32_16x16x32_bf16 v[140:143], v[44:47], v[16:19], v[140:143]
    s_waitcnt lgkmcnt(6)
    v_mfma_f32_16x16x32_bf16 v[128:131], v[240:243], v[224:227], v[128:131]
    v_mfma_f32_16x16x32_bf16 v[144:147], v[240:243], v[228:231], v[144:147]
    v_mfma_f32_16x16x32_bf16 v[160:163], v[240:243], v[232:235], v[160:163]
    s_waitcnt lgkmcnt(0)
    s_barrier
    ds_read_b128 v[64:67], v62 offset:0
    ds_read_b128 v[68:71], v62 offset:64
    ds_read_b128 v[72:75], v62 offset:128
    ds_read_b128 v[76:79], v62 offset:192
    ds_read_b32 v80, v15 offset:0
    ds_read_b32 v82, v15 offset:512
    ds_read_b32 v84, v15 offset:64
    ds_read_b32 v86, v15 offset:576
    ds_read_b32 v88, v15 offset:128
    ds_read_b32 v90, v15 offset:640
    ds_read_b32 v92, v15 offset:192
    ds_read_b32 v94, v15 offset:704
    s_cmp_eq_u32 s61, 15
    s_cbranch_scc1 L_g45
    v_mfma_f32_16x16x32_bf16 v[176:179], v[240:243], v[236:239], v[176:179]
    ds_read_b64_tr_b16 v[32:33], v10 offset:32768
    v_mfma_f32_16x16x32_bf16 v[180:183], v[244:247], v[236:239], v[180:183]
    ds_read_b64_tr_b16 v[34:35], v10 offset:33792
    v_mfma_f32_16x16x32_bf16 v[164:167], v[244:247], v[232:235], v[164:167]
    ds_read_b128 v[16:19], v48 offset:32768
    v_mfma_f32_16x16x32_bf16 v[148:151], v[244:247], v[228:231], v[148:151]
    ds_read_b128 v[20:23], v49 offset:34816
    v_mfma_f32_16x16x32_bf16 v[132:135], v[244:247], v[224:227], v[132:135]
    ds_read_b128 v[24:27], v48 offset:36864
    v_mfma_f32_16x16x32_bf16 v[136:139], v[248:251], v[224:227], v[136:139]
    ds_read_b128 v[28:31], v49 offset:38912
    v_mfma_f32_16x16x32_bf16 v[152:155], v[248:251], v[228:231], v[152:155]
    ds_read_b64_tr_b16 v[36:37], v11 offset:32768
    v_mfma_f32_16x16x32_bf16 v[168:171], v[248:251], v[232:235], v[168:171]
    ds_read_b64_tr_b16 v[38:39], v11 offset:33792
    v_mfma_f32_16x16x32_bf16 v[184:187], v[248:251], v[236:239], v[184:187]
    ds_read_b64_tr_b16 v[40:41], v12 offset:32768
    v_mfma_f32_16x16x32_bf16 v[188:191], v[252:255], v[236:239], v[188:191]
    ds_read_b64_tr_b16 v[42:43], v12 offset:33792
    v_mfma_f32_16x16x32_bf16 v[172:175], v[252:255], v[232:235], v[172:175]
    ds_read_b64_tr_b16 v[44:45], v13 offset:32768
    v_mfma_f32_16x16x32_bf16 v[156:159], v[252:255], v[228:231], v[156:159]
    ds_read_b64_tr_b16 v[46:47], v13 offset:33792
    v_mfma_f32_16x16x32_bf16 v[140:143], v[252:255], v[224:227], v[140:143]
L_g46:
    s_nop 7
    s_waitcnt lgkmcnt(6)
    v_mul_f32 v82, s51, v82
    v_mul_f32 v86, s51, v86
    v_mul_f32 v90, s51, v90
    v_mul_f32 v94, s51, v94
    v_pk_fma_f32 v[128:129], v[64:65], v[80:81], v[128:129] op_sel_hi:[1,0,1]
    v_pk_fma_f32 v[130:131], v[66:67], v[80:81], v[130:131] op_sel_hi:[1,0,1]
    v_pk_fma_f32 v[132:133], v[68:69], v[80:81], v[132:133] op_sel_hi:[1,0,1]
    v_pk_fma_f32 v[134:135], v[70:71], v[80:81], v[134:135] op_sel_hi:[1,0,1]
    v_pk_fma_f32 v[136:137], v[72:73], v[80:81], v[136:137] op_sel_hi:[1,0,1]
    v_pk_fma_f32 v[138:139], v[74:75], v[80:81], v[138:139] op_sel_hi:[1,0,1]
    v_pk_fma_f32 v[140:141], v[76:77], v[80:81], v[140:141] op_sel_hi:[1,0,1]
    v_pk_fma_f32 v[142:143], v[78:79], v[80:81], v[142:143] op_sel_hi:[1,0,1]
    v_pk_mul_f32 v[128:129], v[128:129], v[82:83] op_sel_hi:[1,0]
    v_pk_mul_f32 v[130:131], v[130:131], v[82:83] op_sel_hi:[1,0]
    v_pk_mul_f32 v[132:133], v[132:133], v[82:83] op_sel_hi:[1,0]
    v_pk_mul_f32 v[134:135], v[134:135], v[82:83] op_sel_hi:[1,0]
    v_pk_mul_f32 v[136:137], v[136:137], v[82:83] op_sel_hi:[1,0]
    v_pk_mul_f32 v[138:139], v[138:139], v[82:83] op_sel_hi:[1,0]
    v_pk_mul_f32 v[140:141], v[140:141], v[82:83] op_sel_hi:[1,0]
    v_pk_mul_f32 v[142:143], v[142:143], v[82:83] op_sel_hi:[1,0]
    v_cvt_pk_bf16_f32 v112, v128, v129
    v_cvt_pk_bf16_f32 v113, v130, v131
    v_cvt_pk_bf16_f32 v114, v132, v133
    v_cvt_pk_bf16_f32 v115, v134, v135
    v_cvt_pk_bf16_f32 v116, v136, v137
    v_cvt_pk_bf16_f32 v117, v138, v139
    v_cvt_pk_bf16_f32 v118, v140, v141
    v_cvt_pk_bf16_f32 v119, v142, v143
    buffer_store_dwordx2 v[112:113], v96, s[20:23], 0 offen offset:0 sc1
    buffer_store_dwordx2 v[114:115], v98, s[20:23], 0 offen offset:0 sc1
    buffer_store_dwordx2 v[116:117], v100, s[20:23], 0 offen offset:0 sc1
    buffer_store_dwordx2 v[118:119], v102, s[20:23], 0 offen offset:0 sc1
    v_pk_fma_f32 v[144:145], v[64:65], v[84:85], v[144:145] op_sel_hi:[1,0,1]
    v_pk_fma_f32 v[146:147], v[66:67], v[84:85], v[146:147] op_sel_hi:[1,0,1]
    v_pk_fma_f32 v[148:149], v[68:69], v[84:85], v[148:149] op_sel_hi:[1,0,1]
    v_pk_fma_f32 v[150:151], v[70:71], v[84:85], v[150:151] op_sel_hi:[1,0,1]
    v_pk_fma_f32 v[152:153], v[72:73], v[84:85], v[152:153] op_sel_hi:[1,0,1]
    v_pk_fma_f32 v[154:155], v[74:75], v[84:85], v[154:155] op_sel_hi:[1,0,1]
    v_pk_fma_f32 v[156:157], v[76:77], v[84:85], v[156:157] op_sel_hi:[1,0,1]
    v_pk_fma_f32 v[158:159], v[78:79], v[84:85], v[158:159] op_sel_hi:[1,0,1]
    v_pk_mul_f32 v[144:145], v[144:145], v[86:87] op_sel_hi:[1,0]
    v_pk_mul_f32 v[146:147], v[146:147], v[86:87] op_sel_hi:[1,0]
    v_pk_mul_f32 v[148:149], v[148:149], v[86:87] op_sel_hi:[1,0]
    v_pk_mul_f32 v[150:151], v[150:151], v[86:87] op_sel_hi:[1,0]
    v_pk_mul_f32 v[152:153], v[152:153], v[86:87] op_sel_hi:[1,0]
    v_pk_mul_f32 v[154:155], v[154:155], v[86:87] op_sel_hi:[1,0]
    v_pk_mul_f32 v[156:157], v[156:157], v[86:87] op_sel_hi:[1,0]
    v_pk_mul_f32 v[158:159], v[158:159], v[86:87] op_sel_hi:[1,0]
    v_cvt_pk_bf16_f32 v120, v144, v145
    v_cvt_pk_bf16_f32 v121, v146, v147
    v_cvt_pk_bf16_f32 v122, v148, v149
    v_cvt_pk_bf16_f32 v123, v150, v151
    v_cvt_pk_bf16_f32 v124, v152, v153
    v_cvt_pk_bf16_f32 v125, v154, v155
    v_cvt_pk_bf16_f32 v126, v156, v157
    v_cvt_pk_bf16_f32 v127, v158, v159
    buffer_store_dwordx2 v[120:121], v96, s[20:23], 0 offen offset:128 sc1
    buffer_store_dwordx2 v[122:123], v98, s[20:23], 0 offen offset:128 sc1
    buffer_store_dwordx2 v[124:125], v100, s[20:23], 0 offen offset:128 sc1
    buffer_store_dwordx2 v[126:127], v102, s[20:23], 0 offen offset:128 sc1
    v_pk_fma_f32 v[160:161], v[64:65], v[88:89], v[160:161] op_sel_hi:[1,0,1]
    v_pk_fma_f32 v[162:163], v[66:67], v[88:89], v[162:163] op_sel_hi:[1,0,1]
    v_pk_fma_f32 v[164:165], v[68:69], v[88:89], v[164:165] op_sel_hi:[1,0,1]
    v_pk_fma_f32 v[166:167], v[70:71], v[88:89], v[166:167] op_sel_hi:[1,0,1]
    v_pk_fma_f32 v[168:169], v[72:73], v[88:89], v[168:169] op_sel_hi:[1,0,1]
    v_pk_fma_f32 v[170:171], v[74:75], v[88:89], v[170:171] op_sel_hi:[1,0,1]
    v_pk_fma_f32 v[172:173], v[76:77], v[88:89], v[172:173] op_sel_hi:[1,0,1]
    v_pk_fma_f32 v[174:175], v[78:79], v[88:89], v[174:175] op_sel_hi:[1,0,1]
    v_pk_mul_f32 v[160:161], v[160:161], v[90:91] op_sel_hi:[1,0]
    v_pk_mul_f32 v[162:163], v[162:163], v[90:91] op_sel_hi:[1,0]
    v_pk_mul_f32 v[164:165], v[164:165], v[90:91] op_sel_hi:[1,0]
    v_pk_mul_f32 v[166:167], v[166:167], v[90:91] op_sel_hi:[1,0]
    v_pk_mul_f32 v[168:169], v[168:169], v[90:91] op_sel_hi:[1,0]
    v_pk_mul_f32 v[170:171], v[170:171], v[90:91] op_sel_hi:[1,0]
    v_pk_mul_f32 v[172:173], v[172:173], v[90:91] op_sel_hi:[1,0]
    v_pk_mul_f32 v[174:175], v[174:175], v[90:91] op_sel_hi:[1,0]
    v_cvt_pk_bf16_f32 v192, v160, v161
    v_cvt_pk_bf16_f32 v193, v162, v163
    v_cvt_pk_bf16_f32 v194, v164, v165
    v_cvt_pk_bf16_f32 v195, v166, v167
    v_cvt_pk_bf16_f32 v196, v168, v169
    v_cvt_pk_bf16_f32 v197, v170, v171
    v_cvt_pk_bf16_f32 v198, v172, v173
    v_cvt_pk_bf16_f32 v199, v174, v175
    buffer_store_dwordx2 v[192:193], v97, s[20:23], 0 offen offset:0 sc1
    buffer_store_dwordx2 v[194:195], v99, s[20:23], 0 offen offset:0 sc1
    buffer_store_dwordx2 v[196:197], v101, s[20:23], 0 offen offset:0 sc1
    buffer_store_dwordx2 v[198:199], v103, s[20:23], 0 offen offset:0 sc1
    v_pk_fma_f32 v[176:177], v[64:65], v[92:93], v[176:177] op_sel_hi:[1,0,1]
    v_pk_fma_f32 v[178:179], v[66:67], v[92:93], v[178:179] op_sel_hi:[1,0,1]
    v_pk_fma_f32 v[180:181], v[68:69], v[92:93], v[180:181] op_sel_hi:[1,0,1]
    v_pk_fma_f32 v[182:183], v[70:71], v[92:93], v[182:183] op_sel_hi:[1,0,1]
    v_pk_fma_f32 v[184:185], v[72:73], v[92:93], v[184:185] op_sel_hi:[1,0,1]
    v_pk_fma_f32 v[186:187], v[74:75], v[92:93], v[186:187] op_sel_hi:[1,0,1]
    v_pk_fma_f32 v[188:189], v[76:77], v[92:93], v[188:189] op_sel_hi:[1,0,1]
    v_pk_fma_f32 v[190:191], v[78:79], v[92:93], v[190:191] op_sel_hi:[1,0,1]
    v_pk_mul_f32 v[176:177], v[176:177], v[94:95] op_sel_hi:[1,0]
    v_pk_mul_f32 v[178:179], v[178:179], v[94:95] op_sel_hi:[1,0]
    v_pk_mul_f32 v[180:181], v[180:181], v[94:95] op_sel_hi:[1,0]
    v_pk_mul_f32 v[182:183], v[182:183], v[94:95] op_sel_hi:[1,0]
    v_pk_mul_f32 v[184:185], v[184:185], v[94:95] op_sel_hi:[1,0]
    v_pk_mul_f32 v[186:187], v[186:187], v[94:95] op_sel_hi:[1,0]
    v_pk_mul_f32 v[188:189], v[188:189], v[94:95] op_sel_hi:[1,0]
    v_pk_mul_f32 v[190:191], v[190:191], v[94:95] op_sel_hi:[1,0]
    v_cvt_pk_bf16_f32 v200, v176, v177
    v_cvt_pk_bf16_f32 v201, v178, v179
    v_cvt_pk_bf16_f32 v202, v180, v181
    v_cvt_pk_bf16_f32 v203, v182, v183
    v_cvt_pk_bf16_f32 v204, v184, v185
    v_cvt_pk_bf16_f32 v205, v186, v187
    v_cvt_pk_bf16_f32 v206, v188, v189
    v_cvt_pk_bf16_f32 v207, v190, v191
    buffer_store_dwordx2 v[200:201], v97, s[20:23], 0 offen offset:128 sc1
    buffer_store_dwordx2 v[202:203], v99, s[20:23], 0 offen offset:128 sc1
    buffer_store_dwordx2 v[204:205], v101, s[20:23], 0 offen offset:128 sc1
    buffer_store_dwordx2 v[206:207], v103, s[20:23], 0 offen offset:128 sc1
    s_cmp_eq_u32 s61, 15
    s_cbranch_scc1 L_g_now1
L_g_w1:
    v_mov_b32 v56, 0x3f803f80
    v_mov_b32 v57, 0x3f803f80
    v_mov_b32 v58, 0x3f803f80
    v_mov_b32 v59, 0x3f803f80
    s_waitcnt lgkmcnt(6)
    v_mfma_f32_16x16x32_bf16 v[128:131], v[32:35], v[16:19], 0
    ds_read_b64_tr_b16 v[240:241], v10 offset:40960
    v_mfma_f32_16x16x32_bf16 v[144:147], v[32:35], v[20:23], 0
    ds_read_b64_tr_b16 v[242:243], v10 offset:41984
    v_mfma_f32_16x16x32_bf16 v[160:163], v[32:35], v[24:27], 0
    ds_read_b128 v[224:227], v50 offset:32768
    v_mfma_f32_16x16x32_bf16 v[176:179], v[32:35], v[28:31], 0
    ds_read_b128 v[228:231], v51 offset:34816
    s_waitcnt lgkmcnt(8)
    v_mfma_f32_16x16x32_bf16 v[180:183], v[36:39], v[28:31], 0
    ds_read_b128 v[232:235], v50 offset:36864
    v_mfma_f32_16x16x32_bf16 v[164:167], v[36:39], v[24:27], 0
    ds_read_b128 v[236:239], v51 offset:38912
    v_mfma_f32_16x16x32_bf16 v[148:151], v[36:39], v[20:23], 0
    ds_read_b64_tr_b16 v[244:245], v11 offset:40960
    v_mfma_f32_16x16x32_bf16 v[132:135], v[36:39], v[16:19], 0
    ds_read_b64_tr_b16 v[246:247], v11 offset:41984
    s_waitcnt lgkmcnt(10)
    v_mfma_f32_16x16x32_bf16 v[136:139], v[40:43], v[16:19], 0
    ds_read_b64_tr_b16 v[248:249], v12 offset:40960
    v_mfma_f32_16x16x32_bf16 v[152:155], v[40:43], v[20:23], 0
    ds_read_b64_tr_b16 v[250:251], v12 offset:41984
    v_mfma_f32_16x16x32_bf16 v[168:171], v[40:43], v[24:27], 0
    ds_read_b64_tr_b16 v[252:253], v13 offset:40960
    v_mfma_f32_16x16x32_bf16 v[184:187], v[40:43], v[28:31], 0
    ds_read_b64_tr_b16 v[254:255], v13 offset:41984
    s_waitcnt lgkmcnt(12)
    v_mfma_f32_16x16x32_bf16 v[188:191], v[44:47], v[28:31], 0
    v_mfma_f32_16x16x32_bf16 v[172:175], v[44:47], v[24:27], 0
    v_mfma_f32_16x16x32_bf16 v[156:159], v[44:47], v[20:23], 0
    v_mfma_f32_16x16x32_bf16 v[140:143], v[44:47], v[16:19], 0
    v_mfma_f32_16x16x32_bf16 v[112:115], v[56:59], v[32:35], 0
    v_mfma_f32_16x16x32_bf16 v[116:119], v[56:59], v[36:39], 0
    v_mfma_f32_16x16x32_bf16 v[120:123], v[56:59], v[40:43], 0
    v_mfma_f32_16x16x32_bf16 v[124:127], v[56:59], v[44:47], 0
    s_waitcnt lgkmcnt(6)
    v_mfma_f32_16x16x32_bf16 v[128:131], v[240:243], v[224:227], v[128:131]
    v_mfma_f32_16x16x32_bf16 v[144:147], v[240:243], v[228:231], v[144:147]
    v_mfma_f32_16x16x32_bf16 v[160:163], v[240:243], v[232:235], v[160:163]
    s_waitcnt lgkmcnt(0)
    s_barrier
    v_mfma_f32_16x16x32_bf16 v[176:179], v[240:243], v[236:239], v[176:179]
    ds_read_b64_tr_b16 v[32:33], v10 offset:49152
    v_mfma_f32_16x16x32_bf16 v[180:183], v[244:247], v[236:239], v[180:183]
    ds_read_b64_tr_b16 v[34:35], v10 offset:50176
    v_mfma_f32_16x16x32_bf16 v[164:167], v[244:247], v[232:235], v[164:167]
    ds_read_b128 v[16:19], v48 offset:49152
    v_mfma_f32_16x16x32_bf16 v[148:151], v[244:247], v[228:231], v[148:151]
    ds_read_b128 v[20:23], v49 offset:51200
    v_mfma_f32_16x16x32_bf16 v[132:135], v[244:247], v[224:227], v[132:135]
    ds_read_b128 v[24:27], v48 offset:53248
    v_mfma_f32_16x16x32_bf16 v[136:139], v[248:251], v[224:227], v[136:139]
    ds_read_b128 v[28:31], v49 offset:55296
    v_mfma_f32_16x16x32_bf16 v[152:155], v[248:251], v[228:231], v[152:155]
    ds_read_b64_tr_b16 v[36:37], v11 offset:49152
    v_mfma_f32_16x16x32_bf16 v[168:171], v[248:251], v[232:235], v[168:171]
    ds_read_b64_tr_b16 v[38:39], v11 offset:50176
    v_mfma_f32_16x16x32_bf16 v[184:187], v[248:251], v[236:239], v[184:187]
    ds_read_b64_tr_b16 v[40:41], v12 offset:49152
    v_mfma_f32_16x16x32_bf16 v[188:191], v[252:255], v[236:239], v[188:191]
    ds_read_b64_tr_b16 v[42:43], v12 offset:50176
    v_mfma_f32_16x16x32_bf16 v[172:175], v[252:255], v[232:235], v[172:175]
    ds_read_b64_tr_b16 v[44:45], v13 offset:49152
    v_mfma_f32_16x16x32_bf16 v[156:159], v[252:255], v[228:231], v[156:159]
    ds_read_b64_tr_b16 v[46:47], v13 offset:50176
    v_mfma_f32_16x16x32_bf16 v[140:143], v[252:255], v[224:227], v[140:143]
    v_mfma_f32_16x16x32_bf16 v[112:115], v[56:59], v[240:243], v[112:115]
    v_mfma_f32_16x16x32_bf16 v[116:119], v[56:59], v[244:247], v[116:119]
    v_mfma_f32_16x16x32_bf16 v[120:123], v[56:59], v[248:251], v[120:123]
    v_mfma_f32_16x16x32_bf16 v[124:127], v[56:59], v[252:255], v[124:127]
    s_waitcnt lgkmcnt(0)
    v_mfma_f32_16x16x32_bf16 v[128:131], v[32:35], v[16:19], v[128:131]
    ds_read_b64_tr_b16 v[240:241], v10 offset:57344
    v_mfma_f32_16x16x32_bf16 v[144:147], v[32:35], v[20:23], v[144:147]
    ds_read_b64_tr_b16 v[242:243], v10 offset:58368
    v_mfma_f32_16x16x32_bf16 v[160:163], v[32:35], v[24:27], v[160:163]
    ds_read_b128 v[224:227], v50 offset:49152
    v_mfma_f32_16x16x32_bf16 v[176:179], v[32:35], v[28:31], v[176:179]
    ds_read_b128 v[228:231], v51 offset:51200
    v_mfma_f32_16x16x32_bf16 v[180:183], v[36:39], v[28:31], v[180:183]
    ds_read_b128 v[232:235], v50 offset:53248
    v_mfma_f32_16x16x32_bf16 v[164:167], v[36:39], v[24:27], v[164:167]
    ds_read_b128 v[236:239], v51 offset:55296
    v_mfma_f32_16x16x32_bf16 v[148:151], v[36:39], v[20:23], v[148:151]
    ds_read_b64_tr_b16 v[244:245], v11 offset:57344
    v_mfma_f32_16x16x32_bf16 v[132:135], v[36:39], v[16:19], v[132:135]
    ds_read_b64_tr_b16 v[246:247], v11 offset:58368
    v_mfma_f32_16x16x32_bf16 v[136:139], v[40:43], v[16:19], v[136:139]
    ds_read_b64_tr_b16 v[248:249], v12 offset:57344
    v_mfma_f32_16x16x32_bf16 v[152:155], v[40:43], v[20:23], v[152:155]
    ds_read_b64_tr_b16 v[250:251], v12 offset:58368
    v_mfma_f32_16x16x32_bf16 v[168:171], v[40:43], v[24:27], v[168:171]
    ds_read_b64_tr_b16 v[252:253], v13 offset:57344
    v_mfma_f32_16x16x32_bf16 v[184:187], v[40:43], v[28:31], v[184:187]
    ds_read_b64_tr_b16 v[254:255], v13 offset:58368
    v_mfma_f32_16x16x32_bf16 v[188:191], v[44:47], v[28:31], v[188:191]
    ds_write_b32 v63, v112 offset:0
    v_mfma_f32_16x16x32_bf16 v[172:175], v[44:47], v[24:27], v[172:175]
    ds_write_b32 v63, v116 offset:64
    v_mfma_f32_16x16x32_bf16 v[156:159], v[44:47], v[20:23], v[156:159]
    ds_write_b32 v63, v120 offset:128
    v_mfma_f32_16x16x32_bf16 v[140:143], v[44:47], v[16:19], v[140:143]
    ds_write_b32 v63, v124 offset:192
    s_waitcnt lgkmcnt(6)
    v_mfma_f32_16x16x32_bf16 v[128:131], v[240:243], v[224:227], v[128:131]
    v_mfma_f32_16x16x32_bf16 v[144:147], v[240:243], v[228:231], v[144:147]
    v_mfma_f32_16x16x32_bf16 v[160:163], v[240:243], v[232:235], v[160:163]
    s_waitcnt lgkmcnt(0)
    s_barrier
    v_mfma_f32_16x16x32_bf16 v[176:179], v[240:243], v[236:239], v[176:179]
    ds_read_b64_tr_b16 v[32:33], v10 offset:0
    v_mfma_f32_16x16x32_bf16 v[180:183], v[244:247], v[236:239], v[180:183]
    ds_read_b64_tr_b16 v[34:35], v10 offset:1024
    v_mfma_f32_16x16x32_bf16 v[164:167], v[244:247], v[232:235], v[164:167]
    ds_read_b128 v[16:19], v48 offset:0
    v_mfma_f32_16x16x32_bf16 v[148:151], v[244:247], v[228:231], v[148:151]
    ds_read_b128 v[20:23], v49 offset:2048
    v_mfma_f32_16x16x32_bf16 v[132:135], v[244:247], v[224:227], v[132:135]
    ds_read_b128 v[24:27], v48 offset:4096
    v_mfma_f32_16x16x32_bf16 v[136:139], v[248:251], v[224:227], v[136:139]
    ds_read_b128 v[28:31], v49 offset:6144
    v_mfma_f32_16x16x32_bf16 v[152:155], v[248:251], v[228:231], v[152:155]
    ds_read_b64_tr_b16 v[36:37], v11 offset:0
    v_mfma_f32_16x16x32_bf16 v[168:171], v[248:251], v[232:235], v[168:171]
    ds_read_b64_tr_b16 v[38:39], v11 offset:1024
    v_mfma_f32_16x16x32_bf16 v[184:187], v[248:251], v[236:239], v[184:187]
    ds_read_b64_tr_b16 v[40:41], v12 offset:0
    v_mfma_f32_16x16x32_bf16 v[188:191], v[252:255], v[236:239], v[188:191]
    ds_read_b64_tr_b16 v[42:43], v12 offset:1024
    v_mfma_f32_16x16x32_bf16 v[172:175], v[252:255], v[232:235], v[172:175]
    ds_read_b64_tr_b16 v[44:45], v13 offset:0
    v_mfma_f32_16x16x32_bf16 v[156:159], v[252:255], v[228:231], v[156:159]
    ds_read_b64_tr_b16 v[46:47], v13 offset:1024
    v_mfma_f32_16x16x32_bf16 v[140:143], v[252:255], v[224:227], v[140:143]
    s_waitcnt lgkmcnt(6)
    v_mfma_f32_16x16x32_bf16 v[128:131], v[32:35], v[16:19], v[128:131]
    ds_read_b64_tr_b16 v[240:241], v10 offset:8192
    v_mfma_f32_16x16x32_bf16 v[144:147], v[32:35], v[20:23], v[144:147]
    ds_read_b64_tr_b16 v[242:243], v10 offset:9216
    v_mfma_f32_16x16x32_bf16 v[160:163], v[32:35], v[24:27], v[160:163]
    ds_read_b128 v[224:227], v50 offset:0
    v_mfma_f32_16x16x32_bf16 v[176:179], v[32:35], v[28:31], v[176:179]
    ds_read_b128 v[228:231], v51 offset:2048
    s_waitcnt lgkmcnt(8)
    v_mfma_f32_16x16x32_bf16 v[180:183], v[36:39], v[28:31], v[180:183]
    ds_read_b128 v[232:235], v50 offset:4096
    v_mfma_f32_16x16x32_bf16 v[164:167], v[36:39], v[24:27], v[164:167]
    ds_read_b128 v[236:239], v51 offset:6144
    v_mfma_f32_16x16x32_bf16 v[148:151], v[36:39], v[20:23], v[148:151]
    ds_read_b64_tr_b16 v[244:245], v11 offset:8192
    v_mfma_f32_16x16x32_bf16 v[132:135], v[36:39], v[16:19], v[132:135]
    ds_read_b64_tr_b16 v[246:247], v11 offset:9216
    s_waitcnt lgkmcnt(10)
    v_mfma_f32_16x16x32_bf16 v[136:139], v[40:43], v[16:19], v[136:139]
    ds_read_b64_tr_b16 v[248:249], v12 offset:8192
    v_mfma_f32_16x16x32_bf16 v[152:155], v[40:43], v[20:23], v[152:155]
    ds_read_b64_tr_b16 v[250:251], v12 offset:9216
    v_mfma_f32_16x16x32_bf16 v[168:171], v[40:43], v[24:27], v[168:171]
    ds_read_b64_tr_b16 v[252:253], v13 offset:8192
    v_mfma_f32_16x16x32_bf16 v[184:187], v[40:43], v[28:31], v[184:187]
    ds_read_b64_tr_b16 v[254:255], v13 offset:9216
    s_waitcnt lgkmcnt(12)
    v_mfma_f32_16x16x32_bf16 v[188:191], v[44:47], v[28:31], v[188:191]
    v_mfma_f32_16x16x32_bf16 v[172:175], v[44:47], v[24:27], v[172:175]
    v_mfma_f32_16x16x32_bf16 v[156:159], v[44:47], v[20:23], v[156:159]
    v_mfma_f32_16x16x32_bf16 v[140:143], v[44:47], v[16:19], v[140:143]
    s_waitcnt lgkmcnt(6)
    v_mfma_f32_16x16x32_bf16 v[128:131], v[240:243], v[224:227], v[128:131]
    v_mfma_f32_16x16x32_bf16 v[144:147], v[240:243], v[228:231], v[144:147]
    v_mfma_f32_16x16x32_bf16 v[160:163], v[240:243], v[232:235], v[160:163]
    s_waitcnt lgkmcnt(0)
    s_waitcnt vmcnt(0)
    s_barrier
    v_mfma_f32_16x16x32_bf16 v[176:179], v[240:243], v[236:239], v[176:179]
    ds_read_b64_tr_b16 v[32:33], v10 offset:16384
    v_mfma_f32_16x16x32_bf16 v[180:183], v[244:247], v[236:239], v[180:183]
    ds_read_b64_tr_b16 v[34:35], v10 offset:17408
    v_mfma_f32_16x16x32_bf16 v[164:167], v[244:247], v[232:235], v[164:167]
    ds_read_b128 v[16:19], v48 offset:16384
    v_mfma_f32_16x16x32_bf16 v[148:151], v[244:247], v[228:231], v[148:151]
    ds_read_b128 v[20:23], v49 offset:18432
    v_mfma_f32_16x16x32_bf16 v[132:135], v[244:247], v[224:227], v[132:135]
    ds_read_b128 v[24:27], v48 offset:20480
    v_mfma_f32_16x16x32_bf16 v[136:139], v[248:251], v[224:227], v[136:139]
    ds_read_b128 v[28:31], v49 offset:22528
    v_mfma_f32_16x16x32_bf16 v[152:155], v[248:251], v[228:231], v[152:155]
    ds_read_b64_tr_b16 v[36:37], v11 offset:16384
    v_mfma_f32_16x16x32_bf16 v[168:171], v[248:251], v[232:235], v[168:171]
    ds_read_b64_tr_b16 v[38:39], v11 offset:17408
    v_mfma_f32_16x16x32_bf16 v[184:187], v[248:251], v[236:239], v[184:187]
    ds_read_b64_tr_b16 v[40:41], v12 offset:16384
    v_mfma_f32_16x16x32_bf16 v[188:191], v[252:255], v[236:239], v[188:191]
    ds_read_b64_tr_b16 v[42:43], v12 offset:17408
    v_mfma_f32_16x16x32_bf16 v[172:175], v[252:255], v[232:235], v[172:175]
    ds_read_b64_tr_b16 v[44:45], v13 offset:16384
    v_mfma_f32_16x16x32_bf16 v[156:159], v[252:255], v[228:231], v[156:159]
    ds_read_b64_tr_b16 v[46:47], v13 offset:17408
    v_mfma_f32_16x16x32_bf16 v[140:143], v[252:255], v[224:227], v[140:143]
    s_waitcnt lgkmcnt(6)
    v_mfma_f32_16x16x32_bf16 v[128:131], v[32:35], v[16:19], v[128:131]
    ds_read_b64_tr_b16 v[240:241], v10 offset:24576
    v_mfma_f32_16x16x32_bf16 v[144:147], v[32:35], v[20:23], v[144:147]
    ds_read_b64_tr_b16 v[242:243], v10 offset:25600
    v_mfma_f32_16x16x32_bf16 v[160:163], v[32:35], v[24:27], v[160:163]
    ds_read_b128 v[224:227], v50 offset:16384
    v_mfma_f32_16x16x32_bf16 v[176:179], v[32:35], v[28:31], v[176:179]
    ds_read_b128 v[228:231], v51 offset:18432
    s_waitcnt lgkmcnt(8)
    v_mfma_f32_16x16x32_bf16 v[180:183], v[36:39], v[28:31], v[180:183]
    ds_read_b128 v[232:235], v50 offset:20480
    v_mfma_f32_16x16x32_bf16 v[164:167], v[36:39], v[24:27], v[164:167]
    ds_read_b128 v[236:239], v51 offset:22528
    v_mfma_f32_16x16x32_bf16 v[148:151], v[36:39], v[20:23], v[148:151]
    ds_read_b64_tr_b16 v[244:245], v11 offset:24576
    v_mfma_f32_16x16x32_bf16 v[132:135], v[36:39], v[16:19], v[132:135]
    ds_read_b64_tr_b16 v[246:247], v11 offset:25600
    s_waitcnt lgkmcnt(10)
    v_mfma_f32_16x16x32_bf16 v[136:139], v[40:43], v[16:19], v[136:139]
    ds_read_b64_tr_b16 v[248:249], v12 offset:24576
    v_mfma_f32_16x16x32_bf16 v[152:155], v[40:43], v[20:23], v[152:155]
    ds_read_b64_tr_b16 v[250:251], v12 offset:25600
    v_mfma_f32_16x16x32_bf16 v[168:171], v[40:43], v[24:27], v[168:171]
    ds_read_b64_tr_b16 v[252:253], v13 offset:24576
    v_mfma_f32_16x16x32_bf16 v[184:187], v[40:43], v[28:31], v[184:187]
    ds_read_b64_tr_b16 v[254:255], v13 offset:25600
    s_waitcnt lgkmcnt(12)
    v_mfma_f32_16x16x32_bf16 v[188:191], v[44:47], v[28:31], v[188:191]
    v_mfma_f32_16x16x32_bf16 v[172:175], v[44:47], v[24:27], v[172:175]
    v_mfma_f32_16x16x32_bf16 v[156:159], v[44:47], v[20:23], v[156:159]
    v_mfma_f32_16x16x32_bf16 v[140:143], v[44:47], v[16:19], v[140:143]
    s_waitcnt lgkmcnt(6)
    v_mfma_f32_16x16x32_bf16 v[128:131], v[240:243], v[224:227], v[128:131]
    v_mfma_f32_16x16x32_bf16 v[144:147], v[240:243], v[228:231], v[144:147]
    v_mfma_f32_16x16x32_bf16 v[160:163], v[240:243], v[232:235], v[160:163]
    s_waitcnt lgkmcnt(0)
    s_barrier
    v_mfma_f32_16x16x32_bf16 v[176:179], v[240:243], v[236:239], v[176:179]
    ds_read_b64_tr_b16 v[32:33], v10 offset:32768
    v_mfma_f32_16x16x32_bf16 v[180:183], v[244:247], v[236:239], v[180:183]
    ds_read_b64_tr_b16 v[34:35], v10 offset:33792
    v_mfma_f32_16x16x32_bf16 v[164:167], v[244:247], v[232:235], v[164:167]
    ds_read_b128 v[16:19], v8 offset:32768
    v_mfma_f32_16x16x32_bf16 v[148:151], v[244:247], v[228:231], v[148:151]
    ds_read_b128 v[20:23], v8 offset:34816
    v_mfma_f32_16x16x32_bf16 v[132:135], v[244:247], v[224:227], v[132:135]
    ds_read_b128 v[24:27], v8 offset:36864
    v_mfma_f32_16x16x32_bf16 v[136:139], v[248:251], v[224:227], v[136:139]
    ds_read_b128 v[28:31], v8 offset:38912
    v_mfma_f32_16x16x32_bf16 v[152:155], v[248:251], v[228:231], v[152:155]
    ds_read_b64_tr_b16 v[36:37], v11 offset:32768
    v_mfma_f32_16x16x32_bf16 v[168:171], v[248:251], v[232:235], v[168:171]
    ds_read_b64_tr_b16 v[38:39], v11 offset:33792
    v_mfma_f32_16x16x32_bf16 v[184:187], v[248:251], v[236:239], v[184:187]
    ds_read_b64_tr_b16 v[40:41], v12 offset:32768
    v_mfma_f32_16x16x32_bf16 v[188:191], v[252:255], v[236:239], v[188:191]
    ds_read_b64_tr_b16 v[42:43], v12 offset:33792
    v_mfma_f32_16x16x32_bf16 v[172:175], v[252:255], v[232:235], v[172:175]
    ds_read_b64_tr_b16 v[44:45], v13 offset:32768
    v_mfma_f32_16x16x32_bf16 v[156:159], v[252:255], v[228:231], v[156:159]
    ds_read_b64_tr_b16 v[46:47], v13 offset:33792
    v_mfma_f32_16x16x32_bf16 v[140:143], v[252:255], v[224:227], v[140:143]
    s_waitcnt lgkmcnt(6)
    v_mfma_f32_16x16x32_bf16 v[128:131], v[32:35], v[16:19], v[128:131]
    ds_read_b64_tr_b16 v[240:241], v10 offset:40960
    v_mfma_f32_16x16x32_bf16 v[144:147], v[32:35], v[20:23], v[144:147]
    ds_read_b64_tr_b16 v[242:243], v10 offset:41984
    v_mfma_f32_16x16x32_bf16 v[160:163], v[32:35], v[24:27], v[160:163]
    ds_read_b128 v[224:227], v9 offset:32768
    v_mfma_f32_16x16x32_bf16 v[176:179], v[32:35], v[28:31], v[176:179]
    ds_read_b128 v[228:231], v9 offset:34816
    s_waitcnt lgkmcnt(8)
    v_mfma_f32_16x16x32_bf16 v[180:183], v[36:39], v[28:31], v[180:183]
    ds_read_b128 v[232:235], v9 offset:36864
    v_mfma_f32_16x16x32_bf16 v[164:167], v[36:39], v[24:27], v[164:167]
    ds_read_b128 v[236:239], v9 offset:38912
    v_mfma_f32_16x16x32_bf16 v[148:151], v[36:39], v[20:23], v[148:151]
    ds_read_b64_tr_b16 v[244:245], v11 offset:40960
    v_mfma_f32_16x16x32_bf16 v[132:135], v[36:39], v[16:19], v[132:135]
    ds_read_b64_tr_b16 v[246:247], v11 offset:41984
    s_waitcnt lgkmcnt(10)
    v_mfma_f32_16x16x32_bf16 v[136:139], v[40:43], v[16:19], v[136:139]
    ds_read_b64_tr_b16 v[248:249], v12 offset:40960
    v_mfma_f32_16x16x32_bf16 v[152:155], v[40:43], v[20:23], v[152:155]
    ds_read_b64_tr_b16 v[250:251], v12 offset:41984
    v_mfma_f32_16x16x32_bf16 v[168:171], v[40:43], v[24:27], v[168:171]
    ds_read_b64_tr_b16 v[252:253], v13 offset:40960
    v_mfma_f32_16x16x32_bf16 v[184:187], v[40:43], v[28:31], v[184:187]
    ds_read_b64_tr_b16 v[254:255], v13 offset:41984
    s_waitcnt lgkmcnt(12)
    v_mfma_f32_16x16x32_bf16 v[188:191], v[44:47], v[28:31], v[188:191]
    v_mfma_f32_16x16x32_bf16 v[172:175], v[44:47], v[24:27], v[172:175]
    v_mfma_f32_16x16x32_bf16 v[156:159], v[44:47], v[20:23], v[156:159]
    v_mfma_f32_16x16x32_bf16 v[140:143], v[44:47], v[16:19], v[140:143]
    s_waitcnt lgkmcnt(6)
    v_mfma_f32_16x16x32_bf16 v[128:131], v[240:243], v[224:227], v[128:131]
    v_mfma_f32_16x16x32_bf16 v[144:147], v[240:243], v[228:231], v[144:147]
    v_mfma_f32_16x16x32_bf16 v[160:163], v[240:243], v[232:235], v[160:163]
    s_waitcnt lgkmcnt(0)
    s_barrier
    v_mfma_f32_16x16x32_bf16 v[176:179], v[240:243], v[236:239], v[176:179]
    ds_read_b64_tr_b16 v[32:33], v10 offset:49152
    v_mfma_f32_16x16x32_bf16 v[180:183], v[244:247], v[236:239], v[180:183]
    ds_read_b64_tr_b16 v[34:35], v10 offset:50176
    v_mfma_f32_16x16x32_bf16 v[164:167], v[244:247], v[232:235], v[164:167]
    ds_read_b128 v[16:19], v8 offset:49152
    v_mfma_f32_16x16x32_bf16 v[148:151], v[244:247], v[228:231], v[148:151]
    ds_read_b128 v[20:23], v8 offset:51200
    v_mfma_f32_16x16x32_bf16 v[132:135], v[244:247], v[224:227], v[132:135]
    ds_read_b128 v[24:27], v8 offset:53248
    v_mfma_f32_16x16x32_bf16 v[136:139], v[248:251], v[224:227], v[136:139]
    ds_read_b128 v[28:31], v8 offset:55296
    v_mfma_f32_16x16x32_bf16 v[152:155], v[248:251], v[228:231], v[152:155]
    ds_read_b64_tr_b16 v[36:37], v11 offset:49152
    v_mfma_f32_16x16x32_bf16 v[168:171], v[248:251], v[232:235], v[168:171]
    ds_read_b64_tr_b16 v[38:39], v11 offset:50176
    v_mfma_f32_16x16x32_bf16 v[184:187], v[248:251], v[236:239], v[184:187]
    ds_read_b64_tr_b16 v[40:41], v12 offset:49152
    v_mfma_f32_16x16x32_bf16 v[188:191], v[252:255], v[236:239], v[188:191]
    ds_read_b64_tr_b16 v[42:43], v12 offset:50176
    v_mfma_f32_16x16x32_bf16 v[172:175], v[252:255], v[232:235], v[172:175]
    ds_read_b64_tr_b16 v[44:45], v13 offset:49152
    v_mfma_f32_16x16x32_bf16 v[156:159], v[252:255], v[228:231], v[156:159]
    ds_read_b64_tr_b16 v[46:47], v13 offset:50176
    v_mfma_f32_16x16x32_bf16 v[140:143], v[252:255], v[224:227], v[140:143]
    s_waitcnt lgkmcnt(6)
    v_mfma_f32_16x16x32_bf16 v[128:131], v[32:35], v[16:19], v[128:131]
    ds_read_b64_tr_b16 v[240:241], v10 offset:57344
    v_mfma_f32_16x16x32_bf16 v[144:147], v[32:35], v[20:23], v[144:147]
    ds_read_b64_tr_b16 v[242:243], v10 offset:58368
    v_mfma_f32_16x16x32_bf16 v[160:163], v[32:35], v[24:27], v[160:163]
    ds_read_b128 v[224:227], v9 offset:49152
    v_mfma_f32_16x16x32_bf16 v[176:179], v[32:35], v[28:31], v[176:179]
    ds_read_b128 v[228:231], v9 offset:51200
    s_waitcnt lgkmcnt(8)
    v_mfma_f32_16x16x32_bf16 v[180:183], v[36:39], v[28:31], v[180:183]
    ds_read_b128 v[232:235], v9 offset:53248
    v_mfma_f32_16x16x32_bf16 v[164:167], v[36:39], v[24:27], v[164:167]
    ds_read_b128 v[236:239], v9 offset:55296
    v_mfma_f32_16x16x32_bf16 v[148:151], v[36:39], v[20:23], v[148:151]
    ds_read_b64_tr_b16 v[244:245], v11 offset:57344
    v_mfma_f32_16x16x32_bf16 v[132:135], v[36:39], v[16:19], v[132:135]
    ds_read_b64_tr_b16 v[246:247], v11 offset:58368
    s_waitcnt lgkmcnt(10)
    v_mfma_f32_16x16x32_bf16 v[136:139], v[40:43], v[16:19], v[136:139]
    ds_read_b64_tr_b16 v[248:249], v12 offset:57344
    v_mfma_f32_16x16x32_bf16 v[152:155], v[40:43], v[20:23], v[152:155]
    ds_read_b64_tr_b16 v[250:251], v12 offset:58368
    v_mfma_f32_16x16x32_bf16 v[168:171], v[40:43], v[24:27], v[168:171]
    ds_read_b64_tr_b16 v[252:253], v13 offset:57344
    v_mfma_f32_16x16x32_bf16 v[184:187], v[40:43], v[28:31], v[184:187]
    ds_read_b64_tr_b16 v[254:255], v13 offset:58368
    s_waitcnt lgkmcnt(12)
    v_mfma_f32_16x16x32_bf16 v[188:191], v[44:47], v[28:31], v[188:191]
    v_mfma_f32_16x16x32_bf16 v[172:175], v[44:47], v[24:27], v[172:175]
    v_mfma_f32_16x16x32_bf16 v[156:159], v[44:47], v[20:23], v[156:159]
    v_mfma_f32_16x16x32_bf16 v[140:143], v[44:47], v[16:19], v[140:143]
    s_waitcnt lgkmcnt(6)
    v_mfma_f32_16x16x32_bf16 v[128:131], v[240:243], v[224:227], v[128:131]
    v_mfma_f32_16x16x32_bf16 v[144:147], v[240:243], v[228:231], v[144:147]
    v_mfma_f32_16x16x32_bf16 v[160:163], v[240:243], v[232:235], v[160:163]
    s_waitcnt lgkmcnt(0)
    s_barrier
    v_mfma_f32_16x16x32_bf16 v[176:179], v[240:243], v[236:239], v[176:179]
    ds_read_b64_tr_b16 v[32:33], v10 offset:0
    v_mfma_f32_16x16x32_bf16 v[180:183], v[244:247], v[236:239], v[180:183]
    ds_read_b64_tr_b16 v[34:35], v10 offset:1024
    v_mfma_f32_16x16x32_bf16 v[164:167], v[244:247], v[232:235], v[164:167]
    ds_read_b128 v[16:19], v8 offset:0
    v_mfma_f32_16x16x32_bf16 v[148:151], v[244:247], v[228:231], v[148:151]
    ds_read_b128 v[20:23], v8 offset:2048
    v_mfma_f32_16x16x32_bf16 v[132:135], v[244:247], v[224:227], v[132:135]
    ds_read_b128 v[24:27], v8 offset:4096
    v_mfma_f32_16x16x32_bf16 v[136:139], v[248:251], v[224:227], v[136:139]
    ds_read_b128 v[28:31], v8 offset:6144
    v_mfma_f32_16x16x32_bf16 v[152:155], v[248:251], v[228:231], v[152:155]
    ds_read_b64_tr_b16 v[36:37], v11 offset:0
    v_mfma_f32_16x16x32_bf16 v[168:171], v[248:251], v[232:235], v[168:171]
    ds_read_b64_tr_b16 v[38:39], v11 offset:1024
    v_mfma_f32_16x16x32_bf16 v[184:187], v[248:251], v[236:239], v[184:187]
    ds_read_b64_tr_b16 v[40:41], v12 offset:0
    v_mfma_f32_16x16x32_bf16 v[188:191], v[252:255], v[236:239], v[188:191]
    ds_read_b64_tr_b16 v[42:43], v12 offset:1024
    v_mfma_f32_16x16x32_bf16 v[172:175], v[252:255], v[232:235], v[172:175]
    ds_read_b64_tr_b16 v[44:45], v13 offset:0
    v_mfma_f32_16x16x32_bf16 v[156:159], v[252:255], v[228:231], v[156:159]
    ds_read_b64_tr_b16 v[46:47], v13 offset:1024
    v_mfma_f32_16x16x32_bf16 v[140:143], v[252:255], v[224:227], v[140:143]
    s_waitcnt lgkmcnt(6)
    v_mfma_f32_16x16x32_bf16 v[128:131], v[32:35], v[16:19], v[128:131]
    ds_read_b64_tr_b16 v[240:241], v10 offset:8192
    v_mfma_f32_16x16x32_bf16 v[144:147], v[32:35], v[20:23], v[144:147]
    ds_read_b64_tr_b16 v[242:243], v10 offset:9216
    v_mfma_f32_16x16x32_bf16 v[160:163], v[32:35], v[24:27], v[160:163]
    ds_read_b128 v[224:227], v9 offset:0
    v_mfma_f32_16x16x32_bf16 v[176:179], v[32:35], v[28:31], v[176:179]
    ds_read_b128 v[228:231], v9 offset:2048
    s_waitcnt lgkmcnt(8)
    v_mfma_f32_16x16x32_bf16 v[180:183], v[36:39], v[28:31], v[180:183]
    ds_read_b128 v[232:235], v9 offset:4096
    v_mfma_f32_16x16x32_bf16 v[164:167], v[36:39], v[24:27], v[164:167]
    ds_read_b128 v[236:239], v9 offset:6144
    v_mfma_f32_16x16x32_bf16 v[148:151], v[36:39], v[20:23], v[148:151]
    ds_read_b64_tr_b16 v[244:245], v11 offset:8192
    v_mfma_f32_16x16x32_bf16 v[132:135], v[36:39], v[16:19], v[132:135]
    ds_read_b64_tr_b16 v[246:247], v11 offset:9216
    s_waitcnt lgkmcnt(10)
    v_mfma_f32_16x16x32_bf16 v[136:139], v[40:43], v[16:19], v[136:139]
    ds_read_b64_tr_b16 v[248:249], v12 offset:8192
    v_mfma_f32_16x16x32_bf16 v[152:155], v[40:43], v[20:23], v[152:155]
    ds_read_b64_tr_b16 v[250:251], v12 offset:9216
    v_mfma_f32_16x16x32_bf16 v[168:171], v[40:43], v[24:27], v[168:171]
    ds_read_b64_tr_b16 v[252:253], v13 offset:8192
    v_mfma_f32_16x16x32_bf16 v[184:187], v[40:43], v[28:31], v[184:187]
    ds_read_b64_tr_b16 v[254:255], v13 offset:9216
    s_waitcnt lgkmcnt(12)
    v_mfma_f32_16x16x32_bf16 v[188:191], v[44:47], v[28:31], v[188:191]
    v_mfma_f32_16x16x32_bf16 v[172:175], v[44:47], v[24:27], v[172:175]
    v_mfma_f32_16x16x32_bf16 v[156:159], v[44:47], v[20:23], v[156:159]
    v_mfma_f32_16x16x32_bf16 v[140:143], v[44:47], v[16:19], v[140:143]
    s_waitcnt lgkmcnt(6)
    v_mfma_f32_16x16x32_bf16 v[128:131], v[240:243], v[224:227], v[128:131]
    v_mfma_f32_16x16x32_bf16 v[144:147], v[240:243], v[228:231], v[144:147]
    v_mfma_f32_16x16x32_bf16 v[160:163], v[240:243], v[232:235], v[160:163]
    s_waitcnt lgkmcnt(0)
    s_barrier
    v_mfma_f32_16x16x32_bf16 v[176:179], v[240:243], v[236:239], v[176:179]
    ds_read_b64_tr_b16 v[32:33], v10 offset:16384
    s_lshl_b32 s54, s53, 7
    v_mfma_f32_16x16x32_bf16 v[180:183], v[244:247], v[236:239], v[180:183]
    ds_read_b64_tr_b16 v[34:35], v10 offset:17408
    v_mfma_f32_16x16x32_bf16 v[164:167], v[244:247], v[232:235], v[164:167]
    ds_read_b128 v[16:19], v8 offset:16384
    s_add_u32 m0, s52, 0
    v_mfma_f32_16x16x32_bf16 v[148:151], v[244:247], v[228:231], v[148:151]
    ds_read_b128 v[20:23], v8 offset:18432
    v_mfma_f32_16x16x32_bf16 v[132:135], v[244:247], v[224:227], v[132:135]
    ds_read_b128 v[24:27], v8 offset:20480
    s_mul_i32 s55, s53, 221184
    v_mfma_f32_16x16x32_bf16 v[136:139], v[248:251], v[224:227], v[136:139]
    ds_read_b128 v[28:31], v8 offset:22528
    v_mfma_f32_16x16x32_bf16 v[152:155], v[248:251], v[228:231], v[152:155]
    ds_read_b64_tr_b16 v[36:37], v11 offset:16384
    buffer_load_dwordx4 v208, s[8:11], s54 offen offset:0 lds
    v_mfma_f32_16x16x32_bf16 v[168:171], v[248:251], v[232:235], v[168:171]
    ds_read_b64_tr_b16 v[38:39], v11 offset:17408
    v_mfma_f32_16x16x32_bf16 v[184:187], v[248:251], v[236:239], v[184:187]
    ds_read_b64_tr_b16 v[40:41], v12 offset:16384
    buffer_load_dwordx4 v209, s[8:11], s54 offen offset:1024 lds
    v_mfma_f32_16x16x32_bf16 v[188:191], v[252:255], v[236:239], v[188:191]
    ds_read_b64_tr_b16 v[42:43], v12 offset:17408
    v_mfma_f32_16x16x32_bf16 v[172:175], v[252:255], v[232:235], v[172:175]
    ds_read_b64_tr_b16 v[44:45], v13 offset:16384
    buffer_load_dwordx4 v210, s[8:11], s54 offen offset:2048 lds
    v_mfma_f32_16x16x32_bf16 v[156:159], v[252:255], v[228:231], v[156:159]
    ds_read_b64_tr_b16 v[46:47], v13 offset:17408
    v_mfma_f32_16x16x32_bf16 v[140:143], v[252:255], v[224:227], v[140:143]
    buffer_load_dwordx4 v211, s[8:11], s54 offen offset:3072 lds
    s_add_u32 m0, s52, 65536
    s_add_u32 s53, s53, 1
    buffer_load_dwordx4 v212, s[16:19], s55 offen offset:0 lds
    buffer_load_dwordx4 v213, s[16:19], s55 offen offset:1024 lds
    buffer_load_dwordx4 v214, s[16:19], s55 offen offset:2048 lds
    buffer_load_dwordx4 v215, s[16:19], s55 offen offset:3072 lds
    s_cmp_eq_u32 s53, 10
    s_cselect_b32 s53, 0, s53
    s_waitcnt lgkmcnt(6)
    v_mfma_f32_16x16x32_bf16 v[128:131], v[32:35], v[16:19], v[128:131]
    ds_read_b64_tr_b16 v[240:241], v10 offset:24576
    v_mfma_f32_16x16x32_bf16 v[144:147], v[32:35], v[20:23], v[144:147]
    ds_read_b64_tr_b16 v[242:243], v10 offset:25600
    v_mfma_f32_16x16x32_bf16 v[160:163], v[32:35], v[24:27], v[160:163]
    ds_read_b128 v[224:227], v9 offset:16384
    v_mfma_f32_16x16x32_bf16 v[176:179], v[32:35], v[28:31], v[176:179]
    ds_read_b128 v[228:231], v9 offset:18432
    s_waitcnt lgkmcnt(8)
    v_mfma_f32_16x16x32_bf16 v[180:183], v[36:39], v[28:31], v[180:183]
    ds_read_b128 v[232:235], v9 offset:20480
    v_mfma_f32_16x16x32_bf16 v[164:167], v[36:39], v[24:27], v[164:167]
    ds_read_b128 v[236:239], v9 offset:22528
    v_mfma_f32_16x16x32_bf16 v[148:151], v[36:39], v[20:23], v[148:151]
    ds_read_b64_tr_b16 v[244:245], v11 offset:24576
    v_mfma_f32_16x16x32_bf16 v[132:135], v[36:39], v[16:19], v[132:135]
    ds_read_b64_tr_b16 v[246:247], v11 offset:25600
    s_waitcnt lgkmcnt(10)
    v_mfma_f32_16x16x32_bf16 v[136:139], v[40:43], v[16:19], v[136:139]
    ds_read_b64_tr_b16 v[248:249], v12 offset:24576
    v_mfma_f32_16x16x32_bf16 v[152:155], v[40:43], v[20:23], v[152:155]
    ds_read_b64_tr_b16 v[250:251], v12 offset:25600
    v_mfma_f32_16x16x32_bf16 v[168:171], v[40:43], v[24:27], v[168:171]
    ds_read_b64_tr_b16 v[252:253], v13 offset:24576
    v_mfma_f32_16x16x32_bf16 v[184:187], v[40:43], v[28:31], v[184:187]
    ds_read_b64_tr_b16 v[254:255], v13 offset:25600
    s_waitcnt lgkmcnt(12)
    v_mfma_f32_16x16x32_bf16 v[188:191], v[44:47], v[28:31], v[188:191]
    v_mfma_f32_16x16x32_bf16 v[172:175], v[44:47], v[24:27], v[172:175]
    v_mfma_f32_16x16x32_bf16 v[156:159], v[44:47], v[20:23], v[156:159]
    v_mfma_f32_16x16x32_bf16 v[140:143], v[44:47], v[16:19], v[140:143]
    s_waitcnt lgkmcnt(6)
    v_mfma_f32_16x16x32_bf16 v[128:131], v[240:243], v[224:227], v[128:131]
    v_mfma_f32_16x16x32_bf16 v[144:147], v[240:243], v[228:231], v[144:147]
    v_mfma_f32_16x16x32_bf16 v[160:163], v[240:243], v[232:235], v[160:163]
    s_waitcnt lgkmcnt(0)
    s_barrier
    v_mfma_f32_16x16x32_bf16 v[176:179], v[240:243], v[236:239], v[176:179]
    ds_read_b64_tr_b16 v[32:33], v10 offset:32768
    v_mfma_f32_16x16x32_bf16 v[180:183], v[244:247], v[236:239], v[180:183]
    ds_read_b64_tr_b16 v[34:35], v10 offset:33792
    v_mfma_f32_16x16x32_bf16 v[164:167], v[244:247], v[232:235], v[164:167]
    ds_read_b128 v[16:19], v8 offset:32768
    v_mfma_f32_16x16x32_bf16 v[148:151], v[244:247], v[228:231], v[148:151]
    ds_read_b128 v[20:23], v8 offset:34816
    v_mfma_f32_16x16x32_bf16 v[132:135], v[244:247], v[224:227], v[132:135]
    ds_read_b128 v[24:27], v8 offset:36864
    v_mfma_f32_16x16x32_bf16 v[136:139], v[248:251], v[224:227], v[136:139]
    ds_read_b128 v[28:31], v8 offset:38912
    v_mfma_f32_16x16x32_bf16 v[152:155], v[248:251], v[228:231], v[152:155]
    ds_read_b64_tr_b16 v[36:37], v11 offset:32768
    v_mfma_f32_16x16x32_bf16 v[168:171], v[248:251], v[232:235], v[168:171]
    ds_read_b64_tr_b16 v[38:39], v11 offset:33792
    v_mfma_f32_16x16x32_bf16 v[184:187], v[248:251], v[236:239], v[184:187]
    ds_read_b64_tr_b16 v[40:41], v12 offset:32768
    v_mfma_f32_16x16x32_bf16 v[188:191], v[252:255], v[236:239], v[188:191]
    ds_read_b64_tr_b16 v[42:43], v12 offset:33792
    v_mfma_f32_16x16x32_bf16 v[172:175], v[252:255], v[232:235], v[172:175]
    ds_read_b64_tr_b16 v[44:45], v13 offset:32768
    v_mfma_f32_16x16x32_bf16 v[156:159], v[252:255], v[228:231], v[156:159]
    ds_read_b64_tr_b16 v[46:47], v13 offset:33792
    v_mfma_f32_16x16x32_bf16 v[140:143], v[252:255], v[224:227], v[140:143]
    s_waitcnt lgkmcnt(6)
    v_mfma_f32_16x16x32_bf16 v[128:131], v[32:35], v[16:19], v[128:131]
    ds_read_b64_tr_b16 v[240:241], v10 offset:40960
    v_mfma_f32_16x16x32_bf16 v[144:147], v[32:35], v[20:23], v[144:147]
    ds_read_b64_tr_b16 v[242:243], v10 offset:41984
    v_mfma_f32_16x16x32_bf16 v[160:163], v[32:35], v[24:27], v[160:163]
    ds_read_b128 v[224:227], v9 offset:32768
    v_mfma_f32_16x16x32_bf16 v[176:179], v[32:35], v[28:31], v[176:179]
    ds_read_b128 v[228:231], v9 offset:34816
    s_waitcnt lgkmcnt(8)
    v_mfma_f32_16x16x32_bf16 v[180:183], v[36:39], v[28:31], v[180:183]
    ds_read_b128 v[232:235], v9 offset:36864
    v_mfma_f32_16x16x32_bf16 v[164:167], v[36:39], v[24:27], v[164:167]
    ds_read_b128 v[236:239], v9 offset:38912
    v_mfma_f32_16x16x32_bf16 v[148:151], v[36:39], v[20:23], v[148:151]
    ds_read_b64_tr_b16 v[244:245], v11 offset:40960
    v_mfma_f32_16x16x32_bf16 v[132:135], v[36:39], v[16:19], v[132:135]
    ds_read_b64_tr_b16 v[246:247], v11 offset:41984
    s_waitcnt lgkmcnt(10)
    v_mfma_f32_16x16x32_bf16 v[136:139], v[40:43], v[16:19], v[136:139]
    ds_read_b64_tr_b16 v[248:249], v12 offset:40960
    v_mfma_f32_16x16x32_bf16 v[152:155], v[40:43], v[20:23], v[152:155]
    ds_read_b64_tr_b16 v[250:251], v12 offset:41984
    v_mfma_f32_16x16x32_bf16 v[168:171], v[40:43], v[24:27], v[168:171]
    ds_read_b64_tr_b16 v[252:253], v13 offset:40960
    v_mfma_f32_16x16x32_bf16 v[184:187], v[40:43], v[28:31], v[184:187]
    ds_read_b64_tr_b16 v[254:255], v13 offset:41984
    s_waitcnt lgkmcnt(12)
    v_mfma_f32_16x16x32_bf16 v[188:191], v[44:47], v[28:31], v[188:191]
    v_mfma_f32_16x16x32_bf16 v[172:175], v[44:47], v[24:27], v[172:175]
    v_mfma_f32_16x16x32_bf16 v[156:159], v[44:47], v[20:23], v[156:159]
    v_mfma_f32_16x16x32_bf16 v[140:143], v[44:47], v[16:19], v[140:143]
    s_waitcnt lgkmcnt(6)
    v_mfma_f32_16x16x32_bf16 v[128:131], v[240:243], v[224:227], v[128:131]
    v_mfma_f32_16x16x32_bf16 v[144:147], v[240:243], v[228:231], v[144:147]
    v_mfma_f32_16x16x32_bf16 v[160:163], v[240:243], v[232:235], v[160:163]
    s_waitcnt vmcnt(0) lgkmcnt(0)
    s_mov_b64 exec, 1
    ds_add_u32 v220, v221
    ds_add_u32 v222, v221
    s_mov_b64 exec, -1
    s_mov_b32 s71, 80000
L_w47:
    ds_read_b32 v6, v220 offset:0
    s_waitcnt lgkmcnt(0)
    v_readfirstlane_b32 s70, v6
    s_cmp_ge_u32 s70, 4
    s_cbranch_scc1 L_wd48
    s_sub_u32 s71, s71, 1
    s_cmp_lg_u32 s71, 0
    s_cbranch_scc1 L_w47
L_wd48:
    v_mfma_f32_16x16x32_bf16 v[176:179], v[240:243], v[236:239], v[176:179]
    ds_read_b64_tr_b16 v[32:33], v10 offset:0
    v_mfma_f32_16x16x32_bf16 v[180:183], v[244:247], v[236:239], v[180:183]
    ds_read_b64_tr_b16 v[34:35], v10 offset:1024
    v_mfma_f32_16x16x32_bf16 v[164:167], v[244:247], v[232:235], v[164:167]
    ds_read_b128 v[16:19], v8 offset:0
    v_mfma_f32_16x16x32_bf16 v[148:151], v[244:247], v[228:231], v[148:151]
    ds_read_b128 v[20:23], v8 offset:2048
    v_mfma_f32_16x16x32_bf16 v[132:135], v[244:247], v[224:227], v[132:135]
    ds_read_b128 v[24:27], v8 offset:4096
    v_mfma_f32_16x16x32_bf16 v[136:139], v[248:251], v[224:227], v[136:139]
    ds_read_b128 v[28:31], v8 offset:6144
    v_mfma_f32_16x16x32_bf16 v[152:155], v[248:251], v[228:231], v[152:155]
    ds_read_b64_tr_b16 v[36:37], v11 offset:0
    v_mfma_f32_16x16x32_bf16 v[168:171], v[248:251], v[232:235], v[168:171]
    ds_read_b64_tr_b16 v[38:39], v11 offset:1024
    v_mfma_f32_16x16x32_bf16 v[184:187], v[248:251], v[236:239], v[184:187]
    ds_read_b64_tr_b16 v[40:41], v12 offset:0
    v_mfma_f32_16x16x32_bf16 v[188:191], v[252:255], v[236:239], v[188:191]
    ds_read_b64_tr_b16 v[42:43], v12 offset:1024
    v_mfma_f32_16x16x32_bf16 v[172:175], v[252:255], v[232:235], v[172:175]
    ds_read_b64_tr_b16 v[44:45], v13 offset:0
    v_mfma_f32_16x16x32_bf16 v[156:159], v[252:255], v[228:231], v[156:159]
    ds_read_b64_tr_b16 v[46:47], v13 offset:1024
    v_mfma_f32_16x16x32_bf16 v[140:143], v[252:255], v[224:227], v[140:143]
    s_waitcnt lgkmcnt(6)
    v_mfma_f32_16x16x32_bf16 v[128:131], v[32:35], v[16:19], v[128:131]
    ds_read_b64_tr_b16 v[240:241], v10 offset:8192
    v_mfma_f32_16x16x32_bf16 v[144:147], v[32:35], v[20:23], v[144:147]
    ds_read_b64_tr_b16 v[242:243], v10 offset:9216
    v_mfma_f32_16x16x32_bf16 v[160:163], v[32:35], v[24:27], v[160:163]
    ds_read_b128 v[224:227], v9 offset:0
    v_mfma_f32_16x16x32_bf16 v[176:179], v[32:35], v[28:31], v[176:179]
    ds_read_b128 v[228:231], v9 offset:2048
    s_waitcnt lgkmcnt(8)
    v_mfma_f32_16x16x32_bf16 v[180:183], v[36:39], v[28:31], v[180:183]
    ds_read_b128 v[232:235], v9 offset:4096
    v_mfma_f32_16x16x32_bf16 v[164:167], v[36:39], v[24:27], v[164:167]
    ds_read_b128 v[236:239], v9 offset:6144
    v_mfma_f32_16x16x32_bf16 v[148:151], v[36:39], v[20:23], v[148:151]
    ds_read_b64_tr_b16 v[244:245], v11 offset:8192
    v_mfma_f32_16x16x32_bf16 v[132:135], v[36:39], v[16:19], v[132:135]
    ds_read_b64_tr_b16 v[246:247], v11 offset:9216
    s_waitcnt lgkmcnt(10)
    v_mfma_f32_16x16x32_bf16 v[136:139], v[40:43], v[16:19], v[136:139]
    ds_read_b64_tr_b16 v[248:249], v12 offset:8192
    v_mfma_f32_16x16x32_bf16 v[152:155], v[40:43], v[20:23], v[152:155]
    ds_read_b64_tr_b16 v[250:251], v12 offset:9216
    v_mfma_f32_16x16x32_bf16 v[168:171], v[40:43], v[24:27], v[168:171]
    ds_read_b64_tr_b16 v[252:253], v13 offset:8192
    v_mfma_f32_16x16x32_bf16 v[184:187], v[40:43], v[28:31], v[184:187]
    ds_read_b64_tr_b16 v[254:255], v13 offset:9216
    s_waitcnt lgkmcnt(12)
    v_mfma_f32_16x16x32_bf16 v[188:191], v[44:47], v[28:31], v[188:191]
    v_mfma_f32_16x16x32_bf16 v[172:175], v[44:47], v[24:27], v[172:175]
    v_mfma_f32_16x16x32_bf16 v[156:159], v[44:47], v[20:23], v[156:159]
    v_mfma_f32_16x16x32_bf16 v[140:143], v[44:47], v[16:19], v[140:143]
    s_waitcnt lgkmcnt(6)
    v_mfma_f32_16x16x32_bf16 v[128:131], v[240:243], v[224:227], v[128:131]
    v_mfma_f32_16x16x32_bf16 v[144:147], v[240:243], v[228:231], v[144:147]
    v_mfma_f32_16x16x32_bf16 v[160:163], v[240:243], v[232:235], v[160:163]
    v_mfma_f32_16x16x32_bf16 v[176:179], v[240:243], v[236:239], v[176:179]
    s_waitcnt lgkmcnt(4)
    v_mfma_f32_16x16x32_bf16 v[180:183], v[244:247], v[236:239], v[180:183]
    v_mfma_f32_16x16x32_bf16 v[164:167], v[244:247], v[232:235], v[164:167]
    v_mfma_f32_16x16x32_bf16 v[148:151], v[244:247], v[228:231], v[148:151]
    v_mfma_f32_16x16x32_bf16 v[132:135], v[244:247], v[224:227], v[132:135]
    s_waitcnt lgkmcnt(2)
    v_mfma_f32_16x16x32_bf16 v[136:139], v[248:251], v[224:227], v[136:139]
    v_mfma_f32_16x16x32_bf16 v[152:155], v[248:251], v[228:231], v[152:155]
    v_mfma_f32_16x16x32_bf16 v[168:171], v[248:251], v[232:235], v[168:171]
    v_mfma_f32_16x16x32_bf16 v[184:187], v[248:251], v[236:239], v[184:187]
    s_waitcnt lgkmcnt(0)
    v_mfma_f32_16x16x32_bf16 v[188:191], v[252:255], v[236:239], v[188:191]
    v_mfma_f32_16x16x32_bf16 v[172:175], v[252:255], v[232:235], v[172:175]
    v_mfma_f32_16x16x32_bf16 v[156:159], v[252:255], v[228:231], v[156:159]
    v_mfma_f32_16x16x32_bf16 v[140:143], v[252:255], v[224:227], v[140:143]
    s_nop 7
    s_setprio 2
    ds_read_b32 v6, v222 offset:16
    ds_read_b128 v[64:67], v62 offset:512
    ds_read_b128 v[68:71], v62 offset:576
    ds_read_b128 v[72:75], v62 offset:640
    ds_read_b128 v[76:79], v62 offset:704
    ds_read_b32 v80, v15 offset:0
    ds_read_b32 v82, v15 offset:3584
    ds_read_b32 v84, v15 offset:1024
    ds_read_b32 v86, v15 offset:64
    ds_read_b32 v88, v15 offset:3648
    ds_read_b32 v90, v15 offset:1088
    ds_read_b32 v92, v15 offset:128
    ds_read_b32 v94, v15 offset:3712
    ds_read_b32 v96, v15 offset:1152
    ds_read_b32 v98, v15 offset:192
    ds_read_b32 v100, v15 offset:3776
    ds_read_b32 v102, v15 offset:1216
    s_waitcnt lgkmcnt(0)
    v_readfirstlane_b32 s64, v6
    s_lshl_b32 s42, s61, 1
    s_add_u32 s42, s42, s41
    s_cmp_ge_u32 s42, 27
    s_cbranch_scc1 L_g_hdone
    v_pk_fma_f32 v[128:129], v[64:65], v[80:81], v[128:129] op_sel_hi:[1,0,1]
    v_pk_fma_f32 v[130:131], v[66:67], v[80:81], v[130:131] op_sel_hi:[1,0,1]
    v_pk_fma_f32 v[132:133], v[68:69], v[80:81], v[132:133] op_sel_hi:[1,0,1]
    v_pk_fma_f32 v[134:135], v[70:71], v[80:81], v[134:135] op_sel_hi:[1,0,1]
    v_pk_fma_f32 v[136:137], v[72:73], v[80:81], v[136:137] op_sel_hi:[1,0,1]
    v_pk_fma_f32 v[138:139], v[74:75], v[80:81], v[138:139] op_sel_hi:[1,0,1]
    v_pk_fma_f32 v[140:141], v[76:77], v[80:81], v[140:141] op_sel_hi:[1,0,1]
    v_pk_fma_f32 v[142:143], v[78:79], v[80:81], v[142:143] op_sel_hi:[1,0,1]
    v_pk_mul_f32 v[192:193], v[128:129], v[82:83] op_sel_hi:[1,0]
    v_pk_mul_f32 v[194:195], v[130:131], v[82:83] op_sel_hi:[1,0]
    v_pk_mul_f32 v[196:197], v[132:133], v[82:83] op_sel_hi:[1,0]
    v_pk_mul_f32 v[198:199], v[134:135], v[82:83] op_sel_hi:[1,0]
    v_pk_mul_f32 v[200:201], v[136:137], v[82:83] op_sel_hi:[1,0]
    v_pk_mul_f32 v[202:203], v[138:139], v[82:83] op_sel_hi:[1,0]
    v_pk_mul_f32 v[204:205], v[140:141], v[82:83] op_sel_hi:[1,0]
    v_pk_mul_f32 v[206:207], v[142:143], v[82:83] op_sel_hi:[1,0]
    v_exp_f32 v192, v192
    v_exp_f32 v193, v193
    v_exp_f32 v194, v194
    v_exp_f32 v195, v195
    v_exp_f32 v196, v196
    v_exp_f32 v197, v197
    v_exp_f32 v198, v198
    v_exp_f32 v199, v199
    v_exp_f32 v200, v200
    v_exp_f32 v201, v201
    v_exp_f32 v202, v202
    v_exp_f32 v203, v203
    v_exp_f32 v204, v204
    v_exp_f32 v205, v205
    v_exp_f32 v206, v206
    v_exp_f32 v207, v207
    v_pk_fma_f32 v[192:193], v[192:193], v[84:85], v[84:85] op_sel_hi:[1,0,0]
    v_pk_fma_f32 v[194:195], v[194:195], v[84:85], v[84:85] op_sel_hi:[1,0,0]
    v_pk_fma_f32 v[196:197], v[196:197], v[84:85], v[84:85] op_sel_hi:[1,0,0]
    v_pk_fma_f32 v[198:199], v[198:199], v[84:85], v[84:85] op_sel_hi:[1,0,0]
    v_pk_fma_f32 v[200:201], v[200:201], v[84:85], v[84:85] op_sel_hi:[1,0,0]
    v_pk_fma_f32 v[202:203], v[202:203], v[84:85], v[84:85] op_sel_hi:[1,0,0]
    v_pk_fma_f32 v[204:205], v[204:205], v[84:85], v[84:85] op_sel_hi:[1,0,0]
    v_pk_fma_f32 v[206:207], v[206:207], v[84:85], v[84:85] op_sel_hi:[1,0,0]
    v_rcp_f32 v192, v192
    v_rcp_f32 v193, v193
    v_rcp_f32 v194, v194
    v_rcp_f32 v195, v195
    v_rcp_f32 v196, v196
    v_rcp_f32 v197, v197
    v_rcp_f32 v198, v198
    v_rcp_f32 v199, v199
    v_rcp_f32 v200, v200
    v_rcp_f32 v201, v201
    v_rcp_f32 v202, v202
    v_rcp_f32 v203, v203
    v_rcp_f32 v204, v204
    v_rcp_f32 v205, v205
    v_rcp_f32 v206, v206
    v_rcp_f32 v207, v207
    v_pk_mul_f32 v[192:193], v[192:193], v[128:129]
    v_pk_mul_f32 v[194:195], v[194:195], v[130:131]
    v_pk_mul_f32 v[196:197], v[196:197], v[132:133]
    v_pk_mul_f32 v[198:199], v[198:199], v[134:135]
    v_pk_mul_f32 v[200:201], v[200:201], v[136:137]
    v_pk_mul_f32 v[202:203], v[202:203], v[138:139]
    v_pk_mul_f32 v[204:205], v[204:205], v[140:141]
    v_pk_mul_f32 v[206:207], v[206:207], v[142:143]
    v_cvt_pk_bf16_f32 v128, v192, v193
    v_cvt_pk_bf16_f32 v129, v194, v195
    v_cvt_pk_bf16_f32 v130, v196, v197
    v_cvt_pk_bf16_f32 v131, v198, v199
    v_cvt_pk_bf16_f32 v132, v200, v201
    v_cvt_pk_bf16_f32 v133, v202, v203
    v_cvt_pk_bf16_f32 v134, v204, v205
    v_cvt_pk_bf16_f32 v135, v206, v207
    buffer_store_dwordx4 v[128:131], v14, s[4:7], s46 offen offset:0 sc1
    buffer_store_dwordx4 v[132:135], v14, s[4:7], s46 offen offset:2048 sc1
    v_pk_fma_f32 v[144:145], v[64:65], v[86:87], v[144:145] op_sel_hi:[1,0,1]
    v_pk_fma_f32 v[146:147], v[66:67], v[86:87], v[146:147] op_sel_hi:[1,0,1]
    v_pk_fma_f32 v[148:149], v[68:69], v[86:87], v[148:149] op_sel_hi:[1,0,1]
    v_pk_fma_f32 v[150:151], v[70:71], v[86:87], v[150:151] op_sel_hi:[1,0,1]
    v_pk_fma_f32 v[152:153], v[72:73], v[86:87], v[152:153] op_sel_hi:[1,0,1]
    v_pk_fma_f32 v[154:155], v[74:75], v[86:87], v[154:155] op_sel_hi:[1,0,1]
    v_pk_fma_f32 v[156:157], v[76:77], v[86:87], v[156:157] op_sel_hi:[1,0,1]
    v_pk_fma_f32 v[158:159], v[78:79], v[86:87], v[158:159] op_sel_hi:[1,0,1]
    v_pk_mul_f32 v[192:193], v[144:145], v[88:89] op_sel_hi:[1,0]
    v_pk_mul_f32 v[194:195], v[146:147], v[88:89] op_sel_hi:[1,0]
    v_pk_mul_f32 v[196:197], v[148:149], v[88:89] op_sel_hi:[1,0]
    v_pk_mul_f32 v[198:199], v[150:151], v[88:89] op_sel_hi:[1,0]
    v_pk_mul_f32 v[200:201], v[152:153], v[88:89] op_sel_hi:[1,0]
    v_pk_mul_f32 v[202:203], v[154:155], v[88:89] op_sel_hi:[1,0]
    v_pk_mul_f32 v[204:205], v[156:157], v[88:89] op_sel_hi:[1,0]
    v_pk_mul_f32 v[206:207], v[158:159], v[88:89] op_sel_hi:[1,0]
    v_exp_f32 v192, v192
    v_exp_f32 v193, v193
    v_exp_f32 v194, v194
    v_exp_f32 v195, v195
    v_exp_f32 v196, v196
    v_exp_f32 v197, v197
    v_exp_f32 v198, v198
    v_exp_f32 v199, v199
    v_exp_f32 v200, v200
    v_exp_f32 v201, v201
    v_exp_f32 v202, v202
    v_exp_f32 v203, v203
    v_exp_f32 v204, v204
    v_exp_f32 v205, v205
    v_exp_f32 v206, v206
    v_exp_f32 v207, v207
    v_pk_fma_f32 v[192:193], v[192:193], v[90:91], v[90:91] op_sel_hi:[1,0,0]
    v_pk_fma_f32 v[194:195], v[194:195], v[90:91], v[90:91] op_sel_hi:[1,0,0]
    v_pk_fma_f32 v[196:197], v[196:197], v[90:91], v[90:91] op_sel_hi:[1,0,0]
    v_pk_fma_f32 v[198:199], v[198:199], v[90:91], v[90:91] op_sel_hi:[1,0,0]
    v_pk_fma_f32 v[200:201], v[200:201], v[90:91], v[90:91] op_sel_hi:[1,0,0]
    v_pk_fma_f32 v[202:203], v[202:203], v[90:91], v[90:91] op_sel_hi:[1,0,0]
    v_pk_fma_f32 v[204:205], v[204:205], v[90:91], v[90:91] op_sel_hi:[1,0,0]
    v_pk_fma_f32 v[206:207], v[206:207], v[90:91], v[90:91] op_sel_hi:[1,0,0]
    v_rcp_f32 v192, v192
    v_rcp_f32 v193, v193
    v_rcp_f32 v194, v194
    v_rcp_f32 v195, v195
    v_rcp_f32 v196, v196
    v_rcp_f32 v197, v197
    v_rcp_f32 v198, v198
    v_rcp_f32 v199, v199
    v_rcp_f32 v200, v200
    v_rcp_f32 v201, v201
    v_rcp_f32 v202, v202
    v_rcp_f32 v203, v203
    v_rcp_f32 v204, v204
    v_rcp_f32 v205, v205
    v_rcp_f32 v206, v206
    v_rcp_f32 v207, v207
    v_pk_mul_f32 v[192:193], v[192:193], v[144:145]
    v_pk_mul_f32 v[194:195], v[194:195], v[146:147]
    v_pk_mul_f32 v[196:197], v[196:197], v[148:149]
    v_pk_mul_f32 v[198:199], v[198:199], v[150:151]
    v_pk_mul_f32 v[200:201], v[200:201], v[152:153]
    v_pk_mul_f32 v[202:203], v[202:203], v[154:155]
    v_pk_mul_f32 v[204:205], v[204:205], v[156:157]
    v_pk_mul_f32 v[206:207], v[206:207], v[158:159]
    v_cvt_pk_bf16_f32 v144, v192, v193
    v_cvt_pk_bf16_f32 v145, v194, v195
    v_cvt_pk_bf16_f32 v146, v196, v197
    v_cvt_pk_bf16_f32 v147, v198, v199
    v_cvt_pk_bf16_f32 v148, v200, v201
    v_cvt_pk_bf16_f32 v149, v202, v203
    v_cvt_pk_bf16_f32 v150, v204, v205
    v_cvt_pk_bf16_f32 v151, v206, v207
    buffer_store_dwordx4 v[144:147], v14, s[4:7], s46 offen offset:256 sc1
    buffer_store_dwordx4 v[148:151], v14, s[4:7], s46 offen offset:2304 sc1
    v_pk_fma_f32 v[160:161], v[64:65], v[92:93], v[160:161] op_sel_hi:[1,0,1]
    v_pk_fma_f32 v[162:163], v[66:67], v[92:93], v[162:163] op_sel_hi:[1,0,1]
    v_pk_fma_f32 v[164:165], v[68:69], v[92:93], v[164:165] op_sel_hi:[1,0,1]
    v_pk_fma_f32 v[166:167], v[70:71], v[92:93], v[166:167] op_sel_hi:[1,0,1]
    v_pk_fma_f32 v[168:169], v[72:73], v[92:93], v[168:169] op_sel_hi:[1,0,1]
    v_pk_fma_f32 v[170:171], v[74:75], v[92:93], v[170:171] op_sel_hi:[1,0,1]
    v_pk_fma_f32 v[172:173], v[76:77], v[92:93], v[172:173] op_sel_hi:[1,0,1]
    v_pk_fma_f32 v[174:175], v[78:79], v[92:93], v[174:175] op_sel_hi:[1,0,1]
    v_pk_mul_f32 v[192:193], v[160:161], v[94:95] op_sel_hi:[1,0]
    v_pk_mul_f32 v[194:195], v[162:163], v[94:95] op_sel_hi:[1,0]
    v_pk_mul_f32 v[196:197], v[164:165], v[94:95] op_sel_hi:[1,0]
    v_pk_mul_f32 v[198:199], v[166:167], v[94:95] op_sel_hi:[1,0]
    v_pk_mul_f32 v[200:201], v[168:169], v[94:95] op_sel_hi:[1,0]
    v_pk_mul_f32 v[202:203], v[170:171], v[94:95] op_sel_hi:[1,0]
    v_pk_mul_f32 v[204:205], v[172:173], v[94:95] op_sel_hi:[1,0]
    v_pk_mul_f32 v[206:207], v[174:175], v[94:95] op_sel_hi:[1,0]
    v_exp_f32 v192, v192
    v_exp_f32 v193, v193
    v_exp_f32 v194, v194
    v_exp_f32 v195, v195
    v_exp_f32 v196, v196
    v_exp_f32 v197, v197
    v_exp_f32 v198, v198
    v_exp_f32 v199, v199
    v_exp_f32 v200, v200
    v_exp_f32 v201, v201
    v_exp_f32 v202, v202
    v_exp_f32 v203, v203
    v_exp_f32 v204, v204
    v_exp_f32 v205, v205
    v_exp_f32 v206, v206
    v_exp_f32 v207, v207
    v_pk_fma_f32 v[192:193], v[192:193], v[96:97], v[96:97] op_sel_hi:[1,0,0]
    v_pk_fma_f32 v[194:195], v[194:195], v[96:97], v[96:97] op_sel_hi:[1,0,0]
    v_pk_fma_f32 v[196:197], v[196:197], v[96:97], v[96:97] op_sel_hi:[1,0,0]
    v_pk_fma_f32 v[198:199], v[198:199], v[96:97], v[96:97] op_sel_hi:[1,0,0]
    v_pk_fma_f32 v[200:201], v[200:201], v[96:97], v[96:97] op_sel_hi:[1,0,0]
    v_pk_fma_f32 v[202:203], v[202:203], v[96:97], v[96:97] op_sel_hi:[1,0,0]
    v_pk_fma_f32 v[204:205], v[204:205], v[96:97], v[96:97] op_sel_hi:[1,0,0]
    v_pk_fma_f32 v[206:207], v[206:207], v[96:97], v[96:97] op_sel_hi:[1,0,0]
    v_rcp_f32 v192, v192
    v_rcp_f32 v193, v193
    v_rcp_f32 v194, v194
    v_rcp_f32 v195, v195
    v_rcp_f32 v196, v196
    v_rcp_f32 v197, v197
    v_rcp_f32 v198, v198
    v_rcp_f32 v199, v199
    v_rcp_f32 v200, v200
    v_rcp_f32 v201, v201
    v_rcp_f32 v202, v202
    v_rcp_f32 v203, v203
    v_rcp_f32 v204, v204
    v_rcp_f32 v205, v205
    v_rcp_f32 v206, v206
    v_rcp_f32 v207, v207
    v_pk_mul_f32 v[192:193], v[192:193], v[160:161]
    v_pk_mul_f32 v[194:195], v[194:195], v[162:163]
    v_pk_mul_f32 v[196:197], v[196:197], v[164:165]
    v_pk_mul_f32 v[198:199], v[198:199], v[166:167]
    v_pk_mul_f32 v[200:201], v[200:201], v[168:169]
    v_pk_mul_f32 v[202:203], v[202:203], v[170:171]
    v_pk_mul_f32 v[204:205], v[204:205], v[172:173]
    v_pk_mul_f32 v[206:207], v[206:207], v[174:175]
    v_cvt_pk_bf16_f32 v160, v192, v193
    v_cvt_pk_bf16_f32 v161, v194, v195
    v_cvt_pk_bf16_f32 v162, v196, v197
    v_cvt_pk_bf16_f32 v163, v198, v199
    v_cvt_pk_bf16_f32 v164, v200, v201
    v_cvt_pk_bf16_f32 v165, v202, v203
    v_cvt_pk_bf16_f32 v166, v204, v205
    v_cvt_pk_bf16_f32 v167, v206, v207
    buffer_store_dwordx4 v[160:163], v14, s[4:7], s47 offen offset:0 sc1
    buffer_store_dwordx4 v[164:167], v14, s[4:7], s47 offen offset:2048 sc1
    v_pk_fma_f32 v[176:177], v[64:65], v[98:99], v[176:177] op_sel_hi:[1,0,1]
    v_pk_fma_f32 v[178:179], v[66:67], v[98:99], v[178:179] op_sel_hi:[1,0,1]
    v_pk_fma_f32 v[180:181], v[68:69], v[98:99], v[180:181] op_sel_hi:[1,0,1]
    v_pk_fma_f32 v[182:183], v[70:71], v[98:99], v[182:183] op_sel_hi:[1,0,1]
    v_pk_fma_f32 v[184:185], v[72:73], v[98:99], v[184:185] op_sel_hi:[1,0,1]
    v_pk_fma_f32 v[186:187], v[74:75], v[98:99], v[186:187] op_sel_hi:[1,0,1]
    v_pk_fma_f32 v[188:189], v[76:77], v[98:99], v[188:189] op_sel_hi:[1,0,1]
    v_pk_fma_f32 v[190:191], v[78:79], v[98:99], v[190:191] op_sel_hi:[1,0,1]
    v_pk_mul_f32 v[192:193], v[176:177], v[100:101] op_sel_hi:[1,0]
    v_pk_mul_f32 v[194:195], v[178:179], v[100:101] op_sel_hi:[1,0]
    v_pk_mul_f32 v[196:197], v[180:181], v[100:101] op_sel_hi:[1,0]
    v_pk_mul_f32 v[198:199], v[182:183], v[100:101] op_sel_hi:[1,0]
    v_pk_mul_f32 v[200:201], v[184:185], v[100:101] op_sel_hi:[1,0]
    v_pk_mul_f32 v[202:203], v[186:187], v[100:101] op_sel_hi:[1,0]
    v_pk_mul_f32 v[204:205], v[188:189], v[100:101] op_sel_hi:[1,0]
    v_pk_mul_f32 v[206:207], v[190:191], v[100:101] op_sel_hi:[1,0]
    v_exp_f32 v192, v192
    v_exp_f32 v193, v193
    v_exp_f32 v194, v194
    v_exp_f32 v195, v195
    v_exp_f32 v196, v196
    v_exp_f32 v197, v197
    v_exp_f32 v198, v198
    v_exp_f32 v199, v199
    v_exp_f32 v200, v200
    v_exp_f32 v201, v201
    v_exp_f32 v202, v202
    v_exp_f32 v203, v203
    v_exp_f32 v204, v204
    v_exp_f32 v205, v205
    v_exp_f32 v206, v206
    v_exp_f32 v207, v207
    v_pk_fma_f32 v[192:193], v[192:193], v[102:103], v[102:103] op_sel_hi:[1,0,0]
    v_pk_fma_f32 v[194:195], v[194:195], v[102:103], v[102:103] op_sel_hi:[1,0,0]
    v_pk_fma_f32 v[196:197], v[196:197], v[102:103], v[102:103] op_sel_hi:[1,0,0]
    v_pk_fma_f32 v[198:199], v[198:199], v[102:103], v[102:103] op_sel_hi:[1,0,0]
    v_pk_fma_f32 v[200:201], v[200:201], v[102:103], v[102:103] op_sel_hi:[1,0,0]
    v_pk_fma_f32 v[202:203], v[202:203], v[102:103], v[102:103] op_sel_hi:[1,0,0]
    v_pk_fma_f32 v[204:205], v[204:205], v[102:103], v[102:103] op_sel_hi:[1,0,0]
    v_pk_fma_f32 v[206:207], v[206:207], v[102:103], v[102:103] op_sel_hi:[1,0,0]
    v_rcp_f32 v192, v192
    v_rcp_f32 v193, v193
    v_rcp_f32 v194, v194
    v_rcp_f32 v195, v195
    v_rcp_f32 v196, v196
    v_rcp_f32 v197, v197
    v_rcp_f32 v198, v198
    v_rcp_f32 v199, v199
    v_rcp_f32 v200, v200
    v_rcp_f32 v201, v201
    v_rcp_f32 v202, v202
    v_rcp_f32 v203, v203
    v_rcp_f32 v204, v204
    v_rcp_f32 v205, v205
    v_rcp_f32 v206, v206
    v_rcp_f32 v207, v207
    v_pk_mul_f32 v[192:193], v[192:193], v[176:177]
    v_pk_mul_f32 v[194:195], v[194:195], v[178:179]
    v_pk_mul_f32 v[196:197], v[196:197], v[180:181]
    v_pk_mul_f32 v[198:199], v[198:199], v[182:183]
    v_pk_mul_f32 v[200:201], v[200:201], v[184:185]
    v_pk_mul_f32 v[202:203], v[202:203], v[186:187]
    v_pk_mul_f32 v[204:205], v[204:205], v[188:189]
    v_pk_mul_f32 v[206:207], v[206:207], v[190:191]
    v_cvt_pk_bf16_f32 v176, v192, v193
    v_cvt_pk_bf16_f32 v177, v194, v195
    v_cvt_pk_bf16_f32 v178, v196, v197
    v_cvt_pk_bf16_f32 v179, v198, v199
    v_cvt_pk_bf16_f32 v180, v200, v201
    v_cvt_pk_bf16_f32 v181, v202, v203
    v_cvt_pk_bf16_f32 v182, v204, v205
    v_cvt_pk_bf16_f32 v183, v206, v207
    buffer_store_dwordx4 v[176:179], v14, s[4:7], s47 offen offset:256 sc1
    buffer_store_dwordx4 v[180:183], v14, s[4:7], s47 offen offset:2304 sc1
L_g_hdone:
    s_waitcnt vmcnt(0)
    v_mov_b32 v5, 162312
    v_mov_b32 v6, 1
    s_mov_b64 exec, 1
    ds_add_rtn_u32 v7, v5, v6
    s_waitcnt lgkmcnt(0)
    v_readfirstlane_b32 s70, v7
    s_mov_b64 exec, -1
    s_cmp_lg_u32 s70, 3
    s_cbranch_scc1 L_g_tail
    s_lshl_b32 s42, s59, 4
    s_add_u32 s42, s42, s61
    s_lshl_b32 s42, s42, 7
    s_add_u32 s42, s42, 0x142a000
    v_mov_b32 v5, 0
    v_mov_b32 v6, s64
    s_mov_b64 exec, 1
    buffer_store_dword v6, v5, s[20:23], s42 offen sc1
    s_mov_b64 exec, -1
    s_branch L_g_tail
L_g_now1:
    s_barrier
    s_barrier
    v_mov_b32 v5, 162304
    v_mov_b32 v6, 1
    s_mov_b64 exec, 1
    ds_add_u32 v5, v6
    s_mov_b64 exec, -1
    s_cmp_eq_u32 s60, 15
    s_cbranch_scc1 L_q49
    v_mov_b32 v5, 162320
    ds_read_b32 v6, v5
    s_waitcnt vmcnt(0) lgkmcnt(0)
    v_readfirstlane_b32 s64, v6
    v_mov_b32 v5, 162328
    v_mov_b32 v6, 1
    s_mov_b64 exec, 1
    ds_add_rtn_u32 v7, v5, v6
    s_waitcnt lgkmcnt(0)
    v_readfirstlane_b32 s70, v7
    s_mov_b64 exec, -1
    s_cmp_lg_u32 s70, 3
    s_cbranch_scc1 L_q49
    s_lshl_b32 s42, s60, 4
    s_add_u32 s42, s42, s59
    s_lshl_b32 s42, s42, 7
    s_add_u32 s42, s42, 0x1422000
    v_mov_b32 v5, 0
    v_mov_b32 v6, s64
    s_mov_b64 exec, 1
    buffer_store_dword v6, v5, s[20:23], s42 offen sc1
    s_mov_b64 exec, -1
L_q49:
    v_mov_b32 v5, 162320
    ds_read_b32 v6, v5
    s_waitcnt lgkmcnt(0)
    v_readfirstlane_b32 s64, v6
    v_mov_b32 v5, 162312
    v_mov_b32 v6, 1
    s_mov_b64 exec, 1
    ds_add_rtn_u32 v7, v5, v6
    s_waitcnt lgkmcnt(0)
    v_readfirstlane_b32 s70, v7
    s_mov_b64 exec, -1
    s_cmp_lg_u32 s70, 3
    s_cbranch_scc1 L_g_tail
L_g_tail:
    s_setprio 2
    s_cmp_ge_u32 s58, 2
    s_cbranch_scc1 L_g50
    s_mul_i32 s42, s2, 8640
    s_lshl_b32 s43, s58, 12
    s_add_u32 s42, s42, s43
    v_min_u32 v5, 35, v2
    v_lshlrev_b32 v5, 7, v5
    v_add_u32 v5, s42, v5
    buffer_load_dword v159, v5, s[28:31], 0 offen
    s_mul_i32 s42, s2, 3200
    v_min_u32 v5, 24, v2
    v_lshlrev_b32 v5, 7, v5
    v_add_u32 v5, s42, v5
    buffer_load_dword v159, v5, s[32:35], 0 offen
L_g50:
    s_mov_b32 s42, 0x54381c00
    s_mov_b32 s43, 0xbfa28970
    s_lshl_b32 s44, s62, 3
    s_lshr_b64 s[40:41], s[42:43], s44
    s_bfe_u32 s41, s40, 0x80008
    s_and_b32 s40, s40, 0xff
    s_cmp_eq_u32 s62, 7
    s_cselect_b32 s41, 220, s41
    s_add_u32 s40, s40, s63
    s_cmp_ge_u32 s40, s41
    s_cbranch_scc1 L_end
    s_mul_i32 s44, s40, 205
    s_lshr_b32 s44, s44, 11
    s_mul_i32 s41, s44, 10
    s_sub_u32 s41, s40, s41
    s_mov_b32 s40, s44
    s_mul_i32 s42, s40, 96
    s_add_u32 s43, s42, 95
    s_min_u32 s43, s43, 2047
    s_lshr_b32 s44, s42, 7
    s_lshr_b32 s45, s43, 7
    v_bfe_u32 v5, v2, 4, 1
    v_cmp_eq_u32 vcc, 0, v5
    v_mov_b32 v6, s45
    v_mov_b32 v7, s44
    v_cndmask_b32 v5, v6, v7, vcc
    v_and_b32 v6, 15, v2
    v_min_u32 v6, 13, v6
    v_lshl_add_u32 v5, v5, 4, v6
    v_lshlrev_b32 v5, 7, v5
    v_add_u32 v32, 0x142a000, v5
    s_lshr_b32 s44, s42, 8
    s_lshr_b32 s45, s43, 8
    v_cmp_eq_u32 vcc, 0, v4
    v_mov_b32 v6, s45
    v_mov_b32 v7, s44
    v_cndmask_b32 v5, v6, v7, vcc
    v_lshl_add_u32 v5, v5, 5, v3
    v_lshlrev_b32 v5, 7, v5
    v_add_u32 v33, 0x1432000, v5
    v_lshrrev_b32 v5, 3, v0
    v_add_u32 v5, s42, v5
    v_mul_u32_u24 v5, 1280, v5
    v_and_b32 v6, 7, v0
    v_lshl_add_u32 v5, v6, 4, v5
    s_lshl_b32 s46, s41, 7
    v_add_u32 v34, s46, v5
    v_add_u32 v35, 40960, v34
    v_add_u32 v36, 81920, v34
    v_lshlrev_b32 v8, 4, v2
    v_add_u32 v9, 151552, v8
    v_add_u32 v10, 303104, v8
    v_lshlrev_b32 v37, 3, v3
    v_lshl_add_u32 v37, v4, 9, v37
    v_add_u32 v38, 151552, v37
    v_add_u32 v39, 303104, v37
    s_mul_i32 s47, s40, 454656
    s_mul_i32 s48, s58, 27
    s_add_u32 s49, s48, 40
    s_lshl_b32 s49, s49, 10
    s_add_u32 s49, s49, s47
    s_mov_b32 s55, s48
    s_mov_b32 s54, s49
    s_mul_i32 s53, s40, 86
    s_lshr_b32 s53, s53, 8
    s_mul_i32 s53, s53, 3
    s_sub_u32 s53, s40, s53
    s_mul_i32 s53, s53, 3
    s_add_u32 s53, s53, s41
    s_mul_i32 s53, s53, 3
    s_sub_u32 s48, s53, 27
    s_cmp_ge_u32 s53, 27
    s_cselect_b32 s48, s48, s53
    s_lshl_b32 s53, s48, 10
    s_add_u32 s49, s49, s53
    v_lshrrev_b32 v5, 3, v2
    v_and_b32 v6, 7, v2
    v_bfe_u32 v7, v2, 4, 1
    v_lshlrev_b32 v7, 2, v7
    v_xor_b32 v6, v6, v7
    v_lshlrev_b32 v6, 4, v6
    v_add_u32 v6, s46, v6
    s_movk_i32 s51, 1280
    v_mad_u32_u24 v11, v5, s51, v6
    v_add_u32 v12, 9216, v11
    v_lshrrev_b32 v7, 2, v5
    v_mul_u32_u24 v7, 40, v7
    v_and_b32 v5, 3, v5
    v_add3_u32 v5, v5, v7, 16
    v_mad_u32_u24 v13, v5, s51, v6
    v_add_u32 v14, 24576, v13
    s_mul_i32 s52, s58, 24576
    v_bfe_u32 v5, v2, 2, 2
    v_lshl_add_u32 v6, v4, 2, v5
    v_lshlrev_b32 v6, 7, v6
    v_bfe_u32 v7, v2, 4, 1
    v_lshl_add_u32 v6, v7, 5, v6
    v_and_b32 v7, 3, v2
    v_lshl_add_u32 v6, v7, 3, v6
    v_add_u32 v6, s52, v6
    v_lshrrev_b32 v5, 1, v5
    v_lshl_add_u32 v15, v5, 6, v6
    v_xor_b32 v1, 64, v15
    s_setprio 0
    v_mov_b32 v5, 162304
    s_cmp_lg_u32 s58, 0
    s_cbranch_scc1 L_g_wh
    s_mov_b32 s71, 20000
L_p51:
    buffer_load_dword v6, v32, s[20:23], 0 offen sc1
    buffer_load_dword v7, v33, s[20:23], 0 offen sc1
    s_waitcnt vmcnt(0)
    v_cmp_ne_u32 vcc, s64, v6
    v_cmp_ne_u32 s[44:45], s64, v7
    s_nop 1
    s_or_b64 vcc, vcc, s[44:45]
    s_nop 1
    s_cbranch_vccz L_pd52
    s_sleep 8
    s_sub_u32 s71, s71, 1
    s_cmp_lg_u32 s71, 0
    s_cbranch_scc1 L_p51
L_pd52:
    s_mov_b32 s71, 80000
L_w53:
    ds_read_b32 v6, v5 offset:8
    s_waitcnt lgkmcnt(0)
    v_readfirstlane_b32 s70, v6
    s_cmp_ge_u32 s70, 4
    s_cbranch_scc1 L_wd54
    s_sleep 2
    s_sub_u32 s71, s71, 1
    s_cmp_lg_u32 s71, 0
    s_cbranch_scc1 L_w53
L_wd54:
    s_mov_b32 s71, 80000
L_w55:
    ds_read_b32 v6, v5 offset:0
    s_waitcnt lgkmcnt(0)
    v_readfirstlane_b32 s70, v6
    s_cmp_ge_u32 s70, 4096
    s_cbranch_scc1 L_wd56
    s_sleep 8
    s_sub_u32 s71, s71, 1
    s_cmp_lg_u32 s71, 0
    s_cbranch_scc1 L_w55
L_wd56:
    v_mov_b32 v6, 1
    ds_write_b32 v5, v6 offset:28
    s_branch L_g_gh
L_g_wh:
    s_mov_b32 s71, 80000
L_w57:
    ds_read_b32 v6, v5 offset:28
    s_waitcnt lgkmcnt(0)
    v_readfirstlane_b32 s70, v6
    s_cmp_ge_u32 s70, 1
    s_cbranch_scc1 L_wd58
    s_sleep 8
    s_sub_u32 s71, s71, 1
    s_cmp_lg_u32 s71, 0
    s_cbranch_scc1 L_w57
L_wd58:
L_g_gh:
    v_add_u32 v104, 19456, v11
    s_add_u32 m0, s52, 0
    s_add_u32 s50, s48, s55
    s_and_b32 s53, s50, 1
    s_lshl_b32 s50, s50, 1
    s_sub_u32 s50, s50, s53
    s_mul_i32 s50, s50, 10240
    buffer_load_dwordx4 v[40:43], v8, s[4:7], s49 offen sc1
    buffer_load_dwordx4 v[44:47], v9, s[4:7], s49 offen sc1
    buffer_load_dwordx4 v[48:51], v10, s[4:7], s49 offen sc1
    buffer_load_dwordx4 v11, s[28:31], s50 offen lds
    buffer_load_dwordx4 v104, s[28:31], s50 offen offset:1024 lds
    s_add_u32 s49, s49, 1024
    s_add_u32 s48, s48, 1
    s_cmp_eq_u32 s48, 27
    s_cselect_b32 s48, 0, s48
    s_cselect_b32 s49, s54, s49
    s_add_u32 m0, s52, 2048
    s_add_u32 s50, s48, s55
    s_and_b32 s53, s50, 1
    s_lshl_b32 s50, s50, 1
    s_sub_u32 s50, s50, s53
    s_mul_i32 s50, s50, 10240
    buffer_load_dwordx4 v[52:55], v8, s[4:7], s49 offen sc1
    buffer_load_dwordx4 v[56:59], v9, s[4:7], s49 offen sc1
    buffer_load_dwordx4 v[60:63], v10, s[4:7], s49 offen sc1
    buffer_load_dwordx4 v11, s[28:31], s50 offen lds
    buffer_load_dwordx4 v104, s[28:31], s50 offen offset:1024 lds
    s_add_u32 s49, s49, 1024
    s_add_u32 s48, s48, 1
    s_cmp_eq_u32 s48, 27
    s_cselect_b32 s48, 0, s48
    s_cselect_b32 s49, s54, s49
    s_add_u32 m0, s52, 4096
    s_add_u32 s50, s48, s55
    s_and_b32 s53, s50, 1
    s_lshl_b32 s50, s50, 1
    s_sub_u32 s50, s50, s53
    s_mul_i32 s50, s50, 10240
    buffer_load_dwordx4 v[80:83], v8, s[4:7], s49 offen sc1
    buffer_load_dwordx4 v[84:87], v9, s[4:7], s49 offen sc1
    buffer_load_dwordx4 v[88:91], v10, s[4:7], s49 offen sc1
    buffer_load_dwordx4 v11, s[28:31], s50 offen lds
    buffer_load_dwordx4 v104, s[28:31], s50 offen offset:1024 lds
    s_add_u32 s49, s49, 1024
    s_add_u32 s48, s48, 1
    s_cmp_eq_u32 s48, 27
    s_cselect_b32 s48, 0, s48
    s_cselect_b32 s49, s54, s49
    s_add_u32 m0, s52, 6144
    s_add_u32 s50, s48, s55
    s_and_b32 s53, s50, 1
    s_lshl_b32 s50, s50, 1
    s_sub_u32 s50, s50, s53
    s_mul_i32 s50, s50, 10240
    buffer_load_dwordx4 v[92:95], v8, s[4:7], s49 offen sc1
    buffer_load_dwordx4 v[96:99], v9, s[4:7], s49 offen sc1
    buffer_load_dwordx4 v[100:103], v10, s[4:7], s49 offen sc1
    buffer_load_dwordx4 v11, s[28:31], s50 offen lds
    buffer_load_dwordx4 v104, s[28:31], s50 offen offset:1024 lds
    s_add_u32 s49, s49, 1024
    s_add_u32 s48, s48, 1
    s_cmp_eq_u32 s48, 27
    s_cselect_b32 s48, 0, s48
    s_cselect_b32 s49, s54, s49
    s_waitcnt vmcnt(15)
    ds_read_b64_tr_b16 v[16:17], v15 offset:0
    ds_read_b64_tr_b16 v[18:19], v15 offset:1024
    ds_read_b64_tr_b16 v[20:21], v1 offset:0
    ds_read_b64_tr_b16 v[22:23], v1 offset:1024
    s_waitcnt vmcnt(10)
    ds_read_b64_tr_b16 v[24:25], v15 offset:2048
    ds_read_b64_tr_b16 v[26:27], v15 offset:3072
    ds_read_b64_tr_b16 v[28:29], v1 offset:2048
    ds_read_b64_tr_b16 v[30:31], v1 offset:3072
    s_waitcnt lgkmcnt(4)
    v_mfma_f32_32x32x16_bf16 v[160:175], v[16:19], v[40:43], 0
    v_mfma_f32_32x32x16_bf16 v[192:207], v[16:19], v[44:47], 0
    v_mfma_f32_32x32x16_bf16 v[224:239], v[16:19], v[48:51], 0
    v_mfma_f32_32x32x16_bf16 v[176:191], v[20:23], v[40:43], 0
    v_mfma_f32_32x32x16_bf16 v[208:223], v[20:23], v[44:47], 0
    v_mfma_f32_32x32x16_bf16 v[240:255], v[20:23], v[48:51], 0
    s_add_u32 m0, s52, 0
    s_add_u32 s50, s48, s55
    s_and_b32 s53, s50, 1
    s_lshl_b32 s50, s50, 1
    s_sub_u32 s50, s50, s53
    s_mul_i32 s50, s50, 10240
    buffer_load_dwordx4 v[40:43], v8, s[4:7], s49 offen sc1
    buffer_load_dwordx4 v[44:47], v9, s[4:7], s49 offen sc1
    buffer_load_dwordx4 v[48:51], v10, s[4:7], s49 offen sc1
    buffer_load_dwordx4 v11, s[28:31], s50 offen lds
    buffer_load_dwordx4 v104, s[28:31], s50 offen offset:1024 lds
    s_add_u32 s49, s49, 1024
    s_add_u32 s48, s48, 1
    s_cmp_eq_u32 s48, 27
    s_cselect_b32 s48, 0, s48
    s_cselect_b32 s49, s54, s49
    s_waitcnt vmcnt(10)
    ds_read_b64_tr_b16 v[16:17], v15 offset:4096
    ds_read_b64_tr_b16 v[18:19], v15 offset:5120
    ds_read_b64_tr_b16 v[20:21], v1 offset:4096
    ds_read_b64_tr_b16 v[22:23], v1 offset:5120
    s_waitcnt lgkmcnt(4)
    v_mfma_f32_32x32x16_bf16 v[160:175], v[24:27], v[52:55], v[160:175]
    v_mfma_f32_32x32x16_bf16 v[192:207], v[24:27], v[56:59], v[192:207]
    v_mfma_f32_32x32x16_bf16 v[224:239], v[24:27], v[60:63], v[224:239]
    v_mfma_f32_32x32x16_bf16 v[176:191], v[28:31], v[52:55], v[176:191]
    v_mfma_f32_32x32x16_bf16 v[208:223], v[28:31], v[56:59], v[208:223]
    v_mfma_f32_32x32x16_bf16 v[240:255], v[28:31], v[60:63], v[240:255]
    s_add_u32 m0, s52, 2048
    s_add_u32 s50, s48, s55
    s_and_b32 s53, s50, 1
    s_lshl_b32 s50, s50, 1
    s_sub_u32 s50, s50, s53
    s_mul_i32 s50, s50, 10240
    buffer_load_dwordx4 v[52:55], v8, s[4:7], s49 offen sc1
    buffer_load_dwordx4 v[56:59], v9, s[4:7], s49 offen sc1
    buffer_load_dwordx4 v[60:63], v10, s[4:7], s49 offen sc1
    buffer_load_dwordx4 v11, s[28:31], s50 offen lds
    buffer_load_dwordx4 v104, s[28:31], s50 offen offset:1024 lds
    s_add_u32 s49, s49, 1024
    s_add_u32 s48, s48, 1
    s_cmp_eq_u32 s48, 27
    s_cselect_b32 s48, 0, s48
    s_cselect_b32 s49, s54, s49
    s_waitcnt vmcnt(10)
    ds_read_b64_tr_b16 v[24:25], v15 offset:6144
    ds_read_b64_tr_b16 v[26:27], v15 offset:7168
    ds_read_b64_tr_b16 v[28:29], v1 offset:6144
    ds_read_b64_tr_b16 v[30:31], v1 offset:7168
    s_waitcnt lgkmcnt(4)
    v_mfma_f32_32x32x16_bf16 v[160:175], v[16:19], v[80:83], v[160:175]
    v_mfma_f32_32x32x16_bf16 v[192:207], v[16:19], v[84:87], v[192:207]
    v_mfma_f32_32x32x16_bf16 v[224:239], v[16:19], v[88:91], v[224:239]
    v_mfma_f32_32x32x16_bf16 v[176:191], v[20:23], v[80:83], v[176:191]
    v_mfma_f32_32x32x16_bf16 v[208:223], v[20:23], v[84:87], v[208:223]
    v_mfma_f32_32x32x16_bf16 v[240:255], v[20:23], v[88:91], v[240:255]
    s_add_u32 m0, s52, 4096
    s_add_u32 s50, s48, s55
    s_and_b32 s53, s50, 1
    s_lshl_b32 s50, s50, 1
    s_sub_u32 s50, s50, s53
    s_mul_i32 s50, s50, 10240
    buffer_load_dwordx4 v[80:83], v8, s[4:7], s49 offen sc1
    buffer_load_dwordx4 v[84:87], v9, s[4:7], s49 offen sc1
    buffer_load_dwordx4 v[88:91], v10, s[4:7], s49 offen sc1
    buffer_load_dwordx4 v11, s[28:31], s50 offen lds
    buffer_load_dwordx4 v104, s[28:31], s50 offen offset:1024 lds
    s_add_u32 s49, s49, 1024
    s_add_u32 s48, s48, 1
    s_cmp_eq_u32 s48, 27
    s_cselect_b32 s48, 0, s48
    s_cselect_b32 s49, s54, s49
    s_waitcnt vmcnt(10)
    ds_read_b64_tr_b16 v[16:17], v15 offset:0
    ds_read_b64_tr_b16 v[18:19], v15 offset:1024
    ds_read_b64_tr_b16 v[20:21], v1 offset:0
    ds_read_b64_tr_b16 v[22:23], v1 offset:1024
    s_waitcnt lgkmcnt(4)
    v_mfma_f32_32x32x16_bf16 v[160:175], v[24:27], v[92:95], v[160:175]
    v_mfma_f32_32x32x16_bf16 v[192:207], v[24:27], v[96:99], v[192:207]
    v_mfma_f32_32x32x16_bf16 v[224:239], v[24:27], v[100:103], v[224:239]
    v_mfma_f32_32x32x16_bf16 v[176:191], v[28:31], v[92:95], v[176:191]
    v_mfma_f32_32x32x16_bf16 v[208:223], v[28:31], v[96:99], v[208:223]
    v_mfma_f32_32x32x16_bf16 v[240:255], v[28:31], v[100:103], v[240:255]
    s_add_u32 m0, s52, 6144
    s_add_u32 s50, s48, s55
    s_and_b32 s53, s50, 1
    s_lshl_b32 s50, s50, 1
    s_sub_u32 s50, s50, s53
    s_mul_i32 s50, s50, 10240
    buffer_load_dwordx4 v[92:95], v8, s[4:7], s49 offen sc1
    buffer_load_dwordx4 v[96:99], v9, s[4:7], s49 offen sc1
    buffer_load_dwordx4 v[100:103], v10, s[4:7], s49 offen sc1
    buffer_load_dwordx4 v11, s[28:31], s50 offen lds
    buffer_load_dwordx4 v104, s[28:31], s50 offen offset:1024 lds
    s_add_u32 s49, s49, 1024
    s_add_u32 s48, s48, 1
    s_cmp_eq_u32 s48, 27
    s_cselect_b32 s48, 0, s48
    s_cselect_b32 s49, s54, s49
    s_waitcnt vmcnt(10)
    ds_read_b64_tr_b16 v[24:25], v15 offset:2048
    ds_read_b64_tr_b16 v[26:27], v15 offset:3072
    ds_read_b64_tr_b16 v[28:29], v1 offset:2048
    ds_read_b64_tr_b16 v[30:31], v1 offset:3072
    s_waitcnt lgkmcnt(4)
    v_mfma_f32_32x32x16_bf16 v[160:175], v[16:19], v[40:43], v[160:175]
    v_mfma_f32_32x32x16_bf16 v[192:207], v[16:19], v[44:47], v[192:207]
    v_mfma_f32_32x32x16_bf16 v[224:239], v[16:19], v[48:51], v[224:239]
    v_mfma_f32_32x32x16_bf16 v[176:191], v[20:23], v[40:43], v[176:191]
    v_mfma_f32_32x32x16_bf16 v[208:223], v[20:23], v[44:47], v[208:223]
    v_mfma_f32_32x32x16_bf16 v[240:255], v[20:23], v[48:51], v[240:255]
    s_add_u32 m0, s52, 0
    s_add_u32 s50, s48, s55
    s_and_b32 s53, s50, 1
    s_lshl_b32 s50, s50, 1
    s_sub_u32 s50, s50, s53
    s_mul_i32 s50, s50, 10240
    buffer_load_dwordx4 v[40:43], v8, s[4:7], s49 offen sc1
    buffer_load_dwordx4 v[44:47], v9, s[4:7], s49 offen sc1
    buffer_load_dwordx4 v[48:51], v10, s[4:7], s49 offen sc1
    buffer_load_dwordx4 v11, s[28:31], s50 offen lds
    buffer_load_dwordx4 v104, s[28:31], s50 offen offset:1024 lds
    s_add_u32 s49, s49, 1024
    s_add_u32 s48, s48, 1
    s_cmp_eq_u32 s48, 27
    s_cselect_b32 s48, 0, s48
    s_cselect_b32 s49, s54, s49
    s_waitcnt vmcnt(10)
    ds_read_b64_tr_b16 v[16:17], v15 offset:4096
    ds_read_b64_tr_b16 v[18:19], v15 offset:5120
    ds_read_b64_tr_b16 v[20:21], v1 offset:4096
    ds_read_b64_tr_b16 v[22:23], v1 offset:5120
    s_waitcnt lgkmcnt(4)
    v_mfma_f32_32x32x16_bf16 v[160:175], v[24:27], v[52:55], v[160:175]
    v_mfma_f32_32x32x16_bf16 v[192:207], v[24:27], v[56:59], v[192:207]
    v_mfma_f32_32x32x16_bf16 v[224:239], v[24:27], v[60:63], v[224:239]
    v_mfma_f32_32x32x16_bf16 v[176:191], v[28:31], v[52:55], v[176:191]
    v_mfma_f32_32x32x16_bf16 v[208:223], v[28:31], v[56:59], v[208:223]
    v_mfma_f32_32x32x16_bf16 v[240:255], v[28:31], v[60:63], v[240:255]
    s_add_u32 m0, s52, 2048
    s_add_u32 s50, s48, s55
    s_and_b32 s53, s50, 1
    s_lshl_b32 s50, s50, 1
    s_sub_u32 s50, s50, s53
    s_mul_i32 s50, s50, 10240
    buffer_load_dwordx4 v[52:55], v8, s[4:7], s49 offen sc1
    buffer_load_dwordx4 v[56:59], v9, s[4:7], s49 offen sc1
    buffer_load_dwordx4 v[60:63], v10, s[4:7], s49 offen sc1
    buffer_load_dwordx4 v11, s[28:31], s50 offen lds
    buffer_load_dwordx4 v104, s[28:31], s50 offen offset:1024 lds
    s_add_u32 s49, s49, 1024
    s_add_u32 s48, s48, 1
    s_cmp_eq_u32 s48, 27
    s_cselect_b32 s48, 0, s48
    s_cselect_b32 s49, s54, s49
    s_waitcnt vmcnt(10)
    ds_read_b64_tr_b16 v[24:25], v15 offset:6144
    ds_read_b64_tr_b16 v[26:27], v15 offset:7168
    ds_read_b64_tr_b16 v[28:29], v1 offset:6144
    ds_read_b64_tr_b16 v[30:31], v1 offset:7168
    s_waitcnt lgkmcnt(4)
    v_mfma_f32_32x32x16_bf16 v[160:175], v[16:19], v[80:83], v[160:175]
    v_mfma_f32_32x32x16_bf16 v[192:207], v[16:19], v[84:87], v[192:207]
    v_mfma_f32_32x32x16_bf16 v[224:239], v[16:19], v[88:91], v[224:239]
    v_mfma_f32_32x32x16_bf16 v[176:191], v[20:23], v[80:83], v[176:191]
    v_mfma_f32_32x32x16_bf16 v[208:223], v[20:23], v[84:87], v[208:223]
    v_mfma_f32_32x32x16_bf16 v[240:255], v[20:23], v[88:91], v[240:255]
    s_add_u32 m0, s52, 4096
    s_add_u32 s50, s48, s55
    s_and_b32 s53, s50, 1
    s_lshl_b32 s50, s50, 1
    s_sub_u32 s50, s50, s53
    s_mul_i32 s50, s50, 10240
    buffer_load_dwordx4 v[80:83], v8, s[4:7], s49 offen sc1
    buffer_load_dwordx4 v[84:87], v9, s[4:7], s49 offen sc1
    buffer_load_dwordx4 v[88:91], v10, s[4:7], s49 offen sc1
    buffer_load_dwordx4 v11, s[28:31], s50 offen lds
    buffer_load_dwordx4 v104, s[28:31], s50 offen offset:1024 lds
    s_add_u32 s49, s49, 1024
    s_add_u32 s48, s48, 1
    s_cmp_eq_u32 s48, 27
    s_cselect_b32 s48, 0, s48
    s_cselect_b32 s49, s54, s49
    s_waitcnt vmcnt(10)
    ds_read_b64_tr_b16 v[16:17], v15 offset:0
    ds_read_b64_tr_b16 v[18:19], v15 offset:1024
    ds_read_b64_tr_b16 v[20:21], v1 offset:0
    ds_read_b64_tr_b16 v[22:23], v1 offset:1024
    s_waitcnt lgkmcnt(4)
    v_mfma_f32_32x32x16_bf16 v[160:175], v[24:27], v[92:95], v[160:175]
    v_mfma_f32_32x32x16_bf16 v[192:207], v[24:27], v[96:99], v[192:207]
    v_mfma_f32_32x32x16_bf16 v[224:239], v[24:27], v[100:103], v[224:239]
    v_mfma_f32_32x32x16_bf16 v[176:191], v[28:31], v[92:95], v[176:191]
    v_mfma_f32_32x32x16_bf16 v[208:223], v[28:31], v[96:99], v[208:223]
    v_mfma_f32_32x32x16_bf16 v[240:255], v[28:31], v[100:103], v[240:255]
    s_add_u32 m0, s52, 6144
    s_add_u32 s50, s48, s55
    s_and_b32 s53, s50, 1
    s_lshl_b32 s50, s50, 1
    s_sub_u32 s50, s50, s53
    s_mul_i32 s50, s50, 10240
    buffer_load_dwordx4 v[92:95], v8, s[4:7], s49 offen sc1
    buffer_load_dwordx4 v[96:99], v9, s[4:7], s49 offen sc1
    buffer_load_dwordx4 v[100:103], v10, s[4:7], s49 offen sc1
    buffer_load_dwordx4 v11, s[28:31], s50 offen lds
    buffer_load_dwordx4 v104, s[28:31], s50 offen offset:1024 lds
    s_add_u32 s49, s49, 1024
    s_add_u32 s48, s48, 1
    s_cmp_eq_u32 s48, 27
    s_cselect_b32 s48, 0, s48
    s_cselect_b32 s49, s54, s49
    s_waitcnt vmcnt(10)
    ds_read_b64_tr_b16 v[24:25], v15 offset:2048
    ds_read_b64_tr_b16 v[26:27], v15 offset:3072
    ds_read_b64_tr_b16 v[28:29], v1 offset:2048
    ds_read_b64_tr_b16 v[30:31], v1 offset:3072
    s_waitcnt lgkmcnt(4)
    v_mfma_f32_32x32x16_bf16 v[160:175], v[16:19], v[40:43], v[160:175]
    v_mfma_f32_32x32x16_bf16 v[192:207], v[16:19], v[44:47], v[192:207]
    v_mfma_f32_32x32x16_bf16 v[224:239], v[16:19], v[48:51], v[224:239]
    v_mfma_f32_32x32x16_bf16 v[176:191], v[20:23], v[40:43], v[176:191]
    v_mfma_f32_32x32x16_bf16 v[208:223], v[20:23], v[44:47], v[208:223]
    v_mfma_f32_32x32x16_bf16 v[240:255], v[20:23], v[48:51], v[240:255]
    s_add_u32 m0, s52, 0
    s_add_u32 s50, s48, s55
    s_and_b32 s53, s50, 1
    s_lshl_b32 s50, s50, 1
    s_sub_u32 s50, s50, s53
    s_mul_i32 s50, s50, 10240
    buffer_load_dwordx4 v[40:43], v8, s[4:7], s49 offen sc1
    buffer_load_dwordx4 v[44:47], v9, s[4:7], s49 offen sc1
    buffer_load_dwordx4 v[48:51], v10, s[4:7], s49 offen sc1
    buffer_load_dwordx4 v11, s[28:31], s50 offen lds
    buffer_load_dwordx4 v104, s[28:31], s50 offen offset:1024 lds
    s_add_u32 s49, s49, 1024
    s_add_u32 s48, s48, 1
    s_cmp_eq_u32 s48, 27
    s_cselect_b32 s48, 0, s48
    s_cselect_b32 s49, s54, s49
    s_waitcnt vmcnt(10)
    ds_read_b64_tr_b16 v[16:17], v15 offset:4096
    ds_read_b64_tr_b16 v[18:19], v15 offset:5120
    ds_read_b64_tr_b16 v[20:21], v1 offset:4096
    ds_read_b64_tr_b16 v[22:23], v1 offset:5120
    s_waitcnt lgkmcnt(4)
    v_mfma_f32_32x32x16_bf16 v[160:175], v[24:27], v[52:55], v[160:175]
    v_mfma_f32_32x32x16_bf16 v[192:207], v[24:27], v[56:59], v[192:207]
    v_mfma_f32_32x32x16_bf16 v[224:239], v[24:27], v[60:63], v[224:239]
    v_mfma_f32_32x32x16_bf16 v[176:191], v[28:31], v[52:55], v[176:191]
    v_mfma_f32_32x32x16_bf16 v[208:223], v[28:31], v[56:59], v[208:223]
    v_mfma_f32_32x32x16_bf16 v[240:255], v[28:31], v[60:63], v[240:255]
    s_add_u32 m0, s52, 2048
    s_add_u32 s50, s48, s55
    s_and_b32 s53, s50, 1
    s_lshl_b32 s50, s50, 1
    s_sub_u32 s50, s50, s53
    s_mul_i32 s50, s50, 10240
    buffer_load_dwordx4 v[52:55], v8, s[4:7], s49 offen sc1
    buffer_load_dwordx4 v[56:59], v9, s[4:7], s49 offen sc1
    buffer_load_dwordx4 v[60:63], v10, s[4:7], s49 offen sc1
    buffer_load_dwordx4 v11, s[28:31], s50 offen lds
    buffer_load_dwordx4 v104, s[28:31], s50 offen offset:1024 lds
    s_add_u32 s49, s49, 1024
    s_add_u32 s48, s48, 1
    s_cmp_eq_u32 s48, 27
    s_cselect_b32 s48, 0, s48
    s_cselect_b32 s49, s54, s49
    s_waitcnt vmcnt(10)
    ds_read_b64_tr_b16 v[24:25], v15 offset:6144
    ds_read_b64_tr_b16 v[26:27], v15 offset:7168
    ds_read_b64_tr_b16 v[28:29], v1 offset:6144
    ds_read_b64_tr_b16 v[30:31], v1 offset:7168
    s_waitcnt lgkmcnt(4)
    v_mfma_f32_32x32x16_bf16 v[160:175], v[16:19], v[80:83], v[160:175]
    v_mfma_f32_32x32x16_bf16 v[192:207], v[16:19], v[84:87], v[192:207]
    v_mfma_f32_32x32x16_bf16 v[224:239], v[16:19], v[88:91], v[224:239]
    v_mfma_f32_32x32x16_bf16 v[176:191], v[20:23], v[80:83], v[176:191]
    v_mfma_f32_32x32x16_bf16 v[208:223], v[20:23], v[84:87], v[208:223]
    v_mfma_f32_32x32x16_bf16 v[240:255], v[20:23], v[88:91], v[240:255]
    s_add_u32 m0, s52, 4096
    s_add_u32 s50, s48, s55
    s_and_b32 s53, s50, 1
    s_lshl_b32 s50, s50, 1
    s_sub_u32 s50, s50, s53
    s_mul_i32 s50, s50, 10240
    buffer_load_dwordx4 v[80:83], v8, s[4:7], s49 offen sc1
    buffer_load_dwordx4 v[84:87], v9, s[4:7], s49 offen sc1
    buffer_load_dwordx4 v[88:91], v10, s[4:7], s49 offen sc1
    buffer_load_dwordx4 v11, s[28:31], s50 offen lds
    buffer_load_dwordx4 v104, s[28:31], s50 offen offset:1024 lds
    s_add_u32 s49, s49, 1024
    s_add_u32 s48, s48, 1
    s_cmp_eq_u32 s48, 27
    s_cselect_b32 s48, 0, s48
    s_cselect_b32 s49, s54, s49
    s_waitcnt vmcnt(10)
    ds_read_b64_tr_b16 v[16:17], v15 offset:0
    ds_read_b64_tr_b16 v[18:19], v15 offset:1024
    ds_read_b64_tr_b16 v[20:21], v1 offset:0
    ds_read_b64_tr_b16 v[22:23], v1 offset:1024
    s_waitcnt lgkmcnt(4)
    v_mfma_f32_32x32x16_bf16 v[160:175], v[24:27], v[92:95], v[160:175]
    v_mfma_f32_32x32x16_bf16 v[192:207], v[24:27], v[96:99], v[192:207]
    v_mfma_f32_32x32x16_bf16 v[224:239], v[24:27], v[100:103], v[224:239]
    v_mfma_f32_32x32x16_bf16 v[176:191], v[28:31], v[92:95], v[176:191]
    v_mfma_f32_32x32x16_bf16 v[208:223], v[28:31], v[96:99], v[208:223]
    v_mfma_f32_32x32x16_bf16 v[240:255], v[28:31], v[100:103], v[240:255]
    s_add_u32 m0, s52, 6144
    s_add_u32 s50, s48, s55
    s_and_b32 s53, s50, 1
    s_lshl_b32 s50, s50, 1
    s_sub_u32 s50, s50, s53
    s_mul_i32 s50, s50, 10240
    buffer_load_dwordx4 v[92:95], v8, s[4:7], s49 offen sc1
    buffer_load_dwordx4 v[96:99], v9, s[4:7], s49 offen sc1
    buffer_load_dwordx4 v[100:103], v10, s[4:7], s49 offen sc1
    buffer_load_dwordx4 v11, s[28:31], s50 offen lds
    buffer_load_dwordx4 v104, s[28:31], s50 offen offset:1024 lds
    s_add_u32 s49, s49, 1024
    s_add_u32 s48, s48, 1
    s_cmp_eq_u32 s48, 27
    s_cselect_b32 s48, 0, s48
    s_cselect_b32 s49, s54, s49
    s_waitcnt vmcnt(10)
    ds_read_b64_tr_b16 v[24:25], v15 offset:2048
    ds_read_b64_tr_b16 v[26:27], v15 offset:3072
    ds_read_b64_tr_b16 v[28:29], v1 offset:2048
    ds_read_b64_tr_b16 v[30:31], v1 offset:3072
    s_waitcnt lgkmcnt(4)
    v_mfma_f32_32x32x16_bf16 v[160:175], v[16:19], v[40:43], v[160:175]
    v_mfma_f32_32x32x16_bf16 v[192:207], v[16:19], v[44:47], v[192:207]
    v_mfma_f32_32x32x16_bf16 v[224:239], v[16:19], v[48:51], v[224:239]
    v_mfma_f32_32x32x16_bf16 v[176:191], v[20:23], v[40:43], v[176:191]
    v_mfma_f32_32x32x16_bf16 v[208:223], v[20:23], v[44:47], v[208:223]
    v_mfma_f32_32x32x16_bf16 v[240:255], v[20:23], v[48:51], v[240:255]
    s_add_u32 m0, s52, 0
    s_add_u32 s50, s48, s55
    s_and_b32 s53, s50, 1
    s_lshl_b32 s50, s50, 1
    s_sub_u32 s50, s50, s53
    s_mul_i32 s50, s50, 10240
    buffer_load_dwordx4 v[40:43], v8, s[4:7], s49 offen sc1
    buffer_load_dwordx4 v[44:47], v9, s[4:7], s49 offen sc1
    buffer_load_dwordx4 v[48:51], v10, s[4:7], s49 offen sc1
    buffer_load_dwordx4 v11, s[28:31], s50 offen lds
    buffer_load_dwordx4 v104, s[28:31], s50 offen offset:1024 lds
    s_add_u32 s49, s49, 1024
    s_add_u32 s48, s48, 1
    s_cmp_eq_u32 s48, 27
    s_cselect_b32 s48, 0, s48
    s_cselect_b32 s49, s54, s49
    s_waitcnt vmcnt(10)
    ds_read_b64_tr_b16 v[16:17], v15 offset:4096
    ds_read_b64_tr_b16 v[18:19], v15 offset:5120
    ds_read_b64_tr_b16 v[20:21], v1 offset:4096
    ds_read_b64_tr_b16 v[22:23], v1 offset:5120
    s_waitcnt lgkmcnt(4)
    v_mfma_f32_32x32x16_bf16 v[160:175], v[24:27], v[52:55], v[160:175]
    v_mfma_f32_32x32x16_bf16 v[192:207], v[24:27], v[56:59], v[192:207]
    v_mfma_f32_32x32x16_bf16 v[224:239], v[24:27], v[60:63], v[224:239]
    v_mfma_f32_32x32x16_bf16 v[176:191], v[28:31], v[52:55], v[176:191]
    v_mfma_f32_32x32x16_bf16 v[208:223], v[28:31], v[56:59], v[208:223]
    v_mfma_f32_32x32x16_bf16 v[240:255], v[28:31], v[60:63], v[240:255]
    s_add_u32 m0, s52, 2048
    s_add_u32 s50, s48, s55
    s_and_b32 s53, s50, 1
    s_lshl_b32 s50, s50, 1
    s_sub_u32 s50, s50, s53
    s_mul_i32 s50, s50, 10240
    buffer_load_dwordx4 v[52:55], v8, s[4:7], s49 offen sc1
    buffer_load_dwordx4 v[56:59], v9, s[4:7], s49 offen sc1
    buffer_load_dwordx4 v[60:63], v10, s[4:7], s49 offen sc1
    buffer_load_dwordx4 v11, s[28:31], s50 offen lds
    buffer_load_dwordx4 v104, s[28:31], s50 offen offset:1024 lds
    s_add_u32 s49, s49, 1024
    s_add_u32 s48, s48, 1
    s_cmp_eq_u32 s48, 27
    s_cselect_b32 s48, 0, s48
    s_cselect_b32 s49, s54, s49
    s_waitcnt vmcnt(10)
    ds_read_b64_tr_b16 v[24:25], v15 offset:6144
    ds_read_b64_tr_b16 v[26:27], v15 offset:7168
    ds_read_b64_tr_b16 v[28:29], v1 offset:6144
    ds_read_b64_tr_b16 v[30:31], v1 offset:7168
    s_waitcnt lgkmcnt(4)
    v_mfma_f32_32x32x16_bf16 v[160:175], v[16:19], v[80:83], v[160:175]
    v_mfma_f32_32x32x16_bf16 v[192:207], v[16:19], v[84:87], v[192:207]
    v_mfma_f32_32x32x16_bf16 v[224:239], v[16:19], v[88:91], v[224:239]
    v_mfma_f32_32x32x16_bf16 v[176:191], v[20:23], v[80:83], v[176:191]
    v_mfma_f32_32x32x16_bf16 v[208:223], v[20:23], v[84:87], v[208:223]
    v_mfma_f32_32x32x16_bf16 v[240:255], v[20:23], v[88:91], v[240:255]
    s_add_u32 m0, s52, 4096
    s_add_u32 s50, s48, s55
    s_and_b32 s53, s50, 1
    s_lshl_b32 s50, s50, 1
    s_sub_u32 s50, s50, s53
    s_mul_i32 s50, s50, 10240
    buffer_load_dwordx4 v[80:83], v8, s[4:7], s49 offen sc1
    buffer_load_dwordx4 v[84:87], v9, s[4:7], s49 offen sc1
    buffer_load_dwordx4 v[88:91], v10, s[4:7], s49 offen sc1
    buffer_load_dwordx4 v11, s[28:31], s50 offen lds
    buffer_load_dwordx4 v104, s[28:31], s50 offen offset:1024 lds
    s_add_u32 s49, s49, 1024
    s_add_u32 s48, s48, 1
    s_cmp_eq_u32 s48, 27
    s_cselect_b32 s48, 0, s48
    s_cselect_b32 s49, s54, s49
    s_waitcnt vmcnt(10)
    ds_read_b64_tr_b16 v[16:17], v15 offset:0
    ds_read_b64_tr_b16 v[18:19], v15 offset:1024
    ds_read_b64_tr_b16 v[20:21], v1 offset:0
    ds_read_b64_tr_b16 v[22:23], v1 offset:1024
    s_waitcnt lgkmcnt(4)
    v_mfma_f32_32x32x16_bf16 v[160:175], v[24:27], v[92:95], v[160:175]
    v_mfma_f32_32x32x16_bf16 v[192:207], v[24:27], v[96:99], v[192:207]
    v_mfma_f32_32x32x16_bf16 v[224:239], v[24:27], v[100:103], v[224:239]
    v_mfma_f32_32x32x16_bf16 v[176:191], v[28:31], v[92:95], v[176:191]
    v_mfma_f32_32x32x16_bf16 v[208:223], v[28:31], v[96:99], v[208:223]
    v_mfma_f32_32x32x16_bf16 v[240:255], v[28:31], v[100:103], v[240:255]
    s_add_u32 m0, s52, 6144
    s_add_u32 s50, s48, s55
    s_and_b32 s53, s50, 1
    s_lshl_b32 s50, s50, 1
    s_sub_u32 s50, s50, s53
    s_mul_i32 s50, s50, 10240
    buffer_load_dwordx4 v[92:95], v8, s[4:7], s49 offen sc1
    buffer_load_dwordx4 v[96:99], v9, s[4:7], s49 offen sc1
    buffer_load_dwordx4 v[100:103], v10, s[4:7], s49 offen sc1
    buffer_load_dwordx4 v11, s[28:31], s50 offen lds
    buffer_load_dwordx4 v104, s[28:31], s50 offen offset:1024 lds
    s_add_u32 s49, s49, 1024
    s_add_u32 s48, s48, 1
    s_cmp_eq_u32 s48, 27
    s_cselect_b32 s48, 0, s48
    s_cselect_b32 s49, s54, s49
    s_waitcnt vmcnt(10)
    ds_read_b64_tr_b16 v[24:25], v15 offset:2048
    ds_read_b64_tr_b16 v[26:27], v15 offset:3072
    ds_read_b64_tr_b16 v[28:29], v1 offset:2048
    ds_read_b64_tr_b16 v[30:31], v1 offset:3072
    s_waitcnt lgkmcnt(4)
    v_mfma_f32_32x32x16_bf16 v[160:175], v[16:19], v[40:43], v[160:175]
    v_mfma_f32_32x32x16_bf16 v[192:207], v[16:19], v[44:47], v[192:207]
    v_mfma_f32_32x32x16_bf16 v[224:239], v[16:19], v[48:51], v[224:239]
    v_mfma_f32_32x32x16_bf16 v[176:191], v[20:23], v[40:43], v[176:191]
    v_mfma_f32_32x32x16_bf16 v[208:223], v[20:23], v[44:47], v[208:223]
    v_mfma_f32_32x32x16_bf16 v[240:255], v[20:23], v[48:51], v[240:255]
    s_add_u32 m0, s52, 0
    s_add_u32 s50, s48, s55
    s_and_b32 s53, s50, 1
    s_lshl_b32 s50, s50, 1
    s_sub_u32 s50, s50, s53
    s_mul_i32 s50, s50, 10240
    buffer_load_dwordx4 v[40:43], v8, s[4:7], s49 offen sc1
    buffer_load_dwordx4 v[44:47], v9, s[4:7], s49 offen sc1
    buffer_load_dwordx4 v[48:51], v10, s[4:7], s49 offen sc1
    buffer_load_dwordx4 v11, s[28:31], s50 offen lds
    buffer_load_dwordx4 v104, s[28:31], s50 offen offset:1024 lds
    s_add_u32 s49, s49, 1024
    s_add_u32 s48, s48, 1
    s_cmp_eq_u32 s48, 27
    s_cselect_b32 s48, 0, s48
    s_cselect_b32 s49, s54, s49
    s_waitcnt vmcnt(10)
    ds_read_b64_tr_b16 v[16:17], v15 offset:4096
    ds_read_b64_tr_b16 v[18:19], v15 offset:5120
    ds_read_b64_tr_b16 v[20:21], v1 offset:4096
    ds_read_b64_tr_b16 v[22:23], v1 offset:5120
    s_waitcnt lgkmcnt(4)
    v_mfma_f32_32x32x16_bf16 v[160:175], v[24:27], v[52:55], v[160:175]
    v_mfma_f32_32x32x16_bf16 v[192:207], v[24:27], v[56:59], v[192:207]
    v_mfma_f32_32x32x16_bf16 v[224:239], v[24:27], v[60:63], v[224:239]
    v_mfma_f32_32x32x16_bf16 v[176:191], v[28:31], v[52:55], v[176:191]
    v_mfma_f32_32x32x16_bf16 v[208:223], v[28:31], v[56:59], v[208:223]
    v_mfma_f32_32x32x16_bf16 v[240:255], v[28:31], v[60:63], v[240:255]
    s_add_u32 m0, s52, 2048
    s_add_u32 s50, s48, s55
    s_and_b32 s53, s50, 1
    s_lshl_b32 s50, s50, 1
    s_sub_u32 s50, s50, s53
    s_mul_i32 s50, s50, 10240
    buffer_load_dwordx4 v[52:55], v8, s[4:7], s49 offen sc1
    buffer_load_dwordx4 v[56:59], v9, s[4:7], s49 offen sc1
    buffer_load_dwordx4 v[60:63], v10, s[4:7], s49 offen sc1
    buffer_load_dwordx4 v11, s[28:31], s50 offen lds
    buffer_load_dwordx4 v104, s[28:31], s50 offen offset:1024 lds
    s_add_u32 s49, s49, 1024
    s_add_u32 s48, s48, 1
    s_cmp_eq_u32 s48, 27
    s_cselect_b32 s48, 0, s48
    s_cselect_b32 s49, s54, s49
    s_waitcnt vmcnt(10)
    ds_read_b64_tr_b16 v[24:25], v15 offset:6144
    ds_read_b64_tr_b16 v[26:27], v15 offset:7168
    ds_read_b64_tr_b16 v[28:29], v1 offset:6144
    ds_read_b64_tr_b16 v[30:31], v1 offset:7168
    s_waitcnt lgkmcnt(4)
    v_mfma_f32_32x32x16_bf16 v[160:175], v[16:19], v[80:83], v[160:175]
    v_mfma_f32_32x32x16_bf16 v[192:207], v[16:19], v[84:87], v[192:207]
    v_mfma_f32_32x32x16_bf16 v[224:239], v[16:19], v[88:91], v[224:239]
    v_mfma_f32_32x32x16_bf16 v[176:191], v[20:23], v[80:83], v[176:191]
    v_mfma_f32_32x32x16_bf16 v[208:223], v[20:23], v[84:87], v[208:223]
    v_mfma_f32_32x32x16_bf16 v[240:255], v[20:23], v[88:91], v[240:255]
    s_add_u32 m0, s52, 4096
    s_add_u32 s50, s48, s55
    s_and_b32 s53, s50, 1
    s_lshl_b32 s50, s50, 1
    s_sub_u32 s50, s50, s53
    s_mul_i32 s50, s50, 10240
    buffer_load_dwordx4 v[80:83], v8, s[4:7], s49 offen sc1
    buffer_load_dwordx4 v[84:87], v9, s[4:7], s49 offen sc1
    buffer_load_dwordx4 v[88:91], v10, s[4:7], s49 offen sc1
    buffer_load_dwordx4 v11, s[28:31], s50 offen lds
    buffer_load_dwordx4 v104, s[28:31], s50 offen offset:1024 lds
    s_add_u32 s49, s49, 1024
    s_add_u32 s48, s48, 1
    s_cmp_eq_u32 s48, 27
    s_cselect_b32 s48, 0, s48
    s_cselect_b32 s49, s54, s49
    s_waitcnt vmcnt(10)
    ds_read_b64_tr_b16 v[16:17], v15 offset:0
    ds_read_b64_tr_b16 v[18:19], v15 offset:1024
    ds_read_b64_tr_b16 v[20:21], v1 offset:0
    ds_read_b64_tr_b16 v[22:23], v1 offset:1024
    s_waitcnt lgkmcnt(4)
    v_mfma_f32_32x32x16_bf16 v[160:175], v[24:27], v[92:95], v[160:175]
    v_mfma_f32_32x32x16_bf16 v[192:207], v[24:27], v[96:99], v[192:207]
    v_mfma_f32_32x32x16_bf16 v[224:239], v[24:27], v[100:103], v[224:239]
    v_mfma_f32_32x32x16_bf16 v[176:191], v[28:31], v[92:95], v[176:191]
    v_mfma_f32_32x32x16_bf16 v[208:223], v[28:31], v[96:99], v[208:223]
    v_mfma_f32_32x32x16_bf16 v[240:255], v[28:31], v[100:103], v[240:255]
    s_add_u32 m0, s52, 6144
    s_add_u32 s50, s48, s55
    s_and_b32 s53, s50, 1
    s_lshl_b32 s50, s50, 1
    s_sub_u32 s50, s50, s53
    s_mul_i32 s50, s50, 10240
    buffer_load_dwordx4 v[92:95], v8, s[4:7], s49 offen sc1
    buffer_load_dwordx4 v[96:99], v9, s[4:7], s49 offen sc1
    buffer_load_dwordx4 v[100:103], v10, s[4:7], s49 offen sc1
    buffer_load_dwordx4 v11, s[28:31], s50 offen lds
    buffer_load_dwordx4 v104, s[28:31], s50 offen offset:1024 lds
    s_add_u32 s49, s49, 1024
    s_add_u32 s48, s48, 1
    s_cmp_eq_u32 s48, 27
    s_cselect_b32 s48, 0, s48
    s_cselect_b32 s49, s54, s49
    s_waitcnt vmcnt(10)
    ds_read_b64_tr_b16 v[24:25], v15 offset:2048
    ds_read_b64_tr_b16 v[26:27], v15 offset:3072
    ds_read_b64_tr_b16 v[28:29], v1 offset:2048
    ds_read_b64_tr_b16 v[30:31], v1 offset:3072
    s_waitcnt lgkmcnt(4)
    v_mfma_f32_32x32x16_bf16 v[160:175], v[16:19], v[40:43], v[160:175]
    v_mfma_f32_32x32x16_bf16 v[192:207], v[16:19], v[44:47], v[192:207]
    v_mfma_f32_32x32x16_bf16 v[224:239], v[16:19], v[48:51], v[224:239]
    v_mfma_f32_32x32x16_bf16 v[176:191], v[20:23], v[40:43], v[176:191]
    v_mfma_f32_32x32x16_bf16 v[208:223], v[20:23], v[44:47], v[208:223]
    v_mfma_f32_32x32x16_bf16 v[240:255], v[20:23], v[48:51], v[240:255]
    s_add_u32 m0, s52, 0
    s_add_u32 s50, s48, s55
    s_and_b32 s53, s50, 1
    s_lshl_b32 s50, s50, 1
    s_sub_u32 s50, s50, s53
    s_mul_i32 s50, s50, 10240
    buffer_load_dwordx4 v[40:43], v8, s[4:7], s49 offen sc1
    buffer_load_dwordx4 v[44:47], v9, s[4:7], s49 offen sc1
    buffer_load_dwordx4 v[48:51], v10, s[4:7], s49 offen sc1
    buffer_load_dwordx4 v11, s[28:31], s50 offen lds
    buffer_load_dwordx4 v104, s[28:31], s50 offen offset:1024 lds
    s_add_u32 s49, s49, 1024
    s_add_u32 s48, s48, 1
    s_cmp_eq_u32 s48, 27
    s_cselect_b32 s48, 0, s48
    s_cselect_b32 s49, s54, s49
    s_waitcnt vmcnt(10)
    ds_read_b64_tr_b16 v[16:17], v15 offset:4096
    ds_read_b64_tr_b16 v[18:19], v15 offset:5120
    ds_read_b64_tr_b16 v[20:21], v1 offset:4096
    ds_read_b64_tr_b16 v[22:23], v1 offset:5120
    s_waitcnt lgkmcnt(4)
    v_mfma_f32_32x32x16_bf16 v[160:175], v[24:27], v[52:55], v[160:175]
    v_mfma_f32_32x32x16_bf16 v[192:207], v[24:27], v[56:59], v[192:207]
    v_mfma_f32_32x32x16_bf16 v[224:239], v[24:27], v[60:63], v[224:239]
    v_mfma_f32_32x32x16_bf16 v[176:191], v[28:31], v[52:55], v[176:191]
    v_mfma_f32_32x32x16_bf16 v[208:223], v[28:31], v[56:59], v[208:223]
    v_mfma_f32_32x32x16_bf16 v[240:255], v[28:31], v[60:63], v[240:255]
    s_add_u32 m0, s52, 2048
    s_add_u32 s50, s48, s55
    s_and_b32 s53, s50, 1
    s_lshl_b32 s50, s50, 1
    s_sub_u32 s50, s50, s53
    s_mul_i32 s50, s50, 10240
    buffer_load_dwordx4 v[52:55], v8, s[4:7], s49 offen sc1
    buffer_load_dwordx4 v[56:59], v9, s[4:7], s49 offen sc1
    buffer_load_dwordx4 v[60:63], v10, s[4:7], s49 offen sc1
    buffer_load_dwordx4 v11, s[28:31], s50 offen lds
    buffer_load_dwordx4 v104, s[28:31], s50 offen offset:1024 lds
    s_add_u32 s49, s49, 1024
    s_add_u32 s48, s48, 1
    s_cmp_eq_u32 s48, 27
    s_cselect_b32 s48, 0, s48
    s_cselect_b32 s49, s54, s49
    s_waitcnt lgkmcnt(0)
    v_mfma_f32_32x32x16_bf16 v[160:175], v[16:19], v[80:83], v[160:175]
    v_mfma_f32_32x32x16_bf16 v[192:207], v[16:19], v[84:87], v[192:207]
    v_mfma_f32_32x32x16_bf16 v[224:239], v[16:19], v[88:91], v[224:239]
    v_mfma_f32_32x32x16_bf16 v[176:191], v[20:23], v[80:83], v[176:191]
    v_mfma_f32_32x32x16_bf16 v[208:223], v[20:23], v[84:87], v[208:223]
    v_mfma_f32_32x32x16_bf16 v[240:255], v[20:23], v[88:91], v[240:255]
    s_add_u32 m0, s52, 4096
    s_add_u32 s50, s48, s55
    s_and_b32 s53, s50, 1
    s_lshl_b32 s50, s50, 1
    s_sub_u32 s50, s50, s53
    s_mul_i32 s50, s50, 10240
    buffer_load_dwordx4 v[80:83], v8, s[4:7], s49 offen sc1
    buffer_load_dwordx4 v[84:87], v9, s[4:7], s49 offen sc1
    buffer_load_dwordx4 v[88:91], v10, s[4:7], s49 offen sc1
    buffer_load_dwordx4 v11, s[28:31], s50 offen lds
    buffer_load_dwordx4 v104, s[28:31], s50 offen offset:1024 lds
    s_add_u32 s49, s49, 1024
    s_add_u32 s48, s48, 1
    s_cmp_eq_u32 s48, 27
    s_cselect_b32 s48, 0, s48
    s_cselect_b32 s49, s54, s49
    s_waitcnt vmcnt(0)
    ds_read_b64_tr_b16 v[120:121], v15 offset:6144
    ds_read_b64_tr_b16 v[122:123], v15 offset:7168
    ds_read_b64_tr_b16 v[124:125], v1 offset:6144
    ds_read_b64_tr_b16 v[126:127], v1 offset:7168
    ds_read_b64_tr_b16 v[128:129], v15 offset:0
    ds_read_b64_tr_b16 v[130:131], v15 offset:1024
    ds_read_b64_tr_b16 v[132:133], v1 offset:0
    ds_read_b64_tr_b16 v[134:135], v1 offset:1024
    ds_read_b64_tr_b16 v[136:137], v15 offset:2048
    ds_read_b64_tr_b16 v[138:139], v15 offset:3072
    ds_read_b64_tr_b16 v[140:141], v1 offset:2048
    ds_read_b64_tr_b16 v[142:143], v1 offset:3072
    ds_read_b64_tr_b16 v[144:145], v15 offset:4096
    ds_read_b64_tr_b16 v[146:147], v15 offset:5120
    ds_read_b64_tr_b16 v[148:149], v1 offset:4096
    ds_read_b64_tr_b16 v[150:151], v1 offset:5120
    s_waitcnt lgkmcnt(0)
    s_add_u32 s50, s41, 0
    s_and_b32 s50, s50, 7
    s_lshl_b32 s53, s58, 3
    s_add_u32 s50, s50, s53
    s_lshl_b32 s12, s50, 10
    s_add_u32 s12, s12, s47
    s_mul_i32 s50, s50, 25600
    s_add_u32 m0, s52, 0
    s_nop 0
    buffer_load_dwordx4 v11, s[32:35], s50 offen lds
    buffer_load_dwordx4 v12, s[32:35], s50 offen offset:1024 lds
    s_add_u32 s50, s41, 1
    s_and_b32 s50, s50, 7
    s_lshl_b32 s53, s58, 3
    s_add_u32 s50, s50, s53
    s_lshl_b32 s13, s50, 10
    s_add_u32 s13, s13, s47
    s_mul_i32 s50, s50, 25600
    s_add_u32 m0, s52, 2048
    s_nop 0
    buffer_load_dwordx4 v11, s[32:35], s50 offen lds
    buffer_load_dwordx4 v12, s[32:35], s50 offen offset:1024 lds
    s_add_u32 s50, s41, 2
    s_and_b32 s50, s50, 7
    s_lshl_b32 s53, s58, 3
    s_add_u32 s50, s50, s53
    s_lshl_b32 s14, s50, 10
    s_add_u32 s14, s14, s47
    s_mul_i32 s50, s50, 25600
    s_add_u32 m0, s52, 4096
    s_nop 0
    buffer_load_dwordx4 v11, s[32:35], s50 offen lds
    buffer_load_dwordx4 v12, s[32:35], s50 offen offset:1024 lds
    s_add_u32 s50, s41, 3
    s_and_b32 s50, s50, 7
    s_lshl_b32 s53, s58, 3
    s_add_u32 s50, s50, s53
    s_lshl_b32 s15, s50, 10
    s_add_u32 s15, s15, s47
    s_mul_i32 s50, s50, 25600
    s_add_u32 m0, s52, 6144
    s_nop 0
    buffer_load_dwordx4 v11, s[32:35], s50 offen lds
    buffer_load_dwordx4 v12, s[32:35], s50 offen offset:1024 lds
    s_add_u32 s50, s41, 4
    s_and_b32 s50, s50, 7
    s_lshl_b32 s53, s58, 3
    s_add_u32 s50, s50, s53
    s_lshl_b32 s16, s50, 10
    s_add_u32 s16, s16, s47
    s_mul_i32 s50, s50, 25600
    s_add_u32 m0, s52, 8192
    s_nop 0
    buffer_load_dwordx4 v11, s[32:35], s50 offen lds
    buffer_load_dwordx4 v12, s[32:35], s50 offen offset:1024 lds
    s_add_u32 s50, s41, 5
    s_and_b32 s50, s50, 7
    s_lshl_b32 s53, s58, 3
    s_add_u32 s50, s50, s53
    s_lshl_b32 s17, s50, 10
    s_add_u32 s17, s17, s47
    s_mul_i32 s50, s50, 25600
    s_add_u32 m0, s52, 10240
    s_nop 0
    buffer_load_dwordx4 v11, s[32:35], s50 offen lds
    buffer_load_dwordx4 v12, s[32:35], s50 offen offset:1024 lds
    s_add_u32 s50, s41, 6
    s_and_b32 s50, s50, 7
    s_lshl_b32 s53, s58, 3
    s_add_u32 s50, s50, s53
    s_lshl_b32 s18, s50, 10
    s_add_u32 s18, s18, s47
    s_mul_i32 s50, s50, 25600
    s_add_u32 m0, s52, 12288
    s_nop 0
    buffer_load_dwordx4 v11, s[32:35], s50 offen lds
    buffer_load_dwordx4 v12, s[32:35], s50 offen offset:1024 lds
    s_add_u32 s50, s41, 7
    s_and_b32 s50, s50, 7
    s_lshl_b32 s53, s58, 3
    s_add_u32 s50, s50, s53
    s_lshl_b32 s19, s50, 10
    s_add_u32 s19, s19, s47
    s_mul_i32 s50, s50, 25600
    s_add_u32 m0, s52, 14336
    s_nop 0
    buffer_load_dwordx4 v11, s[32:35], s50 offen lds
    buffer_load_dwordx4 v12, s[32:35], s50 offen offset:1024 lds
    s_mul_i32 s50, s58, 204800
    s_add_u32 s50, s50, 0
    s_add_u32 m0, s52, 16384
    s_nop 0
    buffer_load_dwordx4 v13, s[32:35], s50 offen lds
    buffer_load_dwordx4 v14, s[32:35], s50 offen offset:1024 lds
    s_mul_i32 s50, s58, 204800
    s_add_u32 s50, s50, 102400
    s_add_u32 m0, s52, 18432
    s_nop 0
    buffer_load_dwordx4 v13, s[32:35], s50 offen lds
    buffer_load_dwordx4 v14, s[32:35], s50 offen offset:1024 lds
    s_lshl_b32 s53, s58, 11
    s_add_u32 s53, s53, s47
    s_add_u32 s53, s53, 32768
    v_add_u32 v5, s42, v3
    v_mul_u32_u24 v5, 1280, v5
    v_lshl_add_u32 v5, v4, 3, v5
    s_lshl_b32 s50, s58, 4
    s_add_u32 s50, s50, s46
    v_add_u32 v5, s50, v5
    buffer_load_dwordx2 v[64:65], v5, s[8:11], 0 offen offset:0
    buffer_load_dwordx2 v[66:67], v5, s[8:11], 0 offen offset:64
    v_add_u32 v5, 40960, v5
    buffer_load_dwordx2 v[68:69], v5, s[8:11], 0 offen offset:0
    buffer_load_dwordx2 v[70:71], v5, s[8:11], 0 offen offset:64
    v_add_u32 v5, 40960, v5
    buffer_load_dwordx2 v[106:107], v5, s[8:11], 0 offen offset:0
    buffer_load_dwordx2 v[108:109], v5, s[8:11], 0 offen offset:64
    v_lshlrev_b32 v5, 8, v3
    v_and_b32 v6, 7, v3
    v_xor_b32 v6, v6, v4
    v_lshl_add_u32 v5, v6, 4, v5
    s_lshl_b32 s50, s58, 13
    s_add_u32 s50, s50, 98304
    v_add_u32 v11, s50, v5
    v_add_u32 v12, s52, v5
    v_lshrrev_b32 v5, 3, v0
    v_and_b32 v6, 7, v0
    v_lshlrev_b32 v6, 1, v6
    v_and_b32 v7, 7, v5
    v_xor_b32 v6, v6, v7
    v_lshlrev_b32 v5, 8, v5
    v_lshl_add_u32 v13, v6, 4, v5
    v_add_u32 v14, 98304, v13
    s_waitcnt vmcnt(0)
    ds_read_b64_tr_b16 v[16:17], v15 offset:16384
    ds_read_b64_tr_b16 v[18:19], v15 offset:17408
    ds_read_b64_tr_b16 v[20:21], v1 offset:16384
    ds_read_b64_tr_b16 v[22:23], v1 offset:17408
    s_barrier
    s_setprio 3
    buffer_load_dwordx2 v[72:73], v37, s[4:7], s53 offen offset:0 sc1
    buffer_load_dwordx2 v[74:75], v37, s[4:7], s53 offen offset:256 sc1
    buffer_load_dwordx2 v[76:77], v37, s[4:7], s53 offen offset:1024 sc1
    buffer_load_dwordx2 v[78:79], v37, s[4:7], s53 offen offset:1280 sc1
    buffer_load_dwordx2 v[112:113], v38, s[4:7], s53 offen offset:0 sc1
    buffer_load_dwordx2 v[114:115], v38, s[4:7], s53 offen offset:256 sc1
    buffer_load_dwordx2 v[116:117], v38, s[4:7], s53 offen offset:1024 sc1
    buffer_load_dwordx2 v[118:119], v38, s[4:7], s53 offen offset:1280 sc1
    buffer_load_dwordx2 v[152:153], v39, s[4:7], s53 offen offset:0 sc1
    buffer_load_dwordx2 v[154:155], v39, s[4:7], s53 offen offset:256 sc1
    buffer_load_dwordx2 v[156:157], v39, s[4:7], s53 offen offset:1024 sc1
    buffer_load_dwordx2 v[158:159], v39, s[4:7], s53 offen offset:1280 sc1
    v_mfma_f32_32x32x16_bf16 v[160:175], v[120:123], v[92:95], v[160:175]
    v_mfma_f32_32x32x16_bf16 v[192:207], v[120:123], v[96:99], v[192:207]
    v_mfma_f32_32x32x16_bf16 v[224:239], v[120:123], v[100:103], v[224:239]
    v_mfma_f32_32x32x16_bf16 v[176:191], v[124:127], v[92:95], v[176:191]
    v_mfma_f32_32x32x16_bf16 v[208:223], v[124:127], v[96:99], v[208:223]
    v_mfma_f32_32x32x16_bf16 v[240:255], v[124:127], v[100:103], v[240:255]
    v_mfma_f32_32x32x16_bf16 v[160:175], v[128:131], v[40:43], v[160:175]
    v_mfma_f32_32x32x16_bf16 v[192:207], v[128:131], v[44:47], v[192:207]
    v_mfma_f32_32x32x16_bf16 v[224:239], v[128:131], v[48:51], v[224:239]
    v_mfma_f32_32x32x16_bf16 v[176:191], v[132:135], v[40:43], v[176:191]
    v_mfma_f32_32x32x16_bf16 v[208:223], v[132:135], v[44:47], v[208:223]
    v_mfma_f32_32x32x16_bf16 v[240:255], v[132:135], v[48:51], v[240:255]
    v_mfma_f32_32x32x16_bf16 v[160:175], v[136:139], v[52:55], v[160:175]
    v_mfma_f32_32x32x16_bf16 v[192:207], v[136:139], v[56:59], v[192:207]
    v_mfma_f32_32x32x16_bf16 v[224:239], v[136:139], v[60:63], v[224:239]
    v_mfma_f32_32x32x16_bf16 v[176:191], v[140:143], v[52:55], v[176:191]
    v_mfma_f32_32x32x16_bf16 v[208:223], v[140:143], v[56:59], v[208:223]
    v_mfma_f32_32x32x16_bf16 v[240:255], v[140:143], v[60:63], v[240:255]
    v_mfma_f32_32x32x16_bf16 v[160:175], v[144:147], v[80:83], v[160:175]
    v_mfma_f32_32x32x16_bf16 v[192:207], v[144:147], v[84:87], v[192:207]
    v_mfma_f32_32x32x16_bf16 v[224:239], v[144:147], v[88:91], v[224:239]
    v_mfma_f32_32x32x16_bf16 v[176:191], v[148:151], v[80:83], v[176:191]
    v_mfma_f32_32x32x16_bf16 v[208:223], v[148:151], v[84:87], v[208:223]
    v_mfma_f32_32x32x16_bf16 v[240:255], v[148:151], v[88:91], v[240:255]
    v_lshlrev_b32 v40, 16, v64
    v_and_b32 v41, 0xffff0000, v64
    v_lshlrev_b32 v42, 16, v65
    v_and_b32 v43, 0xffff0000, v65
    v_lshlrev_b32 v44, 16, v66
    v_and_b32 v45, 0xffff0000, v66
    v_lshlrev_b32 v46, 16, v67
    v_and_b32 v47, 0xffff0000, v67
    v_lshlrev_b32 v48, 16, v68
    v_and_b32 v49, 0xffff0000, v68
    v_lshlrev_b32 v50, 16, v69
    v_and_b32 v51, 0xffff0000, v69
    v_lshlrev_b32 v52, 16, v70
    v_and_b32 v53, 0xffff0000, v70
    v_lshlrev_b32 v54, 16, v71
    v_and_b32 v55, 0xffff0000, v71
    v_lshlrev_b32 v56, 16, v106
    v_and_b32 v57, 0xffff0000, v106
    v_lshlrev_b32 v58, 16, v107
    v_and_b32 v59, 0xffff0000, v107
    v_lshlrev_b32 v60, 16, v108
    v_and_b32 v61, 0xffff0000, v108
    v_lshlrev_b32 v62, 16, v109
    v_and_b32 v63, 0xffff0000, v109
    s_cmp_lg_u32 s58, 0
    s_cbranch_scc1 L_x59
    v_add_f32 v160, v160, v40
    v_add_f32 v161, v161, v41
    v_add_f32 v162, v162, v42
    v_add_f32 v163, v163, v43
    v_add_f32 v176, v176, v44
    v_add_f32 v177, v177, v45
    v_add_f32 v178, v178, v46
    v_add_f32 v179, v179, v47
    v_add_f32 v192, v192, v48
    v_add_f32 v193, v193, v49
    v_add_f32 v194, v194, v50
    v_add_f32 v195, v195, v51
    v_add_f32 v208, v208, v52
    v_add_f32 v209, v209, v53
    v_add_f32 v210, v210, v54
    v_add_f32 v211, v211, v55
    v_add_f32 v224, v224, v56
    v_add_f32 v225, v225, v57
    v_add_f32 v226, v226, v58
    v_add_f32 v227, v227, v59
    v_add_f32 v240, v240, v60
    v_add_f32 v241, v241, v61
    v_add_f32 v242, v242, v62
    v_add_f32 v243, v243, v63
L_x59:
    s_cmp_lg_u32 s58, 1
    s_cbranch_scc1 L_x60
    v_add_f32 v164, v164, v40
    v_add_f32 v165, v165, v41
    v_add_f32 v166, v166, v42
    v_add_f32 v167, v167, v43
    v_add_f32 v180, v180, v44
    v_add_f32 v181, v181, v45
    v_add_f32 v182, v182, v46
    v_add_f32 v183, v183, v47
    v_add_f32 v196, v196, v48
    v_add_f32 v197, v197, v49
    v_add_f32 v198, v198, v50
    v_add_f32 v199, v199, v51
    v_add_f32 v212, v212, v52
    v_add_f32 v213, v213, v53
    v_add_f32 v214, v214, v54
    v_add_f32 v215, v215, v55
    v_add_f32 v228, v228, v56
    v_add_f32 v229, v229, v57
    v_add_f32 v230, v230, v58
    v_add_f32 v231, v231, v59
    v_add_f32 v244, v244, v60
    v_add_f32 v245, v245, v61
    v_add_f32 v246, v246, v62
    v_add_f32 v247, v247, v63
L_x60:
    s_cmp_lg_u32 s58, 2
    s_cbranch_scc1 L_x61
    v_add_f32 v168, v168, v40
    v_add_f32 v169, v169, v41
    v_add_f32 v170, v170, v42
    v_add_f32 v171, v171, v43
    v_add_f32 v184, v184, v44
    v_add_f32 v185, v185, v45
    v_add_f32 v186, v186, v46
    v_add_f32 v187, v187, v47
    v_add_f32 v200, v200, v48
    v_add_f32 v201, v201, v49
    v_add_f32 v202, v202, v50
    v_add_f32 v203, v203, v51
    v_add_f32 v216, v216, v52
    v_add_f32 v217, v217, v53
    v_add_f32 v218, v218, v54
    v_add_f32 v219, v219, v55
    v_add_f32 v232, v232, v56
    v_add_f32 v233, v233, v57
    v_add_f32 v234, v234, v58
    v_add_f32 v235, v235, v59
    v_add_f32 v248, v248, v60
    v_add_f32 v249, v249, v61
    v_add_f32 v250, v250, v62
    v_add_f32 v251, v251, v63
L_x61:
    s_cmp_lg_u32 s58, 3
    s_cbranch_scc1 L_x62
    v_add_f32 v172, v172, v40
    v_add_f32 v173, v173, v41
    v_add_f32 v174, v174, v42
    v_add_f32 v175, v175, v43
    v_add_f32 v188, v188, v44
    v_add_f32 v189, v189, v45
    v_add_f32 v190, v190, v46
    v_add_f32 v191, v191, v47
    v_add_f32 v204, v204, v48
    v_add_f32 v205, v205, v49
    v_add_f32 v206, v206, v50
    v_add_f32 v207, v207, v51
    v_add_f32 v220, v220, v52
    v_add_f32 v221, v221, v53
    v_add_f32 v222, v222, v54
    v_add_f32 v223, v223, v55
    v_add_f32 v236, v236, v56
    v_add_f32 v237, v237, v57
    v_add_f32 v238, v238, v58
    v_add_f32 v239, v239, v59
    v_add_f32 v252, v252, v60
    v_add_f32 v253, v253, v61
    v_add_f32 v254, v254, v62
    v_add_f32 v255, v255, v63
L_x62:
    s_waitcnt vmcnt(0)
    v_max_u32 v6, v72, v158
    v_max3_u32 v6, v6, v74, v76
    v_max3_u32 v6, v6, v78, v112
    v_max3_u32 v6, v6, v114, v116
    v_max3_u32 v6, v6, v118, v152
    v_max3_u32 v6, v6, v154, v156
    v_cmp_eq_u32 vcc, -1, v6
    s_nop 1
    s_cbranch_vccz L_g_go
    s_mov_b32 s71, 20000
L_p63:
    buffer_load_dwordx2 v[72:73], v37, s[4:7], s53 offen offset:0 sc1
    buffer_load_dwordx2 v[74:75], v37, s[4:7], s53 offen offset:256 sc1
    buffer_load_dwordx2 v[76:77], v37, s[4:7], s53 offen offset:1024 sc1
    buffer_load_dwordx2 v[78:79], v37, s[4:7], s53 offen offset:1280 sc1
    buffer_load_dwordx2 v[112:113], v38, s[4:7], s53 offen offset:0 sc1
    buffer_load_dwordx2 v[114:115], v38, s[4:7], s53 offen offset:256 sc1
    buffer_load_dwordx2 v[116:117], v38, s[4:7], s53 offen offset:1024 sc1
    buffer_load_dwordx2 v[118:119], v38, s[4:7], s53 offen offset:1280 sc1
    buffer_load_dwordx2 v[152:153], v39, s[4:7], s53 offen offset:0 sc1
    buffer_load_dwordx2 v[154:155], v39, s[4:7], s53 offen offset:256 sc1
    buffer_load_dwordx2 v[156:157], v39, s[4:7], s53 offen offset:1024 sc1
    buffer_load_dwordx2 v[158:159], v39, s[4:7], s53 offen offset:1280 sc1
    s_waitcnt vmcnt(0)
    v_max_u32 v6, v72, v158
    v_max3_u32 v6, v6, v74, v76
    v_max3_u32 v6, v6, v78, v112
    v_max3_u32 v6, v6, v114, v116
    v_max3_u32 v6, v6, v118, v152
    v_max3_u32 v6, v6, v154, v156
    v_cmp_eq_u32 vcc, -1, v6
    s_nop 1
    s_cbranch_vccz L_pd64
    s_sleep 1
    s_sub_u32 s71, s71, 1
    s_cmp_lg_u32 s71, 0
    s_cbranch_scc1 L_p63
L_pd64:
L_g_go:
    buffer_load_dwordx4 v[40:43], v8, s[4:7], s12 offen sc1
    buffer_load_dwordx4 v[80:83], v9, s[4:7], s12 offen sc1
    buffer_load_dwordx4 v[44:47], v8, s[4:7], s13 offen sc1
    buffer_load_dwordx4 v[84:87], v9, s[4:7], s13 offen sc1
    buffer_load_dwordx4 v[48:51], v8, s[4:7], s14 offen sc1
    buffer_load_dwordx4 v[88:91], v9, s[4:7], s14 offen sc1
    buffer_load_dwordx4 v[52:55], v8, s[4:7], s15 offen sc1
    buffer_load_dwordx4 v[92:95], v9, s[4:7], s15 offen sc1
    buffer_load_dwordx4 v[56:59], v8, s[4:7], s16 offen sc1
    buffer_load_dwordx4 v[96:99], v9, s[4:7], s16 offen sc1
    buffer_load_dwordx4 v[60:63], v8, s[4:7], s17 offen sc1
    buffer_load_dwordx4 v[100:103], v9, s[4:7], s17 offen sc1
    buffer_load_dwordx4 v[64:67], v8, s[4:7], s18 offen sc1
    buffer_load_dwordx4 v[104:107], v9, s[4:7], s18 offen sc1
    buffer_load_dwordx4 v[68:71], v8, s[4:7], s19 offen sc1
    buffer_load_dwordx4 v[108:111], v9, s[4:7], s19 offen sc1
    buffer_load_dwordx4 v[120:123], v10, s[4:7], s12 offen sc1
    buffer_load_dwordx4 v[124:127], v10, s[4:7], s13 offen sc1
    buffer_load_dwordx4 v[128:131], v10, s[4:7], s14 offen sc1
    buffer_load_dwordx4 v[132:135], v10, s[4:7], s15 offen sc1
    buffer_load_dwordx4 v[136:139], v10, s[4:7], s16 offen sc1
    buffer_load_dwordx4 v[140:143], v10, s[4:7], s17 offen sc1
    buffer_load_dwordx4 v[144:147], v10, s[4:7], s18 offen sc1
    buffer_load_dwordx4 v[148:151], v10, s[4:7], s19 offen sc1
    v_mov_b32 v2, v34
    v_mov_b32 v3, v35
    v_xor_b32 v7, 16, v14
    v_xor_b32 v4, 16, v13
    v_add_u32 v5, 49152, v13
    v_add_u32 v0, 49152, v4
    v_xor_b32 v32, 0, v11
    v_xor_b32 v33, 32, v11
    v_xor_b32 v34, 64, v11
    v_xor_b32 v35, 96, v11
    ds_read_b64_tr_b16 v[24:25], v15 offset:18432
    ds_read_b64_tr_b16 v[26:27], v15 offset:19456
    ds_read_b64_tr_b16 v[28:29], v1 offset:18432
    ds_read_b64_tr_b16 v[30:31], v1 offset:19456
    s_waitcnt vmcnt(24) lgkmcnt(4)
    v_mfma_f32_32x32x16_bf16 v[160:175], v[16:19], v[72:75], v[160:175]
    v_mfma_f32_32x32x16_bf16 v[192:207], v[16:19], v[112:115], v[192:207]
    v_mfma_f32_32x32x16_bf16 v[176:191], v[20:23], v[72:75], v[176:191]
    v_mfma_f32_32x32x16_bf16 v[208:223], v[20:23], v[112:115], v[208:223]
    ds_read_b64_tr_b16 v[16:17], v15 offset:0
    ds_read_b64_tr_b16 v[18:19], v15 offset:1024
    ds_read_b64_tr_b16 v[20:21], v1 offset:0
    ds_read_b64_tr_b16 v[22:23], v1 offset:1024
    s_waitcnt vmcnt(24) lgkmcnt(4)
    v_mfma_f32_32x32x16_bf16 v[160:175], v[24:27], v[76:79], v[160:175]
    v_mfma_f32_32x32x16_bf16 v[192:207], v[24:27], v[116:119], v[192:207]
    v_mfma_f32_32x32x16_bf16 v[176:191], v[28:31], v[76:79], v[176:191]
    v_mfma_f32_32x32x16_bf16 v[208:223], v[28:31], v[116:119], v[208:223]
    ds_read_b64_tr_b16 v[24:25], v15 offset:2048
    ds_read_b64_tr_b16 v[26:27], v15 offset:3072
    ds_read_b64_tr_b16 v[28:29], v1 offset:2048
    ds_read_b64_tr_b16 v[30:31], v1 offset:3072
    s_waitcnt vmcnt(22) lgkmcnt(4)
    v_max_u32 v6, v40, v80
    v_cmp_eq_u32 vcc, -1, v6
    s_nop 0
    s_cbranch_vccnz L_r65
L_rb66:
    v_mfma_f32_32x32x16_bf16 v[160:175], v[16:19], v[40:43], v[160:175]
    v_mfma_f32_32x32x16_bf16 v[192:207], v[16:19], v[80:83], v[192:207]
    v_mfma_f32_32x32x16_bf16 v[176:191], v[20:23], v[40:43], v[176:191]
    v_mfma_f32_32x32x16_bf16 v[208:223], v[20:23], v[80:83], v[208:223]
    ds_read_b64_tr_b16 v[16:17], v15 offset:4096
    ds_read_b64_tr_b16 v[18:19], v15 offset:5120
    ds_read_b64_tr_b16 v[20:21], v1 offset:4096
    ds_read_b64_tr_b16 v[22:23], v1 offset:5120
    s_waitcnt vmcnt(20) lgkmcnt(4)
    v_max_u32 v6, v44, v84
    v_cmp_eq_u32 vcc, -1, v6
    s_nop 0
    s_cbranch_vccnz L_r67
L_rb68:
    v_mfma_f32_32x32x16_bf16 v[160:175], v[24:27], v[44:47], v[160:175]
    v_mfma_f32_32x32x16_bf16 v[192:207], v[24:27], v[84:87], v[192:207]
    v_mfma_f32_32x32x16_bf16 v[176:191], v[28:31], v[44:47], v[176:191]
    v_mfma_f32_32x32x16_bf16 v[208:223], v[28:31], v[84:87], v[208:223]
    ds_read_b64_tr_b16 v[24:25], v15 offset:6144
    ds_read_b64_tr_b16 v[26:27], v15 offset:7168
    ds_read_b64_tr_b16 v[28:29], v1 offset:6144
    ds_read_b64_tr_b16 v[30:31], v1 offset:7168
    s_waitcnt vmcnt(18) lgkmcnt(4)
    v_max_u32 v6, v48, v88
    v_cmp_eq_u32 vcc, -1, v6
    s_nop 0
    s_cbranch_vccnz L_r69
L_rb70:
    v_mfma_f32_32x32x16_bf16 v[160:175], v[16:19], v[48:51], v[160:175]
    v_mfma_f32_32x32x16_bf16 v[192:207], v[16:19], v[88:91], v[192:207]
    v_mfma_f32_32x32x16_bf16 v[176:191], v[20:23], v[48:51], v[176:191]
    v_mfma_f32_32x32x16_bf16 v[208:223], v[20:23], v[88:91], v[208:223]
    ds_read_b64_tr_b16 v[16:17], v15 offset:8192
    ds_read_b64_tr_b16 v[18:19], v15 offset:9216
    ds_read_b64_tr_b16 v[20:21], v1 offset:8192
    ds_read_b64_tr_b16 v[22:23], v1 offset:9216
    s_waitcnt vmcnt(16) lgkmcnt(4)
    v_max_u32 v6, v52, v92
    v_cmp_eq_u32 vcc, -1, v6
    s_nop 0
    s_cbranch_vccnz L_r71
L_rb72:
    v_mfma_f32_32x32x16_bf16 v[160:175], v[24:27], v[52:55], v[160:175]
    v_mfma_f32_32x32x16_bf16 v[192:207], v[24:27], v[92:95], v[192:207]
    v_mfma_f32_32x32x16_bf16 v[176:191], v[28:31], v[52:55], v[176:191]
    v_mfma_f32_32x32x16_bf16 v[208:223], v[28:31], v[92:95], v[208:223]
    ds_read_b64_tr_b16 v[24:25], v15 offset:10240
    ds_read_b64_tr_b16 v[26:27], v15 offset:11264
    ds_read_b64_tr_b16 v[28:29], v1 offset:10240
    ds_read_b64_tr_b16 v[30:31], v1 offset:11264
    s_waitcnt vmcnt(14) lgkmcnt(4)
    v_max_u32 v6, v56, v96
    v_cmp_eq_u32 vcc, -1, v6
    s_nop 0
    s_cbranch_vccnz L_r73
L_rb74:
    v_mfma_f32_32x32x16_bf16 v[160:175], v[16:19], v[56:59], v[160:175]
    v_mfma_f32_32x32x16_bf16 v[192:207], v[16:19], v[96:99], v[192:207]
    v_mfma_f32_32x32x16_bf16 v[176:191], v[20:23], v[56:59], v[176:191]
    v_mfma_f32_32x32x16_bf16 v[208:223], v[20:23], v[96:99], v[208:223]
    ds_read_b64_tr_b16 v[16:17], v15 offset:12288
    ds_read_b64_tr_b16 v[18:19], v15 offset:13312
    ds_read_b64_tr_b16 v[20:21], v1 offset:12288
    ds_read_b64_tr_b16 v[22:23], v1 offset:13312
    s_waitcnt vmcnt(12) lgkmcnt(4)
    v_max_u32 v6, v60, v100
    v_cmp_eq_u32 vcc, -1, v6
    s_nop 0
    s_cbranch_vccnz L_r75
L_rb76:
    v_mfma_f32_32x32x16_bf16 v[160:175], v[24:27], v[60:63], v[160:175]
    v_mfma_f32_32x32x16_bf16 v[192:207], v[24:27], v[100:103], v[192:207]
    v_mfma_f32_32x32x16_bf16 v[176:191], v[28:31], v[60:63], v[176:191]
    v_mfma_f32_32x32x16_bf16 v[208:223], v[28:31], v[100:103], v[208:223]
    ds_read_b64_tr_b16 v[24:25], v15 offset:14336
    ds_read_b64_tr_b16 v[26:27], v15 offset:15360
    ds_read_b64_tr_b16 v[28:29], v1 offset:14336
    ds_read_b64_tr_b16 v[30:31], v1 offset:15360
    s_waitcnt vmcnt(10) lgkmcnt(4)
    v_max_u32 v6, v64, v104
    v_cmp_eq_u32 vcc, -1, v6
    s_nop 0
    s_cbranch_vccnz L_r77
L_rb78:
    v_mfma_f32_32x32x16_bf16 v[160:175], v[16:19], v[64:67], v[160:175]
    v_mfma_f32_32x32x16_bf16 v[192:207], v[16:19], v[104:107], v[192:207]
    v_mfma_f32_32x32x16_bf16 v[176:191], v[20:23], v[64:67], v[176:191]
    v_mfma_f32_32x32x16_bf16 v[208:223], v[20:23], v[104:107], v[208:223]
    s_waitcnt vmcnt(8) lgkmcnt(0)
    v_max_u32 v6, v68, v108
    v_cmp_eq_u32 vcc, -1, v6
    s_nop 0
    s_cbranch_vccnz L_r79
L_rb80:
    v_mfma_f32_32x32x16_bf16 v[160:175], v[24:27], v[68:71], v[160:175]
    v_mfma_f32_32x32x16_bf16 v[192:207], v[24:27], v[108:111], v[192:207]
    v_mfma_f32_32x32x16_bf16 v[176:191], v[28:31], v[68:71], v[176:191]
    v_mfma_f32_32x32x16_bf16 v[208:223], v[28:31], v[108:111], v[208:223]
    ds_read_b64_tr_b16 v[40:41], v15 offset:16384
    ds_read_b64_tr_b16 v[42:43], v15 offset:17408
    ds_read_b64_tr_b16 v[44:45], v1 offset:16384
    ds_read_b64_tr_b16 v[46:47], v1 offset:17408
    ds_read_b64_tr_b16 v[48:49], v15 offset:18432
    ds_read_b64_tr_b16 v[50:51], v15 offset:19456
    ds_read_b64_tr_b16 v[52:53], v1 offset:18432
    ds_read_b64_tr_b16 v[54:55], v1 offset:19456
    ds_read_b64_tr_b16 v[56:57], v15 offset:0
    ds_read_b64_tr_b16 v[58:59], v15 offset:1024
    ds_read_b64_tr_b16 v[60:61], v1 offset:0
    ds_read_b64_tr_b16 v[62:63], v1 offset:1024
    s_waitcnt vmcnt(8) lgkmcnt(8)
    v_mfma_f32_32x32x16_bf16 v[224:239], v[40:43], v[152:155], v[224:239]
    ds_write_b128 v32, v[160:163] offset:0
    ds_write_b128 v33, v[164:167] offset:0
    v_mfma_f32_32x32x16_bf16 v[240:255], v[44:47], v[152:155], v[240:255]
    ds_read_b64_tr_b16 v[64:65], v15 offset:2048
    ds_read_b64_tr_b16 v[66:67], v15 offset:3072
    ds_read_b64_tr_b16 v[68:69], v1 offset:2048
    ds_read_b64_tr_b16 v[70:71], v1 offset:3072
    s_waitcnt vmcnt(8) lgkmcnt(10)
    v_mfma_f32_32x32x16_bf16 v[224:239], v[48:51], v[156:159], v[224:239]
    ds_write_b128 v34, v[168:171] offset:0
    ds_write_b128 v35, v[172:175] offset:0
    v_mfma_f32_32x32x16_bf16 v[240:255], v[52:55], v[156:159], v[240:255]
    ds_read_b64_tr_b16 v[72:73], v15 offset:4096
    ds_read_b64_tr_b16 v[74:75], v15 offset:5120
    ds_read_b64_tr_b16 v[76:77], v1 offset:4096
    ds_read_b64_tr_b16 v[78:79], v1 offset:5120
    s_waitcnt vmcnt(7) lgkmcnt(12)
    v_max_u32 v6, v120, v120
    v_cmp_eq_u32 vcc, -1, v6
    s_nop 0
    s_cbranch_vccnz L_r81
L_rb82:
    v_mfma_f32_32x32x16_bf16 v[224:239], v[56:59], v[120:123], v[224:239]
    ds_write_b128 v32, v[176:179] offset:128
    ds_write_b128 v33, v[180:183] offset:128
    v_mfma_f32_32x32x16_bf16 v[240:255], v[60:63], v[120:123], v[240:255]
    ds_read_b64_tr_b16 v[80:81], v15 offset:6144
    ds_read_b64_tr_b16 v[82:83], v15 offset:7168
    ds_read_b64_tr_b16 v[84:85], v1 offset:6144
    ds_read_b64_tr_b16 v[86:87], v1 offset:7168
    s_waitcnt vmcnt(6) lgkmcnt(12)
    v_max_u32 v6, v124, v124
    v_cmp_eq_u32 vcc, -1, v6
    s_nop 0
    s_cbranch_vccnz L_r83
L_rb84:
    v_mfma_f32_32x32x16_bf16 v[224:239], v[64:67], v[124:127], v[224:239]
    ds_write_b128 v34, v[184:187] offset:128
    ds_write_b128 v35, v[188:191] offset:128
    v_mfma_f32_32x32x16_bf16 v[240:255], v[68:71], v[124:127], v[240:255]
    ds_read_b64_tr_b16 v[88:89], v15 offset:8192
    ds_read_b64_tr_b16 v[90:91], v15 offset:9216
    ds_read_b64_tr_b16 v[92:93], v1 offset:8192
    ds_read_b64_tr_b16 v[94:95], v1 offset:9216
    s_waitcnt vmcnt(5) lgkmcnt(12)
    v_max_u32 v6, v128, v128
    v_cmp_eq_u32 vcc, -1, v6
    s_nop 0
    s_cbranch_vccnz L_r85
L_rb86:
    v_mfma_f32_32x32x16_bf16 v[224:239], v[72:75], v[128:131], v[224:239]
    ds_write_b128 v32, v[192:195] offset:32768
    ds_write_b128 v33, v[196:199] offset:32768
    v_mfma_f32_32x32x16_bf16 v[240:255], v[76:79], v[128:131], v[240:255]
    ds_read_b64_tr_b16 v[96:97], v15 offset:10240
    ds_read_b64_tr_b16 v[98:99], v15 offset:11264
    ds_read_b64_tr_b16 v[100:101], v1 offset:10240
    ds_read_b64_tr_b16 v[102:103], v1 offset:11264
    s_waitcnt vmcnt(4) lgkmcnt(12)
    v_max_u32 v6, v132, v132
    v_cmp_eq_u32 vcc, -1, v6
    s_nop 0
    s_cbranch_vccnz L_r87
L_rb88:
    v_mfma_f32_32x32x16_bf16 v[224:239], v[80:83], v[132:135], v[224:239]
    ds_write_b128 v34, v[200:203] offset:32768
    ds_write_b128 v35, v[204:207] offset:32768
    v_mfma_f32_32x32x16_bf16 v[240:255], v[84:87], v[132:135], v[240:255]
    ds_read_b64_tr_b16 v[104:105], v15 offset:12288
    ds_read_b64_tr_b16 v[106:107], v15 offset:13312
    ds_read_b64_tr_b16 v[108:109], v1 offset:12288
    ds_read_b64_tr_b16 v[110:111], v1 offset:13312
    s_waitcnt vmcnt(3) lgkmcnt(12)
    v_max_u32 v6, v136, v136
    v_cmp_eq_u32 vcc, -1, v6
    s_nop 0
    s_cbranch_vccnz L_r89
L_rb90:
    v_mfma_f32_32x32x16_bf16 v[224:239], v[88:91], v[136:139], v[224:239]
    ds_write_b128 v32, v[208:211] offset:32896
    ds_write_b128 v33, v[212:215] offset:32896
    v_mfma_f32_32x32x16_bf16 v[240:255], v[92:95], v[136:139], v[240:255]
    ds_read_b64_tr_b16 v[112:113], v15 offset:14336
    ds_read_b64_tr_b16 v[114:115], v15 offset:15360
    ds_read_b64_tr_b16 v[116:117], v1 offset:14336
    ds_read_b64_tr_b16 v[118:119], v1 offset:15360
    s_waitcnt vmcnt(2) lgkmcnt(12)
    v_max_u32 v6, v140, v140
    v_cmp_eq_u32 vcc, -1, v6
    s_nop 0
    s_cbranch_vccnz L_r91
L_rb92:
    v_mfma_f32_32x32x16_bf16 v[224:239], v[96:99], v[140:143], v[224:239]
    ds_write_b128 v34, v[216:219] offset:32896
    ds_write_b128 v35, v[220:223] offset:32896
    v_mfma_f32_32x32x16_bf16 v[240:255], v[100:103], v[140:143], v[240:255]
    s_waitcnt vmcnt(1) lgkmcnt(0)
    s_barrier
    ds_read_b128 v[40:43], v14 offset:0
    ds_read_b128 v[44:47], v7 offset:0
    ds_read_b128 v[48:51], v14 offset:8192
    ds_read_b128 v[52:55], v7 offset:8192
    ds_read_b128 v[56:59], v14 offset:16384
    ds_read_b128 v[60:63], v7 offset:16384
    ds_read_b128 v[64:67], v14 offset:24576
    ds_read_b128 v[68:71], v7 offset:24576
    v_max_u32 v6, v144, v144
    v_cmp_eq_u32 vcc, -1, v6
    s_nop 0
    s_cbranch_vccnz L_r93
L_rb94:
    v_mfma_f32_32x32x16_bf16 v[224:239], v[104:107], v[144:147], v[224:239]
    v_mfma_f32_32x32x16_bf16 v[240:255], v[108:111], v[144:147], v[240:255]
    s_waitcnt vmcnt(0)
    ds_read_b128 v[72:75], v14 offset:32768
    ds_read_b128 v[76:79], v7 offset:32768
    ds_read_b128 v[80:83], v14 offset:40960
    ds_read_b128 v[84:87], v7 offset:40960
    ds_read_b128 v[88:91], v14 offset:49152
    ds_read_b128 v[92:95], v7 offset:49152
    ds_read_b128 v[96:99], v14 offset:57344
    ds_read_b128 v[100:103], v7 offset:57344
    v_max_u32 v6, v148, v148
    v_cmp_eq_u32 vcc, -1, v6
    s_nop 0
    s_cbranch_vccnz L_r95
L_rb96:
    v_mfma_f32_32x32x16_bf16 v[224:239], v[112:115], v[148:151], v[224:239]
    v_mfma_f32_32x32x16_bf16 v[240:255], v[116:119], v[148:151], v[240:255]
    v_xor_b32 v32, 0, v12
    v_xor_b32 v33, 32, v12
    v_xor_b32 v34, 64, v12
    v_xor_b32 v35, 96, v12
    s_waitcnt lgkmcnt(8)
    v_pk_add_f32 v[40:41], v[40:41], v[48:49]
    v_pk_add_f32 v[42:43], v[42:43], v[50:51]
    v_pk_add_f32 v[44:45], v[44:45], v[52:53]
    v_pk_add_f32 v[46:47], v[46:47], v[54:55]
    v_pk_add_f32 v[56:57], v[56:57], v[64:65]
    v_pk_add_f32 v[58:59], v[58:59], v[66:67]
    v_pk_add_f32 v[60:61], v[60:61], v[68:69]
    v_pk_add_f32 v[62:63], v[62:63], v[70:71]
    v_pk_add_f32 v[40:41], v[40:41], v[56:57]
    v_pk_add_f32 v[42:43], v[42:43], v[58:59]
    v_pk_add_f32 v[44:45], v[44:45], v[60:61]
    v_pk_add_f32 v[46:47], v[46:47], v[62:63]
    v_cvt_pk_bf16_f32 v40, v40, v41
    v_cvt_pk_bf16_f32 v41, v42, v43
    v_cvt_pk_bf16_f32 v42, v44, v45
    v_cvt_pk_bf16_f32 v43, v46, v47
    buffer_store_dwordx4 v[40:43], v2, s[36:39], 0 offen sc1
    ds_write_b128 v32, v[224:227] offset:0
    ds_write_b128 v33, v[228:231] offset:0
    ds_write_b128 v34, v[232:235] offset:0
    ds_write_b128 v35, v[236:239] offset:0
    ds_write_b128 v32, v[240:243] offset:128
    ds_write_b128 v33, v[244:247] offset:128
    ds_write_b128 v34, v[248:251] offset:128
    ds_write_b128 v35, v[252:255] offset:128
    s_waitcnt lgkmcnt(8)
    v_pk_add_f32 v[72:73], v[72:73], v[80:81]
    v_pk_add_f32 v[74:75], v[74:75], v[82:83]
    v_pk_add_f32 v[76:77], v[76:77], v[84:85]
    v_pk_add_f32 v[78:79], v[78:79], v[86:87]
    v_pk_add_f32 v[88:89], v[88:89], v[96:97]
    v_pk_add_f32 v[90:91], v[90:91], v[98:99]
    v_pk_add_f32 v[92:93], v[92:93], v[100:101]
    v_pk_add_f32 v[94:95], v[94:95], v[102:103]
    v_pk_add_f32 v[72:73], v[72:73], v[88:89]
    v_pk_add_f32 v[74:75], v[74:75], v[90:91]
    v_pk_add_f32 v[76:77], v[76:77], v[92:93]
    v_pk_add_f32 v[78:79], v[78:79], v[94:95]
    v_cvt_pk_bf16_f32 v72, v72, v73
    v_cvt_pk_bf16_f32 v73, v74, v75
    v_cvt_pk_bf16_f32 v74, v76, v77
    v_cvt_pk_bf16_f32 v75, v78, v79
    buffer_store_dwordx4 v[72:75], v3, s[36:39], 0 offen sc1
    s_waitcnt lgkmcnt(0)
    s_barrier
    ds_read_b128 v[104:107], v13 offset:0
    ds_read_b128 v[108:111], v4 offset:0
    ds_read_b128 v[112:115], v13 offset:24576
    ds_read_b128 v[116:119], v4 offset:24576
    ds_read_b128 v[120:123], v5 offset:0
    ds_read_b128 v[124:127], v0 offset:0
    ds_read_b128 v[128:131], v5 offset:24576
    ds_read_b128 v[132:135], v0 offset:24576
    s_waitcnt lgkmcnt(0)
    v_pk_add_f32 v[104:105], v[104:105], v[112:113]
    v_pk_add_f32 v[106:107], v[106:107], v[114:115]
    v_pk_add_f32 v[108:109], v[108:109], v[116:117]
    v_pk_add_f32 v[110:111], v[110:111], v[118:119]
    v_pk_add_f32 v[120:121], v[120:121], v[128:129]
    v_pk_add_f32 v[122:123], v[122:123], v[130:131]
    v_pk_add_f32 v[124:125], v[124:125], v[132:133]
    v_pk_add_f32 v[126:127], v[126:127], v[134:135]
    v_pk_add_f32 v[104:105], v[104:105], v[120:121]
    v_pk_add_f32 v[106:107], v[106:107], v[122:123]
    v_pk_add_f32 v[108:109], v[108:109], v[124:125]
    v_pk_add_f32 v[110:111], v[110:111], v[126:127]
    v_cvt_pk_bf16_f32 v104, v104, v105
    v_cvt_pk_bf16_f32 v105, v106, v107
    v_cvt_pk_bf16_f32 v106, v108, v109
    v_cvt_pk_bf16_f32 v107, v110, v111
    buffer_store_dwordx4 v[104:107], v36, s[36:39], 0 offen sc1
L_end:
    s_endpgm
L_r65:
    s_mov_b32 s71, 20000
L_p97:
    buffer_load_dwordx4 v[40:43], v8, s[4:7], s12 offen sc1
    buffer_load_dwordx4 v[80:83], v9, s[4:7], s12 offen sc1
    s_waitcnt vmcnt(0)
    v_max_u32 v6, v40, v80
    v_cmp_eq_u32 vcc, -1, v6
    s_nop 1
    s_cbranch_vccz L_pd98
    s_sleep 1
    s_sub_u32 s71, s71, 1
    s_cmp_lg_u32 s71, 0
    s_cbranch_scc1 L_p97
L_pd98:
    s_branch L_rb66
L_r67:
    s_mov_b32 s71, 20000
L_p99:
    buffer_load_dwordx4 v[44:47], v8, s[4:7], s13 offen sc1
    buffer_load_dwordx4 v[84:87], v9, s[4:7], s13 offen sc1
    s_waitcnt vmcnt(0)
    v_max_u32 v6, v44, v84
    v_cmp_eq_u32 vcc, -1, v6
    s_nop 1
    s_cbranch_vccz L_pd100
    s_sleep 1
    s_sub_u32 s71, s71, 1
    s_cmp_lg_u32 s71, 0
    s_cbranch_scc1 L_p99
L_pd100:
    s_branch L_rb68
L_r69:
    s_mov_b32 s71, 20000
L_p101:
    buffer_load_dwordx4 v[48:51], v8, s[4:7], s14 offen sc1
    buffer_load_dwordx4 v[88:91], v9, s[4:7], s14 offen sc1
    s_waitcnt vmcnt(0)
    v_max_u32 v6, v48, v88
    v_cmp_eq_u32 vcc, -1, v6
    s_nop 1
    s_cbranch_vccz L_pd102
    s_sleep 1
    s_sub_u32 s71, s71, 1
    s_cmp_lg_u32 s71, 0
    s_cbranch_scc1 L_p101
L_pd102:
    s_branch L_rb70
L_r71:
    s_mov_b32 s71, 20000
L_p103:
    buffer_load_dwordx4 v[52:55], v8, s[4:7], s15 offen sc1
    buffer_load_dwordx4 v[92:95], v9, s[4:7], s15 offen sc1
    s_waitcnt vmcnt(0)
    v_max_u32 v6, v52, v92
    v_cmp_eq_u32 vcc, -1, v6
    s_nop 1
    s_cbranch_vccz L_pd104
    s_sleep 1
    s_sub_u32 s71, s71, 1
    s_cmp_lg_u32 s71, 0
    s_cbranch_scc1 L_p103
L_pd104:
    s_branch L_rb72
L_r73:
    s_mov_b32 s71, 20000
L_p105:
    buffer_load_dwordx4 v[56:59], v8, s[4:7], s16 offen sc1
    buffer_load_dwordx4 v[96:99], v9, s[4:7], s16 offen sc1
    s_waitcnt vmcnt(0)
    v_max_u32 v6, v56, v96
    v_cmp_eq_u32 vcc, -1, v6
    s_nop 1
    s_cbranch_vccz L_pd106
    s_sleep 1
    s_sub_u32 s71, s71, 1
    s_cmp_lg_u32 s71, 0
    s_cbranch_scc1 L_p105
L_pd106:
    s_branch L_rb74
L_r75:
    s_mov_b32 s71, 20000
L_p107:
    buffer_load_dwordx4 v[60:63], v8, s[4:7], s17 offen sc1
    buffer_load_dwordx4 v[100:103], v9, s[4:7], s17 offen sc1
    s_waitcnt vmcnt(0)
    v_max_u32 v6, v60, v100
    v_cmp_eq_u32 vcc, -1, v6
    s_nop 1
    s_cbranch_vccz L_pd108
    s_sleep 1
    s_sub_u32 s71, s71, 1
    s_cmp_lg_u32 s71, 0
    s_cbranch_scc1 L_p107
L_pd108:
    s_branch L_rb76
L_r77:
    s_mov_b32 s71, 20000
L_p109:
    buffer_load_dwordx4 v[64:67], v8, s[4:7], s18 offen sc1
    buffer_load_dwordx4 v[104:107], v9, s[4:7], s18 offen sc1
    s_waitcnt vmcnt(0)
    v_max_u32 v6, v64, v104
    v_cmp_eq_u32 vcc, -1, v6
    s_nop 1
    s_cbranch_vccz L_pd110
    s_sleep 1
    s_sub_u32 s71, s71, 1
    s_cmp_lg_u32 s71, 0
    s_cbranch_scc1 L_p109
L_pd110:
    s_branch L_rb78
L_r79:
    s_mov_b32 s71, 20000
L_p111:
    buffer_load_dwordx4 v[68:71], v8, s[4:7], s19 offen sc1
    buffer_load_dwordx4 v[108:111], v9, s[4:7], s19 offen sc1
    s_waitcnt vmcnt(0)
    v_max_u32 v6, v68, v108
    v_cmp_eq_u32 vcc, -1, v6
    s_nop 1
    s_cbranch_vccz L_pd112
    s_sleep 1
    s_sub_u32 s71, s71, 1
    s_cmp_lg_u32 s71, 0
    s_cbranch_scc1 L_p111
L_pd112:
    s_branch L_rb80
L_r81:
    s_mov_b32 s71, 20000
L_p113:
    buffer_load_dwordx4 v[120:123], v10, s[4:7], s12 offen sc1
    s_waitcnt vmcnt(0)
    v_max_u32 v6, v120, v120
    v_cmp_eq_u32 vcc, -1, v6
    s_nop 1
    s_cbranch_vccz L_pd114
    s_sleep 1
    s_sub_u32 s71, s71, 1
    s_cmp_lg_u32 s71, 0
    s_cbranch_scc1 L_p113
L_pd114:
    s_branch L_rb82
L_r83:
    s_mov_b32 s71, 20000
L_p115:
    buffer_load_dwordx4 v[124:127], v10, s[4:7], s13 offen sc1
    s_waitcnt vmcnt(0)
    v_max_u32 v6, v124, v124
    v_cmp_eq_u32 vcc, -1, v6
    s_nop 1
    s_cbranch_vccz L_pd116
    s_sleep 1
    s_sub_u32 s71, s71, 1
    s_cmp_lg_u32 s71, 0
    s_cbranch_scc1 L_p115
L_pd116:
    s_branch L_rb84
L_r85:
    s_mov_b32 s71, 20000
L_p117:
    buffer_load_dwordx4 v[128:131], v10, s[4:7], s14 offen sc1
    s_waitcnt vmcnt(0)
    v_max_u32 v6, v128, v128
    v_cmp_eq_u32 vcc, -1, v6
    s_nop 1
    s_cbranch_vccz L_pd118
    s_sleep 1
    s_sub_u32 s71, s71, 1
    s_cmp_lg_u32 s71, 0
    s_cbranch_scc1 L_p117
L_pd118:
    s_branch L_rb86
L_r87:
    s_mov_b32 s71, 20000
L_p119:
    buffer_load_dwordx4 v[132:135], v10, s[4:7], s15 offen sc1
    s_waitcnt vmcnt(0)
    v_max_u32 v6, v132, v132
    v_cmp_eq_u32 vcc, -1, v6
    s_nop 1
    s_cbranch_vccz L_pd120
    s_sleep 1
    s_sub_u32 s71, s71, 1
    s_cmp_lg_u32 s71, 0
    s_cbranch_scc1 L_p119
L_pd120:
    s_branch L_rb88
L_r89:
    s_mov_b32 s71, 20000
L_p121:
    buffer_load_dwordx4 v[136:139], v10, s[4:7], s16 offen sc1
    s_waitcnt vmcnt(0)
    v_max_u32 v6, v136, v136
    v_cmp_eq_u32 vcc, -1, v6
    s_nop 1
    s_cbranch_vccz L_pd122
    s_sleep 1
    s_sub_u32 s71, s71, 1
    s_cmp_lg_u32 s71, 0
    s_cbranch_scc1 L_p121
L_pd122:
    s_branch L_rb90
L_r91:
    s_mov_b32 s71, 20000
L_p123:
    buffer_load_dwordx4 v[140:143], v10, s[4:7], s17 offen sc1
    s_waitcnt vmcnt(0)
    v_max_u32 v6, v140, v140
    v_cmp_eq_u32 vcc, -1, v6
    s_nop 1
    s_cbranch_vccz L_pd124
    s_sleep 1
    s_sub_u32 s71, s71, 1
    s_cmp_lg_u32 s71, 0
    s_cbranch_scc1 L_p123
L_pd124:
    s_branch L_rb92
L_r93:
    s_mov_b32 s71, 20000
L_p125:
    buffer_load_dwordx4 v[144:147], v10, s[4:7], s18 offen sc1
    s_waitcnt vmcnt(0)
    v_max_u32 v6, v144, v144
    v_cmp_eq_u32 vcc, -1, v6
    s_nop 1
    s_cbranch_vccz L_pd126
    s_sleep 1
    s_sub_u32 s71, s71, 1
    s_cmp_lg_u32 s71, 0
    s_cbranch_scc1 L_p125
L_pd126:
    s_branch L_rb94
L_r95:
    s_mov_b32 s71, 20000
L_p127:
    buffer_load_dwordx4 v[148:151], v10, s[4:7], s19 offen sc1
    s_waitcnt vmcnt(0)
    v_max_u32 v6, v148, v148
    v_cmp_eq_u32 vcc, -1, v6
    s_nop 1
    s_cbranch_vccz L_pd128
    s_sleep 1
    s_sub_u32 s71, s71, 1
    s_cmp_lg_u32 s71, 0
    s_cbranch_scc1 L_p127
L_pd128:
    s_branch L_rb96
L_g_v:
    s_sub_u32 s42, s60, 10
    s_lshl_b32 s42, s42, 7
    s_lshl_b32 s43, s41, 6
    s_add_u32 s42, s42, s43
    s_mul_i32 s48, s45, 1280
    s_add_u32 s48, s48, s44
    s_add_u32 s48, s48, 5253120
    s_mov_b32 s50, 163840
    v_mul_u32_u24 v48, 320, v61
    v_add_u32 v48, s48, v48
    s_add_u32 s43, s42, 0
    v_add_u32 v5, s43, v60
    v_mul_u32_u24 v6, 3277, v5
    v_lshrrev_b32 v6, 16, v6
    v_mul_u32_u24 v7, 20, v6
    v_sub_u32 v7, v5, v7
    v_lshl_add_u32 v7, v7, 4, v48
    v_mad_u32_u24 v96, v6, s50, v7
    s_add_u32 s43, s42, 16
    v_add_u32 v5, s43, v60
    v_mul_u32_u24 v6, 3277, v5
    v_lshrrev_b32 v6, 16, v6
    v_mul_u32_u24 v7, 20, v6
    v_sub_u32 v7, v5, v7
    v_lshl_add_u32 v7, v7, 4, v48
    v_mad_u32_u24 v97, v6, s50, v7
    s_add_u32 s43, s42, 32
    v_add_u32 v5, s43, v60
    v_mul_u32_u24 v6, 3277, v5
    v_lshrrev_b32 v6, 16, v6
    v_mul_u32_u24 v7, 20, v6
    v_sub_u32 v7, v5, v7
    v_lshl_add_u32 v7, v7, 4, v48
    v_mad_u32_u24 v98, v6, s50, v7
    s_add_u32 s43, s42, 48
    v_add_u32 v5, s43, v60
    v_mul_u32_u24 v6, 3277, v5
    v_lshrrev_b32 v6, 16, v6
    v_mul_u32_u24 v7, 20, v6
    v_sub_u32 v7, v5, v7
    v_lshl_add_u32 v7, v7, 4, v48
    v_mad_u32_u24 v99, v6, s50, v7
    v_lshrrev_b32 v5, 3, v60
    v_lshlrev_b32 v5, 4, v5
    v_and_b32 v6, 7, v60
    v_add_u32 v5, v5, v6
    v_bfe_u32 v6, v60, 1, 2
    v_lshrrev_b32 v7, 3, v60
    v_lshl_add_u32 v6, v7, 2, v6
    v_xor_b32 v6, v6, v61
    s_lshl_b32 s42, s40, 13
    v_lshlrev_b32 v5, 7, v5
    v_add_u32 v5, s42, v5
    v_lshl_add_u32 v52, v6, 4, v5
    v_xor_b32 v53, 64, v52
    v_subrev_u32 v54, 1536, v63
    s_lshl_b32 s42, s40, 8
    s_add_u32 s42, s42, 159744
    v_lshrrev_b32 v5, 1, v61
    v_lshlrev_b32 v5, 6, v5
    v_and_b32 v6, 1, v61
    v_lshl_add_u32 v5, v6, 4, v5
    v_add_u32 v55, s42, v5
    s_lshl_b32 s42, s40, 13
    v_lshlrev_b32 v5, 7, v60
    v_add_u32 v5, s42, v5
    v_bfe_u32 v6, v60, 1, 2
    v_xor_b32 v6, v6, v61
    v_lshl_add_u32 v48, v6, 4, v5
    v_xor_b32 v49, 64, v48
    v_mov_b32 v50, v49
    v_mov_b32 v51, v48
    s_waitcnt vmcnt(0)
    s_barrier
    ds_read_b64_tr_b16 v[32:33], v10 offset:0
    ds_read_b64_tr_b16 v[34:35], v10 offset:1024
    ds_read_b128 v[16:19], v52 offset:0
    ds_read_b128 v[20:23], v52 offset:1024
    ds_read_b128 v[24:27], v52 offset:4096
    ds_read_b128 v[28:31], v52 offset:5120
    ds_read_b64_tr_b16 v[36:37], v11 offset:0
    ds_read_b64_tr_b16 v[38:39], v11 offset:1024
    ds_read_b64_tr_b16 v[40:41], v12 offset:0
    ds_read_b64_tr_b16 v[42:43], v12 offset:1024
    ds_read_b64_tr_b16 v[44:45], v13 offset:0
    ds_read_b64_tr_b16 v[46:47], v13 offset:1024
    v_mov_b32 v56, 0x3f803f80
    v_mov_b32 v57, 0x3f803f80
    v_mov_b32 v58, 0x3f803f80
    v_mov_b32 v59, 0x3f803f80
    s_waitcnt lgkmcnt(6)
    v_mfma_f32_16x16x32_bf16 v[128:131], v[16:19], v[32:35], 0
    ds_read_b64_tr_b16 v[240:241], v10 offset:8192
    v_mfma_f32_16x16x32_bf16 v[144:147], v[20:23], v[32:35], 0
    ds_read_b64_tr_b16 v[242:243], v10 offset:9216
    v_mfma_f32_16x16x32_bf16 v[160:163], v[24:27], v[32:35], 0
    ds_read_b128 v[224:227], v53 offset:0
    v_mfma_f32_16x16x32_bf16 v[176:179], v[28:31], v[32:35], 0
    ds_read_b128 v[228:231], v53 offset:1024
    s_waitcnt lgkmcnt(8)
    v_mfma_f32_16x16x32_bf16 v[180:183], v[28:31], v[36:39], 0
    ds_read_b128 v[232:235], v53 offset:4096
    v_mfma_f32_16x16x32_bf16 v[164:167], v[24:27], v[36:39], 0
    ds_read_b128 v[236:239], v53 offset:5120
    v_mfma_f32_16x16x32_bf16 v[148:151], v[20:23], v[36:39], 0
    ds_read_b64_tr_b16 v[244:245], v11 offset:8192
    v_mfma_f32_16x16x32_bf16 v[132:135], v[16:19], v[36:39], 0
    ds_read_b64_tr_b16 v[246:247], v11 offset:9216
    s_waitcnt lgkmcnt(10)
    v_mfma_f32_16x16x32_bf16 v[136:139], v[16:19], v[40:43], 0
    ds_read_b64_tr_b16 v[248:249], v12 offset:8192
    v_mfma_f32_16x16x32_bf16 v[152:155], v[20:23], v[40:43], 0
    ds_read_b64_tr_b16 v[250:251], v12 offset:9216
    v_mfma_f32_16x16x32_bf16 v[168:171], v[24:27], v[40:43], 0
    ds_read_b64_tr_b16 v[252:253], v13 offset:8192
    v_mfma_f32_16x16x32_bf16 v[184:187], v[28:31], v[40:43], 0
    ds_read_b64_tr_b16 v[254:255], v13 offset:9216
    s_waitcnt lgkmcnt(12)
    v_mfma_f32_16x16x32_bf16 v[188:191], v[28:31], v[44:47], 0
    v_mfma_f32_16x16x32_bf16 v[172:175], v[24:27], v[44:47], 0
    v_mfma_f32_16x16x32_bf16 v[156:159], v[20:23], v[44:47], 0
    v_mfma_f32_16x16x32_bf16 v[140:143], v[16:19], v[44:47], 0
    v_mfma_f32_16x16x32_bf16 v[112:115], v[56:59], v[32:35], 0
    v_mfma_f32_16x16x32_bf16 v[116:119], v[56:59], v[36:39], 0
    v_mfma_f32_16x16x32_bf16 v[120:123], v[56:59], v[40:43], 0
    v_mfma_f32_16x16x32_bf16 v[124:127], v[56:59], v[44:47], 0
    s_waitcnt lgkmcnt(6)
    v_mfma_f32_16x16x32_bf16 v[128:131], v[224:227], v[240:243], v[128:131]
    v_mfma_f32_16x16x32_bf16 v[144:147], v[228:231], v[240:243], v[144:147]
    v_mfma_f32_16x16x32_bf16 v[160:163], v[232:235], v[240:243], v[160:163]
    s_waitcnt lgkmcnt(0)
    s_barrier
    v_mfma_f32_16x16x32_bf16 v[176:179], v[236:239], v[240:243], v[176:179]
    ds_read_b64_tr_b16 v[32:33], v10 offset:16384
    v_mfma_f32_16x16x32_bf16 v[180:183], v[236:239], v[244:247], v[180:183]
    ds_read_b64_tr_b16 v[34:35], v10 offset:17408
    v_mfma_f32_16x16x32_bf16 v[164:167], v[232:235], v[244:247], v[164:167]
    ds_read_b128 v[16:19], v52 offset:16384
    v_mfma_f32_16x16x32_bf16 v[148:151], v[228:231], v[244:247], v[148:151]
    ds_read_b128 v[20:23], v52 offset:17408
    v_mfma_f32_16x16x32_bf16 v[132:135], v[224:227], v[244:247], v[132:135]
    ds_read_b128 v[24:27], v52 offset:20480
    v_mfma_f32_16x16x32_bf16 v[136:139], v[224:227], v[248:251], v[136:139]
    ds_read_b128 v[28:31], v52 offset:21504
    v_mfma_f32_16x16x32_bf16 v[152:155], v[228:231], v[248:251], v[152:155]
    ds_read_b64_tr_b16 v[36:37], v11 offset:16384
    v_mfma_f32_16x16x32_bf16 v[168:171], v[232:235], v[248:251], v[168:171]
    ds_read_b64_tr_b16 v[38:39], v11 offset:17408
    v_mfma_f32_16x16x32_bf16 v[184:187], v[236:239], v[248:251], v[184:187]
    ds_read_b64_tr_b16 v[40:41], v12 offset:16384
    v_mfma_f32_16x16x32_bf16 v[188:191], v[236:239], v[252:255], v[188:191]
    ds_read_b64_tr_b16 v[42:43], v12 offset:17408
    v_mfma_f32_16x16x32_bf16 v[172:175], v[232:235], v[252:255], v[172:175]
    ds_read_b64_tr_b16 v[44:45], v13 offset:16384
    v_mfma_f32_16x16x32_bf16 v[156:159], v[228:231], v[252:255], v[156:159]
    ds_read_b64_tr_b16 v[46:47], v13 offset:17408
    v_mfma_f32_16x16x32_bf16 v[140:143], v[224:227], v[252:255], v[140:143]
    v_mfma_f32_16x16x32_bf16 v[112:115], v[56:59], v[240:243], v[112:115]
    v_mfma_f32_16x16x32_bf16 v[116:119], v[56:59], v[244:247], v[116:119]
    v_mfma_f32_16x16x32_bf16 v[120:123], v[56:59], v[248:251], v[120:123]
    v_mfma_f32_16x16x32_bf16 v[124:127], v[56:59], v[252:255], v[124:127]
    s_waitcnt lgkmcnt(0)
    v_mfma_f32_16x16x32_bf16 v[128:131], v[16:19], v[32:35], v[128:131]
    ds_read_b64_tr_b16 v[240:241], v10 offset:24576
    v_mfma_f32_16x16x32_bf16 v[144:147], v[20:23], v[32:35], v[144:147]
    ds_read_b64_tr_b16 v[242:243], v10 offset:25600
    v_mfma_f32_16x16x32_bf16 v[160:163], v[24:27], v[32:35], v[160:163]
    ds_read_b128 v[224:227], v53 offset:16384
    v_mfma_f32_16x16x32_bf16 v[176:179], v[28:31], v[32:35], v[176:179]
    ds_read_b128 v[228:231], v53 offset:17408
    v_mfma_f32_16x16x32_bf16 v[180:183], v[28:31], v[36:39], v[180:183]
    ds_read_b128 v[232:235], v53 offset:20480
    v_mfma_f32_16x16x32_bf16 v[164:167], v[24:27], v[36:39], v[164:167]
    ds_read_b128 v[236:239], v53 offset:21504
    v_mfma_f32_16x16x32_bf16 v[148:151], v[20:23], v[36:39], v[148:151]
    ds_read_b64_tr_b16 v[244:245], v11 offset:24576
    v_mfma_f32_16x16x32_bf16 v[132:135], v[16:19], v[36:39], v[132:135]
    ds_read_b64_tr_b16 v[246:247], v11 offset:25600
    v_mfma_f32_16x16x32_bf16 v[136:139], v[16:19], v[40:43], v[136:139]
    ds_read_b64_tr_b16 v[248:249], v12 offset:24576
    v_mfma_f32_16x16x32_bf16 v[152:155], v[20:23], v[40:43], v[152:155]
    ds_read_b64_tr_b16 v[250:251], v12 offset:25600
    v_mfma_f32_16x16x32_bf16 v[168:171], v[24:27], v[40:43], v[168:171]
    ds_read_b64_tr_b16 v[252:253], v13 offset:24576
    v_mfma_f32_16x16x32_bf16 v[184:187], v[28:31], v[40:43], v[184:187]
    ds_read_b64_tr_b16 v[254:255], v13 offset:25600
    v_mfma_f32_16x16x32_bf16 v[188:191], v[28:31], v[44:47], v[188:191]
    ds_write_b32 v63, v112 offset:0
    v_mfma_f32_16x16x32_bf16 v[172:175], v[24:27], v[44:47], v[172:175]
    ds_write_b32 v63, v116 offset:64
    v_mfma_f32_16x16x32_bf16 v[156:159], v[20:23], v[44:47], v[156:159]
    ds_write_b32 v63, v120 offset:128
    v_mfma_f32_16x16x32_bf16 v[140:143], v[16:19], v[44:47], v[140:143]
    ds_write_b32 v63, v124 offset:192
    s_waitcnt lgkmcnt(6)
    v_mfma_f32_16x16x32_bf16 v[128:131], v[224:227], v[240:243], v[128:131]
    v_mfma_f32_16x16x32_bf16 v[144:147], v[228:231], v[240:243], v[144:147]
    v_mfma_f32_16x16x32_bf16 v[160:163], v[232:235], v[240:243], v[160:163]
    s_waitcnt lgkmcnt(0)
    s_barrier
    v_mfma_f32_16x16x32_bf16 v[176:179], v[236:239], v[240:243], v[176:179]
    ds_read_b64_tr_b16 v[32:33], v10 offset:32768
    v_mfma_f32_16x16x32_bf16 v[180:183], v[236:239], v[244:247], v[180:183]
    ds_read_b64_tr_b16 v[34:35], v10 offset:33792
    v_mfma_f32_16x16x32_bf16 v[164:167], v[232:235], v[244:247], v[164:167]
    ds_read_b128 v[16:19], v52 offset:32768
    v_mfma_f32_16x16x32_bf16 v[148:151], v[228:231], v[244:247], v[148:151]
    ds_read_b128 v[20:23], v52 offset:33792
    v_mfma_f32_16x16x32_bf16 v[132:135], v[224:227], v[244:247], v[132:135]
    ds_read_b128 v[24:27], v52 offset:36864
    v_mfma_f32_16x16x32_bf16 v[136:139], v[224:227], v[248:251], v[136:139]
    ds_read_b128 v[28:31], v52 offset:37888
    v_mfma_f32_16x16x32_bf16 v[152:155], v[228:231], v[248:251], v[152:155]
    ds_read_b64_tr_b16 v[36:37], v11 offset:32768
    v_mfma_f32_16x16x32_bf16 v[168:171], v[232:235], v[248:251], v[168:171]
    ds_read_b64_tr_b16 v[38:39], v11 offset:33792
    v_mfma_f32_16x16x32_bf16 v[184:187], v[236:239], v[248:251], v[184:187]
    ds_read_b64_tr_b16 v[40:41], v12 offset:32768
    v_mfma_f32_16x16x32_bf16 v[188:191], v[236:239], v[252:255], v[188:191]
    ds_read_b64_tr_b16 v[42:43], v12 offset:33792
    v_mfma_f32_16x16x32_bf16 v[172:175], v[232:235], v[252:255], v[172:175]
    ds_read_b64_tr_b16 v[44:45], v13 offset:32768
    v_mfma_f32_16x16x32_bf16 v[156:159], v[228:231], v[252:255], v[156:159]
    ds_read_b64_tr_b16 v[46:47], v13 offset:33792
    v_mfma_f32_16x16x32_bf16 v[140:143], v[224:227], v[252:255], v[140:143]
    s_waitcnt lgkmcnt(6)
    v_mfma_f32_16x16x32_bf16 v[128:131], v[16:19], v[32:35], v[128:131]
    ds_read_b64_tr_b16 v[240:241], v10 offset:40960
    v_mfma_f32_16x16x32_bf16 v[144:147], v[20:23], v[32:35], v[144:147]
    ds_read_b64_tr_b16 v[242:243], v10 offset:41984
    v_mfma_f32_16x16x32_bf16 v[160:163], v[24:27], v[32:35], v[160:163]
    ds_read_b128 v[224:227], v53 offset:32768
    v_mfma_f32_16x16x32_bf16 v[176:179], v[28:31], v[32:35], v[176:179]
    ds_read_b128 v[228:231], v53 offset:33792
    s_waitcnt lgkmcnt(8)
    v_mfma_f32_16x16x32_bf16 v[180:183], v[28:31], v[36:39], v[180:183]
    ds_read_b128 v[232:235], v53 offset:36864
    v_mfma_f32_16x16x32_bf16 v[164:167], v[24:27], v[36:39], v[164:167]
    ds_read_b128 v[236:239], v53 offset:37888
    v_mfma_f32_16x16x32_bf16 v[148:151], v[20:23], v[36:39], v[148:151]
    ds_read_b64_tr_b16 v[244:245], v11 offset:40960
    v_mfma_f32_16x16x32_bf16 v[132:135], v[16:19], v[36:39], v[132:135]
    ds_read_b64_tr_b16 v[246:247], v11 offset:41984
    s_waitcnt lgkmcnt(10)
    v_mfma_f32_16x16x32_bf16 v[136:139], v[16:19], v[40:43], v[136:139]
    ds_read_b64_tr_b16 v[248:249], v12 offset:40960
    v_mfma_f32_16x16x32_bf16 v[152:155], v[20:23], v[40:43], v[152:155]
    ds_read_b64_tr_b16 v[250:251], v12 offset:41984
    v_mfma_f32_16x16x32_bf16 v[168:171], v[24:27], v[40:43], v[168:171]
    ds_read_b64_tr_b16 v[252:253], v13 offset:40960
    v_mfma_f32_16x16x32_bf16 v[184:187], v[28:31], v[40:43], v[184:187]
    ds_read_b64_tr_b16 v[254:255], v13 offset:41984
    s_waitcnt lgkmcnt(12)
    v_mfma_f32_16x16x32_bf16 v[188:191], v[28:31], v[44:47], v[188:191]
    v_mfma_f32_16x16x32_bf16 v[172:175], v[24:27], v[44:47], v[172:175]
    v_mfma_f32_16x16x32_bf16 v[156:159], v[20:23], v[44:47], v[156:159]
    v_mfma_f32_16x16x32_bf16 v[140:143], v[16:19], v[44:47], v[140:143]
    s_waitcnt lgkmcnt(6)
    v_mfma_f32_16x16x32_bf16 v[128:131], v[224:227], v[240:243], v[128:131]
    v_mfma_f32_16x16x32_bf16 v[144:147], v[228:231], v[240:243], v[144:147]
    v_mfma_f32_16x16x32_bf16 v[160:163], v[232:235], v[240:243], v[160:163]
    s_waitcnt lgkmcnt(0)
    s_barrier
    v_mfma_f32_16x16x32_bf16 v[176:179], v[236:239], v[240:243], v[176:179]
    ds_read_b64_tr_b16 v[32:33], v10 offset:49152
    v_mfma_f32_16x16x32_bf16 v[180:183], v[236:239], v[244:247], v[180:183]
    ds_read_b64_tr_b16 v[34:35], v10 offset:50176
    v_mfma_f32_16x16x32_bf16 v[164:167], v[232:235], v[244:247], v[164:167]
    ds_read_b128 v[16:19], v52 offset:49152
    v_mfma_f32_16x16x32_bf16 v[148:151], v[228:231], v[244:247], v[148:151]
    ds_read_b128 v[20:23], v52 offset:50176
    v_mfma_f32_16x16x32_bf16 v[132:135], v[224:227], v[244:247], v[132:135]
    ds_read_b128 v[24:27], v52 offset:53248
    v_mfma_f32_16x16x32_bf16 v[136:139], v[224:227], v[248:251], v[136:139]
    ds_read_b128 v[28:31], v52 offset:54272
    v_mfma_f32_16x16x32_bf16 v[152:155], v[228:231], v[248:251], v[152:155]
    ds_read_b64_tr_b16 v[36:37], v11 offset:49152
    v_mfma_f32_16x16x32_bf16 v[168:171], v[232:235], v[248:251], v[168:171]
    ds_read_b64_tr_b16 v[38:39], v11 offset:50176
    v_mfma_f32_16x16x32_bf16 v[184:187], v[236:239], v[248:251], v[184:187]
    ds_read_b64_tr_b16 v[40:41], v12 offset:49152
    v_mfma_f32_16x16x32_bf16 v[188:191], v[236:239], v[252:255], v[188:191]
    ds_read_b64_tr_b16 v[42:43], v12 offset:50176
    v_mfma_f32_16x16x32_bf16 v[172:175], v[232:235], v[252:255], v[172:175]
    ds_read_b64_tr_b16 v[44:45], v13 offset:49152
    v_mfma_f32_16x16x32_bf16 v[156:159], v[228:231], v[252:255], v[156:159]
    ds_read_b64_tr_b16 v[46:47], v13 offset:50176
    v_mfma_f32_16x16x32_bf16 v[140:143], v[224:227], v[252:255], v[140:143]
    s_waitcnt lgkmcnt(6)
    v_mfma_f32_16x16x32_bf16 v[128:131], v[16:19], v[32:35], v[128:131]
    ds_read_b64_tr_b16 v[240:241], v10 offset:57344
    v_mfma_f32_16x16x32_bf16 v[144:147], v[20:23], v[32:35], v[144:147]
    ds_read_b64_tr_b16 v[242:243], v10 offset:58368
    v_mfma_f32_16x16x32_bf16 v[160:163], v[24:27], v[32:35], v[160:163]
    ds_read_b128 v[224:227], v53 offset:49152
    v_mfma_f32_16x16x32_bf16 v[176:179], v[28:31], v[32:35], v[176:179]
    ds_read_b128 v[228:231], v53 offset:50176
    s_waitcnt lgkmcnt(8)
    v_mfma_f32_16x16x32_bf16 v[180:183], v[28:31], v[36:39], v[180:183]
    ds_read_b128 v[232:235], v53 offset:53248
    v_mfma_f32_16x16x32_bf16 v[164:167], v[24:27], v[36:39], v[164:167]
    ds_read_b128 v[236:239], v53 offset:54272
    v_mfma_f32_16x16x32_bf16 v[148:151], v[20:23], v[36:39], v[148:151]
    ds_read_b64_tr_b16 v[244:245], v11 offset:57344
    v_mfma_f32_16x16x32_bf16 v[132:135], v[16:19], v[36:39], v[132:135]
    ds_read_b64_tr_b16 v[246:247], v11 offset:58368
    s_waitcnt lgkmcnt(10)
    v_mfma_f32_16x16x32_bf16 v[136:139], v[16:19], v[40:43], v[136:139]
    ds_read_b64_tr_b16 v[248:249], v12 offset:57344
    v_mfma_f32_16x16x32_bf16 v[152:155], v[20:23], v[40:43], v[152:155]
    ds_read_b64_tr_b16 v[250:251], v12 offset:58368
    v_mfma_f32_16x16x32_bf16 v[168:171], v[24:27], v[40:43], v[168:171]
    ds_read_b64_tr_b16 v[252:253], v13 offset:57344
    v_mfma_f32_16x16x32_bf16 v[184:187], v[28:31], v[40:43], v[184:187]
    ds_read_b64_tr_b16 v[254:255], v13 offset:58368
    s_waitcnt lgkmcnt(12)
    v_mfma_f32_16x16x32_bf16 v[188:191], v[28:31], v[44:47], v[188:191]
    v_mfma_f32_16x16x32_bf16 v[172:175], v[24:27], v[44:47], v[172:175]
    v_mfma_f32_16x16x32_bf16 v[156:159], v[20:23], v[44:47], v[156:159]
    v_mfma_f32_16x16x32_bf16 v[140:143], v[16:19], v[44:47], v[140:143]
    s_waitcnt lgkmcnt(6)
    v_mfma_f32_16x16x32_bf16 v[128:131], v[224:227], v[240:243], v[128:131]
    v_mfma_f32_16x16x32_bf16 v[144:147], v[228:231], v[240:243], v[144:147]
    v_mfma_f32_16x16x32_bf16 v[160:163], v[232:235], v[240:243], v[160:163]
    s_waitcnt lgkmcnt(0)
    s_barrier
    v_mfma_f32_16x16x32_bf16 v[176:179], v[236:239], v[240:243], v[176:179]
    ds_read_b64_tr_b16 v[32:33], v10 offset:0
    v_mfma_f32_16x16x32_bf16 v[180:183], v[236:239], v[244:247], v[180:183]
    ds_read_b64_tr_b16 v[34:35], v10 offset:1024
    v_mfma_f32_16x16x32_bf16 v[164:167], v[232:235], v[244:247], v[164:167]
    ds_read_b128 v[16:19], v52 offset:0
    v_mfma_f32_16x16x32_bf16 v[148:151], v[228:231], v[244:247], v[148:151]
    ds_read_b128 v[20:23], v52 offset:1024
    v_mfma_f32_16x16x32_bf16 v[132:135], v[224:227], v[244:247], v[132:135]
    ds_read_b128 v[24:27], v52 offset:4096
    v_mfma_f32_16x16x32_bf16 v[136:139], v[224:227], v[248:251], v[136:139]
    ds_read_b128 v[28:31], v52 offset:5120
    v_mfma_f32_16x16x32_bf16 v[152:155], v[228:231], v[248:251], v[152:155]
    ds_read_b64_tr_b16 v[36:37], v11 offset:0
    v_mfma_f32_16x16x32_bf16 v[168:171], v[232:235], v[248:251], v[168:171]
    ds_read_b64_tr_b16 v[38:39], v11 offset:1024
    v_mfma_f32_16x16x32_bf16 v[184:187], v[236:239], v[248:251], v[184:187]
    ds_read_b64_tr_b16 v[40:41], v12 offset:0
    v_mfma_f32_16x16x32_bf16 v[188:191], v[236:239], v[252:255], v[188:191]
    ds_read_b64_tr_b16 v[42:43], v12 offset:1024
    v_mfma_f32_16x16x32_bf16 v[172:175], v[232:235], v[252:255], v[172:175]
    ds_read_b64_tr_b16 v[44:45], v13 offset:0
    v_mfma_f32_16x16x32_bf16 v[156:159], v[228:231], v[252:255], v[156:159]
    ds_read_b64_tr_b16 v[46:47], v13 offset:1024
    v_mfma_f32_16x16x32_bf16 v[140:143], v[224:227], v[252:255], v[140:143]
    s_waitcnt lgkmcnt(6)
    v_mfma_f32_16x16x32_bf16 v[128:131], v[16:19], v[32:35], v[128:131]
    ds_read_b64_tr_b16 v[240:241], v10 offset:8192
    v_mfma_f32_16x16x32_bf16 v[144:147], v[20:23], v[32:35], v[144:147]
    ds_read_b64_tr_b16 v[242:243], v10 offset:9216
    v_mfma_f32_16x16x32_bf16 v[160:163], v[24:27], v[32:35], v[160:163]
    ds_read_b128 v[224:227], v53 offset:0
    v_mfma_f32_16x16x32_bf16 v[176:179], v[28:31], v[32:35], v[176:179]
    ds_read_b128 v[228:231], v53 offset:1024
    s_waitcnt lgkmcnt(8)
    v_mfma_f32_16x16x32_bf16 v[180:183], v[28:31], v[36:39], v[180:183]
    ds_read_b128 v[232:235], v53 offset:4096
    v_mfma_f32_16x16x32_bf16 v[164:167], v[24:27], v[36:39], v[164:167]
    ds_read_b128 v[236:239], v53 offset:5120
    v_mfma_f32_16x16x32_bf16 v[148:151], v[20:23], v[36:39], v[148:151]
    ds_read_b64_tr_b16 v[244:245], v11 offset:8192
    v_mfma_f32_16x16x32_bf16 v[132:135], v[16:19], v[36:39], v[132:135]
    ds_read_b64_tr_b16 v[246:247], v11 offset:9216
    s_waitcnt lgkmcnt(10)
    v_mfma_f32_16x16x32_bf16 v[136:139], v[16:19], v[40:43], v[136:139]
    ds_read_b64_tr_b16 v[248:249], v12 offset:8192
    v_mfma_f32_16x16x32_bf16 v[152:155], v[20:23], v[40:43], v[152:155]
    ds_read_b64_tr_b16 v[250:251], v12 offset:9216
    v_mfma_f32_16x16x32_bf16 v[168:171], v[24:27], v[40:43], v[168:171]
    ds_read_b64_tr_b16 v[252:253], v13 offset:8192
    v_mfma_f32_16x16x32_bf16 v[184:187], v[28:31], v[40:43], v[184:187]
    ds_read_b64_tr_b16 v[254:255], v13 offset:9216
    s_waitcnt lgkmcnt(12)
    v_mfma_f32_16x16x32_bf16 v[188:191], v[28:31], v[44:47], v[188:191]
    v_mfma_f32_16x16x32_bf16 v[172:175], v[24:27], v[44:47], v[172:175]
    v_mfma_f32_16x16x32_bf16 v[156:159], v[20:23], v[44:47], v[156:159]
    v_mfma_f32_16x16x32_bf16 v[140:143], v[16:19], v[44:47], v[140:143]
    s_waitcnt lgkmcnt(6)
    v_mfma_f32_16x16x32_bf16 v[128:131], v[224:227], v[240:243], v[128:131]
    v_mfma_f32_16x16x32_bf16 v[144:147], v[228:231], v[240:243], v[144:147]
    v_mfma_f32_16x16x32_bf16 v[160:163], v[232:235], v[240:243], v[160:163]
    s_waitcnt lgkmcnt(0)
    s_barrier
    v_mfma_f32_16x16x32_bf16 v[176:179], v[236:239], v[240:243], v[176:179]
    ds_read_b64_tr_b16 v[32:33], v10 offset:16384
    v_mfma_f32_16x16x32_bf16 v[180:183], v[236:239], v[244:247], v[180:183]
    ds_read_b64_tr_b16 v[34:35], v10 offset:17408
    v_mfma_f32_16x16x32_bf16 v[164:167], v[232:235], v[244:247], v[164:167]
    ds_read_b128 v[16:19], v52 offset:16384
    v_mfma_f32_16x16x32_bf16 v[148:151], v[228:231], v[244:247], v[148:151]
    ds_read_b128 v[20:23], v52 offset:17408
    v_mfma_f32_16x16x32_bf16 v[132:135], v[224:227], v[244:247], v[132:135]
    ds_read_b128 v[24:27], v52 offset:20480
    v_mfma_f32_16x16x32_bf16 v[136:139], v[224:227], v[248:251], v[136:139]
    ds_read_b128 v[28:31], v52 offset:21504
    v_mfma_f32_16x16x32_bf16 v[152:155], v[228:231], v[248:251], v[152:155]
    ds_read_b64_tr_b16 v[36:37], v11 offset:16384
    v_mfma_f32_16x16x32_bf16 v[168:171], v[232:235], v[248:251], v[168:171]
    ds_read_b64_tr_b16 v[38:39], v11 offset:17408
    v_mfma_f32_16x16x32_bf16 v[184:187], v[236:239], v[248:251], v[184:187]
    ds_read_b64_tr_b16 v[40:41], v12 offset:16384
    v_mfma_f32_16x16x32_bf16 v[188:191], v[236:239], v[252:255], v[188:191]
    ds_read_b64_tr_b16 v[42:43], v12 offset:17408
    v_mfma_f32_16x16x32_bf16 v[172:175], v[232:235], v[252:255], v[172:175]
    ds_read_b64_tr_b16 v[44:45], v13 offset:16384
    v_mfma_f32_16x16x32_bf16 v[156:159], v[228:231], v[252:255], v[156:159]
    ds_read_b64_tr_b16 v[46:47], v13 offset:17408
    v_mfma_f32_16x16x32_bf16 v[140:143], v[224:227], v[252:255], v[140:143]
    s_waitcnt lgkmcnt(6)
    v_mfma_f32_16x16x32_bf16 v[128:131], v[16:19], v[32:35], v[128:131]
    ds_read_b64_tr_b16 v[240:241], v10 offset:24576
    v_mfma_f32_16x16x32_bf16 v[144:147], v[20:23], v[32:35], v[144:147]
    ds_read_b64_tr_b16 v[242:243], v10 offset:25600
    v_mfma_f32_16x16x32_bf16 v[160:163], v[24:27], v[32:35], v[160:163]
    ds_read_b128 v[224:227], v53 offset:16384
    v_mfma_f32_16x16x32_bf16 v[176:179], v[28:31], v[32:35], v[176:179]
    ds_read_b128 v[228:231], v53 offset:17408
    s_waitcnt lgkmcnt(8)
    v_mfma_f32_16x16x32_bf16 v[180:183], v[28:31], v[36:39], v[180:183]
    ds_read_b128 v[232:235], v53 offset:20480
    v_mfma_f32_16x16x32_bf16 v[164:167], v[24:27], v[36:39], v[164:167]
    ds_read_b128 v[236:239], v53 offset:21504
    v_mfma_f32_16x16x32_bf16 v[148:151], v[20:23], v[36:39], v[148:151]
    ds_read_b64_tr_b16 v[244:245], v11 offset:24576
    v_mfma_f32_16x16x32_bf16 v[132:135], v[16:19], v[36:39], v[132:135]
    ds_read_b64_tr_b16 v[246:247], v11 offset:25600
    s_waitcnt lgkmcnt(10)
    v_mfma_f32_16x16x32_bf16 v[136:139], v[16:19], v[40:43], v[136:139]
    ds_read_b64_tr_b16 v[248:249], v12 offset:24576
    v_mfma_f32_16x16x32_bf16 v[152:155], v[20:23], v[40:43], v[152:155]
    ds_read_b64_tr_b16 v[250:251], v12 offset:25600
    v_mfma_f32_16x16x32_bf16 v[168:171], v[24:27], v[40:43], v[168:171]
    ds_read_b64_tr_b16 v[252:253], v13 offset:24576
    v_mfma_f32_16x16x32_bf16 v[184:187], v[28:31], v[40:43], v[184:187]
    ds_read_b64_tr_b16 v[254:255], v13 offset:25600
    s_waitcnt lgkmcnt(12)
    v_mfma_f32_16x16x32_bf16 v[188:191], v[28:31], v[44:47], v[188:191]
    v_mfma_f32_16x16x32_bf16 v[172:175], v[24:27], v[44:47], v[172:175]
    v_mfma_f32_16x16x32_bf16 v[156:159], v[20:23], v[44:47], v[156:159]
    v_mfma_f32_16x16x32_bf16 v[140:143], v[16:19], v[44:47], v[140:143]
    s_waitcnt lgkmcnt(6)
    v_mfma_f32_16x16x32_bf16 v[128:131], v[224:227], v[240:243], v[128:131]
    v_mfma_f32_16x16x32_bf16 v[144:147], v[228:231], v[240:243], v[144:147]
    v_mfma_f32_16x16x32_bf16 v[160:163], v[232:235], v[240:243], v[160:163]
    s_waitcnt lgkmcnt(0)
    s_barrier
    v_mfma_f32_16x16x32_bf16 v[176:179], v[236:239], v[240:243], v[176:179]
    ds_read_b64_tr_b16 v[32:33], v10 offset:32768
    v_mfma_f32_16x16x32_bf16 v[180:183], v[236:239], v[244:247], v[180:183]
    ds_read_b64_tr_b16 v[34:35], v10 offset:33792
    v_mfma_f32_16x16x32_bf16 v[164:167], v[232:235], v[244:247], v[164:167]
    ds_read_b128 v[16:19], v52 offset:32768
    v_mfma_f32_16x16x32_bf16 v[148:151], v[228:231], v[244:247], v[148:151]
    ds_read_b128 v[20:23], v52 offset:33792
    v_mfma_f32_16x16x32_bf16 v[132:135], v[224:227], v[244:247], v[132:135]
    ds_read_b128 v[24:27], v52 offset:36864
    v_mfma_f32_16x16x32_bf16 v[136:139], v[224:227], v[248:251], v[136:139]
    ds_read_b128 v[28:31], v52 offset:37888
    v_mfma_f32_16x16x32_bf16 v[152:155], v[228:231], v[248:251], v[152:155]
    ds_read_b64_tr_b16 v[36:37], v11 offset:32768
    v_mfma_f32_16x16x32_bf16 v[168:171], v[232:235], v[248:251], v[168:171]
    ds_read_b64_tr_b16 v[38:39], v11 offset:33792
    v_mfma_f32_16x16x32_bf16 v[184:187], v[236:239], v[248:251], v[184:187]
    ds_read_b64_tr_b16 v[40:41], v12 offset:32768
    v_mfma_f32_16x16x32_bf16 v[188:191], v[236:239], v[252:255], v[188:191]
    ds_read_b64_tr_b16 v[42:43], v12 offset:33792
    v_mfma_f32_16x16x32_bf16 v[172:175], v[232:235], v[252:255], v[172:175]
    ds_read_b64_tr_b16 v[44:45], v13 offset:32768
    v_mfma_f32_16x16x32_bf16 v[156:159], v[228:231], v[252:255], v[156:159]
    ds_read_b64_tr_b16 v[46:47], v13 offset:33792
    v_mfma_f32_16x16x32_bf16 v[140:143], v[224:227], v[252:255], v[140:143]
    s_waitcnt lgkmcnt(6)
    v_mfma_f32_16x16x32_bf16 v[128:131], v[16:19], v[32:35], v[128:131]
    ds_read_b64_tr_b16 v[240:241], v10 offset:40960
    v_mfma_f32_16x16x32_bf16 v[144:147], v[20:23], v[32:35], v[144:147]
    ds_read_b64_tr_b16 v[242:243], v10 offset:41984
    v_mfma_f32_16x16x32_bf16 v[160:163], v[24:27], v[32:35], v[160:163]
    ds_read_b128 v[224:227], v53 offset:32768
    v_mfma_f32_16x16x32_bf16 v[176:179], v[28:31], v[32:35], v[176:179]
    ds_read_b128 v[228:231], v53 offset:33792
    s_waitcnt lgkmcnt(8)
    v_mfma_f32_16x16x32_bf16 v[180:183], v[28:31], v[36:39], v[180:183]
    ds_read_b128 v[232:235], v53 offset:36864
    v_mfma_f32_16x16x32_bf16 v[164:167], v[24:27], v[36:39], v[164:167]
    ds_read_b128 v[236:239], v53 offset:37888
    v_mfma_f32_16x16x32_bf16 v[148:151], v[20:23], v[36:39], v[148:151]
    ds_read_b64_tr_b16 v[244:245], v11 offset:40960
    v_mfma_f32_16x16x32_bf16 v[132:135], v[16:19], v[36:39], v[132:135]
    ds_read_b64_tr_b16 v[246:247], v11 offset:41984
    s_waitcnt lgkmcnt(10)
    v_mfma_f32_16x16x32_bf16 v[136:139], v[16:19], v[40:43], v[136:139]
    ds_read_b64_tr_b16 v[248:249], v12 offset:40960
    v_mfma_f32_16x16x32_bf16 v[152:155], v[20:23], v[40:43], v[152:155]
    ds_read_b64_tr_b16 v[250:251], v12 offset:41984
    v_mfma_f32_16x16x32_bf16 v[168:171], v[24:27], v[40:43], v[168:171]
    ds_read_b64_tr_b16 v[252:253], v13 offset:40960
    v_mfma_f32_16x16x32_bf16 v[184:187], v[28:31], v[40:43], v[184:187]
    ds_read_b64_tr_b16 v[254:255], v13 offset:41984
    s_waitcnt lgkmcnt(12)
    v_mfma_f32_16x16x32_bf16 v[188:191], v[28:31], v[44:47], v[188:191]
    v_mfma_f32_16x16x32_bf16 v[172:175], v[24:27], v[44:47], v[172:175]
    v_mfma_f32_16x16x32_bf16 v[156:159], v[20:23], v[44:47], v[156:159]
    v_mfma_f32_16x16x32_bf16 v[140:143], v[16:19], v[44:47], v[140:143]
    s_waitcnt lgkmcnt(6)
    v_mfma_f32_16x16x32_bf16 v[128:131], v[224:227], v[240:243], v[128:131]
    v_mfma_f32_16x16x32_bf16 v[144:147], v[228:231], v[240:243], v[144:147]
    v_mfma_f32_16x16x32_bf16 v[160:163], v[232:235], v[240:243], v[160:163]
    s_waitcnt lgkmcnt(0)
    s_barrier
    v_mfma_f32_16x16x32_bf16 v[176:179], v[236:239], v[240:243], v[176:179]
    ds_read_b64_tr_b16 v[32:33], v10 offset:49152
    v_mfma_f32_16x16x32_bf16 v[180:183], v[236:239], v[244:247], v[180:183]
    ds_read_b64_tr_b16 v[34:35], v10 offset:50176
    v_mfma_f32_16x16x32_bf16 v[164:167], v[232:235], v[244:247], v[164:167]
    ds_read_b128 v[16:19], v52 offset:49152
    v_mfma_f32_16x16x32_bf16 v[148:151], v[228:231], v[244:247], v[148:151]
    ds_read_b128 v[20:23], v52 offset:50176
    v_mfma_f32_16x16x32_bf16 v[132:135], v[224:227], v[244:247], v[132:135]
    ds_read_b128 v[24:27], v52 offset:53248
    v_mfma_f32_16x16x32_bf16 v[136:139], v[224:227], v[248:251], v[136:139]
    ds_read_b128 v[28:31], v52 offset:54272
    v_mfma_f32_16x16x32_bf16 v[152:155], v[228:231], v[248:251], v[152:155]
    ds_read_b64_tr_b16 v[36:37], v11 offset:49152
    v_mfma_f32_16x16x32_bf16 v[168:171], v[232:235], v[248:251], v[168:171]
    ds_read_b64_tr_b16 v[38:39], v11 offset:50176
    v_mfma_f32_16x16x32_bf16 v[184:187], v[236:239], v[248:251], v[184:187]
    ds_read_b64_tr_b16 v[40:41], v12 offset:49152
    v_mfma_f32_16x16x32_bf16 v[188:191], v[236:239], v[252:255], v[188:191]
    ds_read_b64_tr_b16 v[42:43], v12 offset:50176
    v_mfma_f32_16x16x32_bf16 v[172:175], v[232:235], v[252:255], v[172:175]
    ds_read_b64_tr_b16 v[44:45], v13 offset:49152
    v_mfma_f32_16x16x32_bf16 v[156:159], v[228:231], v[252:255], v[156:159]
    ds_read_b64_tr_b16 v[46:47], v13 offset:50176
    v_mfma_f32_16x16x32_bf16 v[140:143], v[224:227], v[252:255], v[140:143]
    s_waitcnt lgkmcnt(6)
    v_mfma_f32_16x16x32_bf16 v[128:131], v[16:19], v[32:35], v[128:131]
    ds_read_b64_tr_b16 v[240:241], v10 offset:57344
    v_mfma_f32_16x16x32_bf16 v[144:147], v[20:23], v[32:35], v[144:147]
    ds_read_b64_tr_b16 v[242:243], v10 offset:58368
    v_mfma_f32_16x16x32_bf16 v[160:163], v[24:27], v[32:35], v[160:163]
    ds_read_b128 v[224:227], v53 offset:49152
    v_mfma_f32_16x16x32_bf16 v[176:179], v[28:31], v[32:35], v[176:179]
    ds_read_b128 v[228:231], v53 offset:50176
    s_waitcnt lgkmcnt(8)
    v_mfma_f32_16x16x32_bf16 v[180:183], v[28:31], v[36:39], v[180:183]
    ds_read_b128 v[232:235], v53 offset:53248
    v_mfma_f32_16x16x32_bf16 v[164:167], v[24:27], v[36:39], v[164:167]
    ds_read_b128 v[236:239], v53 offset:54272
    v_mfma_f32_16x16x32_bf16 v[148:151], v[20:23], v[36:39], v[148:151]
    ds_read_b64_tr_b16 v[244:245], v11 offset:57344
    v_mfma_f32_16x16x32_bf16 v[132:135], v[16:19], v[36:39], v[132:135]
    ds_read_b64_tr_b16 v[246:247], v11 offset:58368
    s_waitcnt lgkmcnt(10)
    v_mfma_f32_16x16x32_bf16 v[136:139], v[16:19], v[40:43], v[136:139]
    ds_read_b64_tr_b16 v[248:249], v12 offset:57344
    v_mfma_f32_16x16x32_bf16 v[152:155], v[20:23], v[40:43], v[152:155]
    ds_read_b64_tr_b16 v[250:251], v12 offset:58368
    v_mfma_f32_16x16x32_bf16 v[168:171], v[24:27], v[40:43], v[168:171]
    ds_read_b64_tr_b16 v[252:253], v13 offset:57344
    v_mfma_f32_16x16x32_bf16 v[184:187], v[28:31], v[40:43], v[184:187]
    ds_read_b64_tr_b16 v[254:255], v13 offset:58368
    s_waitcnt lgkmcnt(12)
    v_mfma_f32_16x16x32_bf16 v[188:191], v[28:31], v[44:47], v[188:191]
    v_mfma_f32_16x16x32_bf16 v[172:175], v[24:27], v[44:47], v[172:175]
    v_mfma_f32_16x16x32_bf16 v[156:159], v[20:23], v[44:47], v[156:159]
    v_mfma_f32_16x16x32_bf16 v[140:143], v[16:19], v[44:47], v[140:143]
    s_waitcnt lgkmcnt(6)
    v_mfma_f32_16x16x32_bf16 v[128:131], v[224:227], v[240:243], v[128:131]
    v_mfma_f32_16x16x32_bf16 v[144:147], v[228:231], v[240:243], v[144:147]
    v_mfma_f32_16x16x32_bf16 v[160:163], v[232:235], v[240:243], v[160:163]
    s_waitcnt lgkmcnt(0)
    s_barrier
    v_mfma_f32_16x16x32_bf16 v[176:179], v[236:239], v[240:243], v[176:179]
    ds_read_b64_tr_b16 v[32:33], v10 offset:0
    v_mfma_f32_16x16x32_bf16 v[180:183], v[236:239], v[244:247], v[180:183]
    ds_read_b64_tr_b16 v[34:35], v10 offset:1024
    v_mfma_f32_16x16x32_bf16 v[164:167], v[232:235], v[244:247], v[164:167]
    ds_read_b128 v[16:19], v52 offset:0
    v_mfma_f32_16x16x32_bf16 v[148:151], v[228:231], v[244:247], v[148:151]
    ds_read_b128 v[20:23], v52 offset:1024
    v_mfma_f32_16x16x32_bf16 v[132:135], v[224:227], v[244:247], v[132:135]
    ds_read_b128 v[24:27], v52 offset:4096
    v_mfma_f32_16x16x32_bf16 v[136:139], v[224:227], v[248:251], v[136:139]
    ds_read_b128 v[28:31], v52 offset:5120
    v_mfma_f32_16x16x32_bf16 v[152:155], v[228:231], v[248:251], v[152:155]
    ds_read_b64_tr_b16 v[36:37], v11 offset:0
    v_mfma_f32_16x16x32_bf16 v[168:171], v[232:235], v[248:251], v[168:171]
    ds_read_b64_tr_b16 v[38:39], v11 offset:1024
    v_mfma_f32_16x16x32_bf16 v[184:187], v[236:239], v[248:251], v[184:187]
    ds_read_b64_tr_b16 v[40:41], v12 offset:0
    v_mfma_f32_16x16x32_bf16 v[188:191], v[236:239], v[252:255], v[188:191]
    ds_read_b64_tr_b16 v[42:43], v12 offset:1024
    v_mfma_f32_16x16x32_bf16 v[172:175], v[232:235], v[252:255], v[172:175]
    ds_read_b64_tr_b16 v[44:45], v13 offset:0
    v_mfma_f32_16x16x32_bf16 v[156:159], v[228:231], v[252:255], v[156:159]
    ds_read_b64_tr_b16 v[46:47], v13 offset:1024
    v_mfma_f32_16x16x32_bf16 v[140:143], v[224:227], v[252:255], v[140:143]
    s_waitcnt lgkmcnt(6)
    v_mfma_f32_16x16x32_bf16 v[128:131], v[16:19], v[32:35], v[128:131]
    ds_read_b64_tr_b16 v[240:241], v10 offset:8192
    v_mfma_f32_16x16x32_bf16 v[144:147], v[20:23], v[32:35], v[144:147]
    ds_read_b64_tr_b16 v[242:243], v10 offset:9216
    v_mfma_f32_16x16x32_bf16 v[160:163], v[24:27], v[32:35], v[160:163]
    ds_read_b128 v[224:227], v53 offset:0
    v_mfma_f32_16x16x32_bf16 v[176:179], v[28:31], v[32:35], v[176:179]
    ds_read_b128 v[228:231], v53 offset:1024
    s_waitcnt lgkmcnt(8)
    v_mfma_f32_16x16x32_bf16 v[180:183], v[28:31], v[36:39], v[180:183]
    ds_read_b128 v[232:235], v53 offset:4096
    v_mfma_f32_16x16x32_bf16 v[164:167], v[24:27], v[36:39], v[164:167]
    ds_read_b128 v[236:239], v53 offset:5120
    v_mfma_f32_16x16x32_bf16 v[148:151], v[20:23], v[36:39], v[148:151]
    ds_read_b64_tr_b16 v[244:245], v11 offset:8192
    v_mfma_f32_16x16x32_bf16 v[132:135], v[16:19], v[36:39], v[132:135]
    ds_read_b64_tr_b16 v[246:247], v11 offset:9216
    s_waitcnt lgkmcnt(10)
    v_mfma_f32_16x16x32_bf16 v[136:139], v[16:19], v[40:43], v[136:139]
    ds_read_b64_tr_b16 v[248:249], v12 offset:8192
    v_mfma_f32_16x16x32_bf16 v[152:155], v[20:23], v[40:43], v[152:155]
    ds_read_b64_tr_b16 v[250:251], v12 offset:9216
    v_mfma_f32_16x16x32_bf16 v[168:171], v[24:27], v[40:43], v[168:171]
    ds_read_b64_tr_b16 v[252:253], v13 offset:8192
    v_mfma_f32_16x16x32_bf16 v[184:187], v[28:31], v[40:43], v[184:187]
    ds_read_b64_tr_b16 v[254:255], v13 offset:9216
    s_waitcnt lgkmcnt(12)
    v_mfma_f32_16x16x32_bf16 v[188:191], v[28:31], v[44:47], v[188:191]
    v_mfma_f32_16x16x32_bf16 v[172:175], v[24:27], v[44:47], v[172:175]
    v_mfma_f32_16x16x32_bf16 v[156:159], v[20:23], v[44:47], v[156:159]
    v_mfma_f32_16x16x32_bf16 v[140:143], v[16:19], v[44:47], v[140:143]
    s_waitcnt lgkmcnt(6)
    v_mfma_f32_16x16x32_bf16 v[128:131], v[224:227], v[240:243], v[128:131]
    v_mfma_f32_16x16x32_bf16 v[144:147], v[228:231], v[240:243], v[144:147]
    v_mfma_f32_16x16x32_bf16 v[160:163], v[232:235], v[240:243], v[160:163]
    s_waitcnt lgkmcnt(0)
    s_barrier
    v_mfma_f32_16x16x32_bf16 v[176:179], v[236:239], v[240:243], v[176:179]
    ds_read_b64_tr_b16 v[32:33], v10 offset:16384
    v_mfma_f32_16x16x32_bf16 v[180:183], v[236:239], v[244:247], v[180:183]
    ds_read_b64_tr_b16 v[34:35], v10 offset:17408
    v_mfma_f32_16x16x32_bf16 v[164:167], v[232:235], v[244:247], v[164:167]
    ds_read_b128 v[16:19], v52 offset:16384
    v_mfma_f32_16x16x32_bf16 v[148:151], v[228:231], v[244:247], v[148:151]
    ds_read_b128 v[20:23], v52 offset:17408
    v_mfma_f32_16x16x32_bf16 v[132:135], v[224:227], v[244:247], v[132:135]
    ds_read_b128 v[24:27], v52 offset:20480
    v_mfma_f32_16x16x32_bf16 v[136:139], v[224:227], v[248:251], v[136:139]
    ds_read_b128 v[28:31], v52 offset:21504
    v_mfma_f32_16x16x32_bf16 v[152:155], v[228:231], v[248:251], v[152:155]
    ds_read_b64_tr_b16 v[36:37], v11 offset:16384
    v_mfma_f32_16x16x32_bf16 v[168:171], v[232:235], v[248:251], v[168:171]
    ds_read_b64_tr_b16 v[38:39], v11 offset:17408
    v_mfma_f32_16x16x32_bf16 v[184:187], v[236:239], v[248:251], v[184:187]
    ds_read_b64_tr_b16 v[40:41], v12 offset:16384
    v_mfma_f32_16x16x32_bf16 v[188:191], v[236:239], v[252:255], v[188:191]
    ds_read_b64_tr_b16 v[42:43], v12 offset:17408
    v_mfma_f32_16x16x32_bf16 v[172:175], v[232:235], v[252:255], v[172:175]
    ds_read_b64_tr_b16 v[44:45], v13 offset:16384
    v_mfma_f32_16x16x32_bf16 v[156:159], v[228:231], v[252:255], v[156:159]
    ds_read_b64_tr_b16 v[46:47], v13 offset:17408
    v_mfma_f32_16x16x32_bf16 v[140:143], v[224:227], v[252:255], v[140:143]
    s_waitcnt lgkmcnt(6)
    v_mfma_f32_16x16x32_bf16 v[128:131], v[16:19], v[32:35], v[128:131]
    ds_read_b64_tr_b16 v[240:241], v10 offset:24576
    v_mfma_f32_16x16x32_bf16 v[144:147], v[20:23], v[32:35], v[144:147]
    ds_read_b64_tr_b16 v[242:243], v10 offset:25600
    v_mfma_f32_16x16x32_bf16 v[160:163], v[24:27], v[32:35], v[160:163]
    ds_read_b128 v[224:227], v53 offset:16384
    v_mfma_f32_16x16x32_bf16 v[176:179], v[28:31], v[32:35], v[176:179]
    ds_read_b128 v[228:231], v53 offset:17408
    s_waitcnt lgkmcnt(8)
    v_mfma_f32_16x16x32_bf16 v[180:183], v[28:31], v[36:39], v[180:183]
    ds_read_b128 v[232:235], v53 offset:20480
    v_mfma_f32_16x16x32_bf16 v[164:167], v[24:27], v[36:39], v[164:167]
    ds_read_b128 v[236:239], v53 offset:21504
    v_mfma_f32_16x16x32_bf16 v[148:151], v[20:23], v[36:39], v[148:151]
    ds_read_b64_tr_b16 v[244:245], v11 offset:24576
    v_mfma_f32_16x16x32_bf16 v[132:135], v[16:19], v[36:39], v[132:135]
    ds_read_b64_tr_b16 v[246:247], v11 offset:25600
    s_waitcnt lgkmcnt(10)
    v_mfma_f32_16x16x32_bf16 v[136:139], v[16:19], v[40:43], v[136:139]
    ds_read_b64_tr_b16 v[248:249], v12 offset:24576
    v_mfma_f32_16x16x32_bf16 v[152:155], v[20:23], v[40:43], v[152:155]
    ds_read_b64_tr_b16 v[250:251], v12 offset:25600
    v_mfma_f32_16x16x32_bf16 v[168:171], v[24:27], v[40:43], v[168:171]
    ds_read_b64_tr_b16 v[252:253], v13 offset:24576
    v_mfma_f32_16x16x32_bf16 v[184:187], v[28:31], v[40:43], v[184:187]
    ds_read_b64_tr_b16 v[254:255], v13 offset:25600
    s_waitcnt lgkmcnt(12)
    v_mfma_f32_16x16x32_bf16 v[188:191], v[28:31], v[44:47], v[188:191]
    v_mfma_f32_16x16x32_bf16 v[172:175], v[24:27], v[44:47], v[172:175]
    v_mfma_f32_16x16x32_bf16 v[156:159], v[20:23], v[44:47], v[156:159]
    v_mfma_f32_16x16x32_bf16 v[140:143], v[16:19], v[44:47], v[140:143]
    s_waitcnt lgkmcnt(6)
    v_mfma_f32_16x16x32_bf16 v[128:131], v[224:227], v[240:243], v[128:131]
    v_mfma_f32_16x16x32_bf16 v[144:147], v[228:231], v[240:243], v[144:147]
    v_mfma_f32_16x16x32_bf16 v[160:163], v[232:235], v[240:243], v[160:163]
    s_waitcnt lgkmcnt(0)
    s_barrier
    ds_read_b128 v[64:67], v55 offset:0
    ds_read_b128 v[80:83], v55 offset:512
    ds_read_b128 v[68:71], v55 offset:32
    ds_read_b128 v[84:87], v55 offset:544
    ds_read_b128 v[72:75], v55 offset:128
    ds_read_b128 v[88:91], v55 offset:640
    ds_read_b128 v[76:79], v55 offset:160
    ds_read_b128 v[92:95], v55 offset:672
    ds_read_b32 v104, v54 offset:0
    ds_read_b32 v106, v54 offset:64
    ds_read_b32 v108, v54 offset:128
    ds_read_b32 v110, v54 offset:192
    s_cmp_eq_u32 s61, 15
    s_cbranch_scc1 L_g129
    v_mfma_f32_16x16x32_bf16 v[176:179], v[236:239], v[240:243], v[176:179]
    ds_read_b64_tr_b16 v[32:33], v10 offset:32768
    v_mfma_f32_16x16x32_bf16 v[180:183], v[236:239], v[244:247], v[180:183]
    ds_read_b64_tr_b16 v[34:35], v10 offset:33792
    v_mfma_f32_16x16x32_bf16 v[164:167], v[232:235], v[244:247], v[164:167]
    ds_read_b128 v[16:19], v48 offset:32768
    v_mfma_f32_16x16x32_bf16 v[148:151], v[228:231], v[244:247], v[148:151]
    ds_read_b128 v[20:23], v49 offset:34816
    v_mfma_f32_16x16x32_bf16 v[132:135], v[224:227], v[244:247], v[132:135]
    ds_read_b128 v[24:27], v48 offset:36864
    v_mfma_f32_16x16x32_bf16 v[136:139], v[224:227], v[248:251], v[136:139]
    ds_read_b128 v[28:31], v49 offset:38912
    v_mfma_f32_16x16x32_bf16 v[152:155], v[228:231], v[248:251], v[152:155]
    ds_read_b64_tr_b16 v[36:37], v11 offset:32768
    v_mfma_f32_16x16x32_bf16 v[168:171], v[232:235], v[248:251], v[168:171]
    ds_read_b64_tr_b16 v[38:39], v11 offset:33792
    v_mfma_f32_16x16x32_bf16 v[184:187], v[236:239], v[248:251], v[184:187]
    ds_read_b64_tr_b16 v[40:41], v12 offset:32768
    v_mfma_f32_16x16x32_bf16 v[188:191], v[236:239], v[252:255], v[188:191]
    ds_read_b64_tr_b16 v[42:43], v12 offset:33792
    v_mfma_f32_16x16x32_bf16 v[172:175], v[232:235], v[252:255], v[172:175]
    ds_read_b64_tr_b16 v[44:45], v13 offset:32768
    v_mfma_f32_16x16x32_bf16 v[156:159], v[228:231], v[252:255], v[156:159]
    ds_read_b64_tr_b16 v[46:47], v13 offset:33792
    v_mfma_f32_16x16x32_bf16 v[140:143], v[224:227], v[252:255], v[140:143]
L_g130:
    s_nop 7
    s_waitcnt lgkmcnt(6)
    v_pk_fma_f32 v[128:129], v[64:65], v[104:105], v[128:129] op_sel_hi:[1,0,1]
    v_pk_fma_f32 v[130:131], v[66:67], v[104:105], v[130:131] op_sel_hi:[1,0,1]
    v_pk_fma_f32 v[132:133], v[64:65], v[106:107], v[132:133] op_sel_hi:[1,0,1]
    v_pk_fma_f32 v[134:135], v[66:67], v[106:107], v[134:135] op_sel_hi:[1,0,1]
    v_pk_fma_f32 v[136:137], v[64:65], v[108:109], v[136:137] op_sel_hi:[1,0,1]
    v_pk_fma_f32 v[138:139], v[66:67], v[108:109], v[138:139] op_sel_hi:[1,0,1]
    v_pk_fma_f32 v[140:141], v[64:65], v[110:111], v[140:141] op_sel_hi:[1,0,1]
    v_pk_fma_f32 v[142:143], v[66:67], v[110:111], v[142:143] op_sel_hi:[1,0,1]
    v_pk_mul_f32 v[128:129], v[128:129], v[80:81]
    v_pk_mul_f32 v[130:131], v[130:131], v[82:83]
    v_pk_mul_f32 v[132:133], v[132:133], v[80:81]
    v_pk_mul_f32 v[134:135], v[134:135], v[82:83]
    v_pk_mul_f32 v[136:137], v[136:137], v[80:81]
    v_pk_mul_f32 v[138:139], v[138:139], v[82:83]
    v_pk_mul_f32 v[140:141], v[140:141], v[80:81]
    v_pk_mul_f32 v[142:143], v[142:143], v[82:83]
    v_cvt_pk_bf16_f32 v112, v128, v129
    v_cvt_pk_bf16_f32 v113, v130, v131
    v_cvt_pk_bf16_f32 v116, v132, v133
    v_cvt_pk_bf16_f32 v117, v134, v135
    v_cvt_pk_bf16_f32 v120, v136, v137
    v_cvt_pk_bf16_f32 v121, v138, v139
    v_cvt_pk_bf16_f32 v124, v140, v141
    v_cvt_pk_bf16_f32 v125, v142, v143
    v_pk_fma_f32 v[144:145], v[68:69], v[104:105], v[144:145] op_sel_hi:[1,0,1]
    v_pk_fma_f32 v[146:147], v[70:71], v[104:105], v[146:147] op_sel_hi:[1,0,1]
    v_pk_fma_f32 v[148:149], v[68:69], v[106:107], v[148:149] op_sel_hi:[1,0,1]
    v_pk_fma_f32 v[150:151], v[70:71], v[106:107], v[150:151] op_sel_hi:[1,0,1]
    v_pk_fma_f32 v[152:153], v[68:69], v[108:109], v[152:153] op_sel_hi:[1,0,1]
    v_pk_fma_f32 v[154:155], v[70:71], v[108:109], v[154:155] op_sel_hi:[1,0,1]
    v_pk_fma_f32 v[156:157], v[68:69], v[110:111], v[156:157] op_sel_hi:[1,0,1]
    v_pk_fma_f32 v[158:159], v[70:71], v[110:111], v[158:159] op_sel_hi:[1,0,1]
    v_pk_mul_f32 v[144:145], v[144:145], v[84:85]
    v_pk_mul_f32 v[146:147], v[146:147], v[86:87]
    v_pk_mul_f32 v[148:149], v[148:149], v[84:85]
    v_pk_mul_f32 v[150:151], v[150:151], v[86:87]
    v_pk_mul_f32 v[152:153], v[152:153], v[84:85]
    v_pk_mul_f32 v[154:155], v[154:155], v[86:87]
    v_pk_mul_f32 v[156:157], v[156:157], v[84:85]
    v_pk_mul_f32 v[158:159], v[158:159], v[86:87]
    v_cvt_pk_bf16_f32 v114, v144, v145
    v_cvt_pk_bf16_f32 v115, v146, v147
    v_cvt_pk_bf16_f32 v118, v148, v149
    v_cvt_pk_bf16_f32 v119, v150, v151
    v_cvt_pk_bf16_f32 v122, v152, v153
    v_cvt_pk_bf16_f32 v123, v154, v155
    v_cvt_pk_bf16_f32 v126, v156, v157
    v_cvt_pk_bf16_f32 v127, v158, v159
    buffer_store_dwordx4 v[112:115], v96, s[20:23], 0 offen offset:0 sc1
    buffer_store_dwordx4 v[116:119], v97, s[20:23], 0 offen offset:0 sc1
    buffer_store_dwordx4 v[120:123], v98, s[20:23], 0 offen offset:0 sc1
    buffer_store_dwordx4 v[124:127], v99, s[20:23], 0 offen offset:0 sc1
    v_pk_fma_f32 v[160:161], v[72:73], v[104:105], v[160:161] op_sel_hi:[1,0,1]
    v_pk_fma_f32 v[162:163], v[74:75], v[104:105], v[162:163] op_sel_hi:[1,0,1]
    v_pk_fma_f32 v[164:165], v[72:73], v[106:107], v[164:165] op_sel_hi:[1,0,1]
    v_pk_fma_f32 v[166:167], v[74:75], v[106:107], v[166:167] op_sel_hi:[1,0,1]
    v_pk_fma_f32 v[168:169], v[72:73], v[108:109], v[168:169] op_sel_hi:[1,0,1]
    v_pk_fma_f32 v[170:171], v[74:75], v[108:109], v[170:171] op_sel_hi:[1,0,1]
    v_pk_fma_f32 v[172:173], v[72:73], v[110:111], v[172:173] op_sel_hi:[1,0,1]
    v_pk_fma_f32 v[174:175], v[74:75], v[110:111], v[174:175] op_sel_hi:[1,0,1]
    v_pk_mul_f32 v[160:161], v[160:161], v[88:89]
    v_pk_mul_f32 v[162:163], v[162:163], v[90:91]
    v_pk_mul_f32 v[164:165], v[164:165], v[88:89]
    v_pk_mul_f32 v[166:167], v[166:167], v[90:91]
    v_pk_mul_f32 v[168:169], v[168:169], v[88:89]
    v_pk_mul_f32 v[170:171], v[170:171], v[90:91]
    v_pk_mul_f32 v[172:173], v[172:173], v[88:89]
    v_pk_mul_f32 v[174:175], v[174:175], v[90:91]
    v_cvt_pk_bf16_f32 v192, v160, v161
    v_cvt_pk_bf16_f32 v193, v162, v163
    v_cvt_pk_bf16_f32 v196, v164, v165
    v_cvt_pk_bf16_f32 v197, v166, v167
    v_cvt_pk_bf16_f32 v200, v168, v169
    v_cvt_pk_bf16_f32 v201, v170, v171
    v_cvt_pk_bf16_f32 v204, v172, v173
    v_cvt_pk_bf16_f32 v205, v174, v175
    v_pk_fma_f32 v[176:177], v[76:77], v[104:105], v[176:177] op_sel_hi:[1,0,1]
    v_pk_fma_f32 v[178:179], v[78:79], v[104:105], v[178:179] op_sel_hi:[1,0,1]
    v_pk_fma_f32 v[180:181], v[76:77], v[106:107], v[180:181] op_sel_hi:[1,0,1]
    v_pk_fma_f32 v[182:183], v[78:79], v[106:107], v[182:183] op_sel_hi:[1,0,1]
    v_pk_fma_f32 v[184:185], v[76:77], v[108:109], v[184:185] op_sel_hi:[1,0,1]
    v_pk_fma_f32 v[186:187], v[78:79], v[108:109], v[186:187] op_sel_hi:[1,0,1]
    v_pk_fma_f32 v[188:189], v[76:77], v[110:111], v[188:189] op_sel_hi:[1,0,1]
    v_pk_fma_f32 v[190:191], v[78:79], v[110:111], v[190:191] op_sel_hi:[1,0,1]
    v_pk_mul_f32 v[176:177], v[176:177], v[92:93]
    v_pk_mul_f32 v[178:179], v[178:179], v[94:95]
    v_pk_mul_f32 v[180:181], v[180:181], v[92:93]
    v_pk_mul_f32 v[182:183], v[182:183], v[94:95]
    v_pk_mul_f32 v[184:185], v[184:185], v[92:93]
    v_pk_mul_f32 v[186:187], v[186:187], v[94:95]
    v_pk_mul_f32 v[188:189], v[188:189], v[92:93]
    v_pk_mul_f32 v[190:191], v[190:191], v[94:95]
    v_cvt_pk_bf16_f32 v194, v176, v177
    v_cvt_pk_bf16_f32 v195, v178, v179
    v_cvt_pk_bf16_f32 v198, v180, v181
    v_cvt_pk_bf16_f32 v199, v182, v183
    v_cvt_pk_bf16_f32 v202, v184, v185
    v_cvt_pk_bf16_f32 v203, v186, v187
    v_cvt_pk_bf16_f32 v206, v188, v189
    v_cvt_pk_bf16_f32 v207, v190, v191
    buffer_store_dwordx4 v[192:195], v96, s[20:23], 0 offen offset:1280 sc1
    buffer_store_dwordx4 v[196:199], v97, s[20:23], 0 offen offset:1280 sc1
    buffer_store_dwordx4 v[200:203], v98, s[20:23], 0 offen offset:1280 sc1
    buffer_store_dwordx4 v[204:207], v99, s[20:23], 0 offen offset:1280 sc1
    s_cmp_eq_u32 s61, 15
    s_cbranch_scc1 L_g_now1
    s_branch L_g_w1
L_g_colsum:
    s_mul_i32 s42, s59, 138240
    s_mul_i32 s43, s58, 34560
    s_add_u32 s42, s42, s43
    v_lshlrev_b32 v5, 7, v2
    v_add_u32 v5, s42, v5
    buffer_load_dword v6, v5, s[16:19], 0 offen
    v_add_u32 v5, 6912, v5
    buffer_load_dword v6, v5, s[16:19], 0 offen
    v_add_u32 v5, 6912, v5
    buffer_load_dword v6, v5, s[16:19], 0 offen
    v_add_u32 v5, 6912, v5
    buffer_load_dword v6, v5, s[16:19], 0 offen
    v_add_u32 v5, 6912, v5
    buffer_load_dword v6, v5, s[16:19], 0 offen
    v_add_u32 v5, 6912, v5
    v_mov_b32 v48, v8
    v_mov_b32 v49, v8
    v_mov_b32 v50, v9
    v_mov_b32 v51, v9
    s_waitcnt vmcnt(0)
    s_barrier
    ds_read_b64_tr_b16 v[32:33], v10 offset:32768
    ds_read_b64_tr_b16 v[34:35], v10 offset:33792
    ds_read_b128 v[16:19], v48 offset:32768
    ds_read_b128 v[20:23], v49 offset:34816
    ds_read_b128 v[24:27], v48 offset:36864
    ds_read_b128 v[28:31], v49 offset:38912
    ds_read_b64_tr_b16 v[36:37], v11 offset:32768
    ds_read_b64_tr_b16 v[38:39], v11 offset:33792
    ds_read_b64_tr_b16 v[40:41], v12 offset:32768
    ds_read_b64_tr_b16 v[42:43], v12 offset:33792
    ds_read_b64_tr_b16 v[44:45], v13 offset:32768
    ds_read_b64_tr_b16 v[46:47], v13 offset:33792
    s_branch L_g_w1
L_ld_h:
    s_mov_b64 s[68:69], s[44:45]
    s_mov_b32 s70, s46
    s_mov_b32 s40, s42
    s_mov_b32 s41, s43
    v_mov_b32 v8, v12
    v_mov_b32 v9, v13
    v_mov_b32 v10, v14
    v_mov_b32 v11, v15
    s_add_u32 s52, s3, 6
    s_sub_u32 s54, s52, 10
    s_cmp_ge_u32 s52, 10
    s_cselect_b32 s52, s54, s52
    s_mov_b32 s65, 10
    s_mov_b32 s48, 32768
    s_branch L_ld_0
L_o1:
    s_mov_b32 s71, 20000
L_p3:
    buffer_load_dword v6, v5, s[24:27], 0 offen sc1
    s_waitcnt vmcnt(0)
    v_cmp_eq_u32 vcc, 0, v6
    s_nop 1
    s_cbranch_vccz L_pd4
    s_sleep 1
    s_sub_u32 s71, s71, 1
    s_cmp_lg_u32 s71, 0
    s_cbranch_scc1 L_p3
L_pd4:
    s_branch L_ob2
L_o5:
    s_mov_b32 s71, 20000
L_p7:
    buffer_load_dwordx4 v[28:31], v9, s[20:23], s42 offen sc1
    buffer_load_dwordx4 v[32:35], v9, s[20:23], s42 offen offset:1024 sc1
    s_waitcnt vmcnt(0)
    v_cmp_ne_u32 vcc, s64, v31
    v_cmp_ne_u32 s[44:45], s64, v35
    s_nop 1
    s_or_b64 vcc, vcc, s[44:45]
    s_nop 1
    s_cbranch_vccz L_pd8
    s_sleep 1
    s_sub_u32 s71, s71, 1
    s_cmp_lg_u32 s71, 0
    s_cbranch_scc1 L_p7
L_pd8:
    s_branch L_ob6
L_o9:
    s_mov_b32 s71, 20000
L_p11:
    buffer_load_dword v6, v5, s[24:27], 0 offen sc1
    s_waitcnt vmcnt(0)
    v_cmp_eq_u32 vcc, 0, v6
    s_nop 1
    s_cbranch_vccz L_pd12
    s_sleep 1
    s_sub_u32 s71, s71, 1
    s_cmp_lg_u32 s71, 0
    s_cbranch_scc1 L_p11
L_pd12:
    s_branch L_ob10
L_o13:
    s_mov_b32 s71, 20000
L_p15:
    buffer_load_dwordx4 v[88:91], v218, s[20:23], s28 offen offset:0 sc1
    buffer_load_dwordx4 v[92:95], v218, s[20:23], s28 offen offset:1024 sc1
    buffer_load_dwordx4 v[96:99], v218, s[20:23], s28 offen offset:2048 sc1
    buffer_load_dwordx4 v[100:103], v218, s[20:23], s28 offen offset:3072 sc1
    buffer_load_dwordx4 v[104:107], v218, s[20:23], s29 offen offset:0 sc1
    buffer_load_dwordx4 v[108:111], v218, s[20:23], s29 offen offset:1024 sc1
    buffer_load_dwordx4 v[112:115], v218, s[20:23], s29 offen offset:2048 sc1
    buffer_load_dwordx4 v[116:119], v218, s[20:23], s29 offen offset:3072 sc1
    buffer_load_dwordx4 v[120:123], v218, s[20:23], s30 offen offset:0 sc1
    buffer_load_dwordx4 v[124:127], v218, s[20:23], s30 offen offset:1024 sc1
    s_waitcnt vmcnt(0)
    v_min_u32 v10, v89, v91
    v_max_u32 v11, v89, v91
    v_min3_u32 v10, v10, v93, v95
    v_max3_u32 v11, v11, v93, v95
    v_min3_u32 v10, v10, v97, v99
    v_max3_u32 v11, v11, v97, v99
    v_min3_u32 v10, v10, v101, v103
    v_max3_u32 v11, v11, v101, v103
    v_min3_u32 v10, v10, v105, v107
    v_max3_u32 v11, v11, v105, v107
    v_min3_u32 v10, v10, v109, v111
    v_max3_u32 v11, v11, v109, v111
    v_min3_u32 v10, v10, v113, v115
    v_max3_u32 v11, v11, v113, v115
    v_min3_u32 v10, v10, v117, v119
    v_max3_u32 v11, v11, v117, v119
    v_min3_u32 v10, v10, v121, v123
    v_max3_u32 v11, v11, v121, v123
    v_min3_u32 v10, v10, v125, v127
    v_max3_u32 v11, v11, v125, v127
    v_cmp_ne_u32 vcc, s64, v10
    v_cmp_ne_u32 s[32:33], s64, v11
    s_nop 1
    s_or_b64 vcc, vcc, s[32:33]
    s_nop 1
    s_cbranch_vccz L_pd16
    s_sleep 1
    s_sub_u32 s71, s71, 1
    s_cmp_lg_u32 s71, 0
    s_cbranch_scc1 L_p15
L_pd16:
    s_branch L_ob14
L_o17:
    s_mov_b32 s71, 20000
L_p19:
    buffer_load_dwordx4 v[88:91], v218, s[20:23], s28 offen offset:0 sc1
    buffer_load_dwordx4 v[92:95], v218, s[20:23], s28 offen offset:1024 sc1
    buffer_load_dwordx4 v[96:99], v218, s[20:23], s28 offen offset:2048 sc1
    buffer_load_dwordx4 v[100:103], v218, s[20:23], s28 offen offset:3072 sc1
    buffer_load_dwordx4 v[104:107], v218, s[20:23], s29 offen offset:0 sc1
    buffer_load_dwordx4 v[108:111], v218, s[20:23], s29 offen offset:1024 sc1
    buffer_load_dwordx4 v[112:115], v218, s[20:23], s29 offen offset:2048 sc1
    buffer_load_dwordx4 v[116:119], v218, s[20:23], s29 offen offset:3072 sc1
    buffer_load_dwordx4 v[120:123], v218, s[20:23], s30 offen offset:0 sc1
    buffer_load_dwordx4 v[124:127], v218, s[20:23], s30 offen offset:1024 sc1
    s_waitcnt vmcnt(0)
    v_min_u32 v10, v89, v91
    v_max_u32 v11, v89, v91
    v_min3_u32 v10, v10, v93, v95
    v_max3_u32 v11, v11, v93, v95
    v_min3_u32 v10, v10, v97, v99
    v_max3_u32 v11, v11, v97, v99
    v_min3_u32 v10, v10, v101, v103
    v_max3_u32 v11, v11, v101, v103
    v_min3_u32 v10, v10, v105, v107
    v_max3_u32 v11, v11, v105, v107
    v_min3_u32 v10, v10, v109, v111
    v_max3_u32 v11, v11, v109, v111
    v_min3_u32 v10, v10, v113, v115
    v_max3_u32 v11, v11, v113, v115
    v_min3_u32 v10, v10, v117, v119
    v_max3_u32 v11, v11, v117, v119
    v_min3_u32 v10, v10, v121, v123
    v_max3_u32 v11, v11, v121, v123
    v_min3_u32 v10, v10, v125, v127
    v_max3_u32 v11, v11, v125, v127
    v_cmp_ne_u32 vcc, s64, v10
    v_cmp_ne_u32 s[32:33], s64, v11
    s_nop 1
    s_or_b64 vcc, vcc, s[32:33]
    s_nop 1
    s_cbranch_vccz L_pd20
    s_sleep 1
    s_sub_u32 s71, s71, 1
    s_cmp_lg_u32 s71, 0
    s_cbranch_scc1 L_p19
L_pd20:
    s_branch L_ob18
L_o21:
    s_mov_b32 s71, 20000
L_p23:
    buffer_load_dword v6, v5, s[24:27], 0 offen sc1
    s_waitcnt vmcnt(0)
    v_cmp_eq_u32 vcc, 0, v6
    s_nop 1
    s_cbranch_vccz L_pd24
    s_sleep 1
    s_sub_u32 s71, s71, 1
    s_cmp_lg_u32 s71, 0
    s_cbranch_scc1 L_p23
L_pd24:
    s_branch L_ob22
L_o25:
    s_mov_b32 s71, 20000
L_p27:
    buffer_load_dwordx4 v[28:31], v9, s[20:23], s42 offen sc1
    buffer_load_dwordx4 v[32:35], v9, s[20:23], s42 offen offset:1024 sc1
    s_waitcnt vmcnt(0)
    v_cmp_ne_u32 vcc, s64, v31
    v_cmp_ne_u32 s[44:45], s64, v35
    s_nop 1
    s_or_b64 vcc, vcc, s[44:45]
    s_nop 1
    s_cbranch_vccz L_pd28
    s_sleep 1
    s_sub_u32 s71, s71, 1
    s_cmp_lg_u32 s71, 0
    s_cbranch_scc1 L_p27
L_pd28:
    s_branch L_ob26
L_o29:
    s_mov_b32 s71, 20000
L_p31:
    buffer_load_dwordx4 v[88:91], v218, s[20:23], s28 offen offset:0 sc1
    buffer_load_dwordx4 v[92:95], v218, s[20:23], s28 offen offset:1024 sc1
    buffer_load_dwordx4 v[96:99], v218, s[20:23], s28 offen offset:2048 sc1
    buffer_load_dwordx4 v[100:103], v218, s[20:23], s28 offen offset:3072 sc1
    buffer_load_dwordx4 v[104:107], v218, s[20:23], s29 offen offset:0 sc1
    buffer_load_dwordx4 v[108:111], v218, s[20:23], s29 offen offset:1024 sc1
    buffer_load_dwordx4 v[112:115], v218, s[20:23], s29 offen offset:2048 sc1
    buffer_load_dwordx4 v[116:119], v218, s[20:23], s29 offen offset:3072 sc1
    buffer_load_dwordx4 v[120:123], v218, s[20:23], s30 offen offset:0 sc1
    buffer_load_dwordx4 v[124:127], v218, s[20:23], s30 offen offset:1024 sc1
    s_waitcnt vmcnt(0)
    v_min_u32 v10, v89, v91
    v_max_u32 v11, v89, v91
    v_min3_u32 v10, v10, v93, v95
    v_max3_u32 v11, v11, v93, v95
    v_min3_u32 v10, v10, v97, v99
    v_max3_u32 v11, v11, v97, v99
    v_min3_u32 v10, v10, v101, v103
    v_max3_u32 v11, v11, v101, v103
    v_min3_u32 v10, v10, v105, v107
    v_max3_u32 v11, v11, v105, v107
    v_min3_u32 v10, v10, v109, v111
    v_max3_u32 v11, v11, v109, v111
    v_min3_u32 v10, v10, v113, v115
    v_max3_u32 v11, v11, v113, v115
    v_min3_u32 v10, v10, v117, v119
    v_max3_u32 v11, v11, v117, v119
    v_min3_u32 v10, v10, v121, v123
    v_max3_u32 v11, v11, v121, v123
    v_min3_u32 v10, v10, v125, v127
    v_max3_u32 v11, v11, v125, v127
    v_cmp_ne_u32 vcc, s64, v10
    v_cmp_ne_u32 s[32:33], s64, v11
    s_nop 1
    s_or_b64 vcc, vcc, s[32:33]
    s_nop 1
    s_cbranch_vccz L_pd32
    s_sleep 1
    s_sub_u32 s71, s71, 1
    s_cmp_lg_u32 s71, 0
    s_cbranch_scc1 L_p31
L_pd32:
    s_branch L_ob30
L_g45:
    v_mfma_f32_16x16x32_bf16 v[176:179], v[240:243], v[236:239], v[176:179]
    v_mfma_f32_16x16x32_bf16 v[180:183], v[244:247], v[236:239], v[180:183]
    v_mfma_f32_16x16x32_bf16 v[164:167], v[244:247], v[232:235], v[164:167]
    v_mfma_f32_16x16x32_bf16 v[148:151], v[244:247], v[228:231], v[148:151]
    v_mfma_f32_16x16x32_bf16 v[132:135], v[244:247], v[224:227], v[132:135]
    v_mfma_f32_16x16x32_bf16 v[136:139], v[248:251], v[224:227], v[136:139]
    v_mfma_f32_16x16x32_bf16 v[152:155], v[248:251], v[228:231], v[152:155]
    v_mfma_f32_16x16x32_bf16 v[168:171], v[248:251], v[232:235], v[168:171]
    v_mfma_f32_16x16x32_bf16 v[184:187], v[248:251], v[236:239], v[184:187]
    v_mfma_f32_16x16x32_bf16 v[188:191], v[252:255], v[236:239], v[188:191]
    v_mfma_f32_16x16x32_bf16 v[172:175], v[252:255], v[232:235], v[172:175]
    v_mfma_f32_16x16x32_bf16 v[156:159], v[252:255], v[228:231], v[156:159]
    v_mfma_f32_16x16x32_bf16 v[140:143], v[252:255], v[224:227], v[140:143]
    s_waitcnt lgkmcnt(0)
    s_branch L_g46
L_g129:
    v_mfma_f32_16x16x32_bf16 v[176:179], v[236:239], v[240:243], v[176:179]
    v_mfma_f32_16x16x32_bf16 v[180:183], v[236:239], v[244:247], v[180:183]
    v_mfma_f32_16x16x32_bf16 v[164:167], v[232:235], v[244:247], v[164:167]
    v_mfma_f32_16x16x32_bf16 v[148:151], v[228:231], v[244:247], v[148:151]
    v_mfma_f32_16x16x32_bf16 v[132:135], v[224:227], v[244:247], v[132:135]
    v_mfma_f32_16x16x32_bf16 v[136:139], v[224:227], v[248:251], v[136:139]
    v_mfma_f32_16x16x32_bf16 v[152:155], v[228:231], v[248:251], v[152:155]
    v_mfma_f32_16x16x32_bf16 v[168:171], v[232:235], v[248:251], v[168:171]
    v_mfma_f32_16x16x32_bf16 v[184:187], v[236:239], v[248:251], v[184:187]
    v_mfma_f32_16x16x32_bf16 v[188:191], v[236:239], v[252:255], v[188:191]
    v_mfma_f32_16x16x32_bf16 v[172:175], v[232:235], v[252:255], v[172:175]
    v_mfma_f32_16x16x32_bf16 v[156:159], v[228:231], v[252:255], v[156:159]
    v_mfma_f32_16x16x32_bf16 v[140:143], v[224:227], v[252:255], v[140:143]
    s_waitcnt lgkmcnt(0)
    s_branch L_g130
L_code_end:
.section .rodata,"a"
.p2align 6
.amdhsa_kernel parallel_sum__softmax_full_mha__dense_activation_silu__prompt_kernel
  .amdhsa_next_free_vgpr 256
  .amdhsa_next_free_sgpr 102
  .amdhsa_accum_offset 256
  .amdhsa_group_segment_fixed_size 0
  .amdhsa_kernarg_size 72
  .amdhsa_user_sgpr_count 2
  .amdhsa_user_sgpr_kernarg_segment_ptr 1
  .amdhsa_system_sgpr_workgroup_id_x 1
  .amdhsa_float_denorm_mode_32 3
.end_amdhsa_kernel
```
